```python
import torch

def _softmax(x, axis=-1):
    return torch.softmax(x, dim=axis)

def _gelu(x):
    return torch.nn.functional.gelu(x, approximate='tanh')

def _silu(x):
    return torch.nn.functional.silu(x)

def _sigmoid(x):
    return torch.sigmoid(x)

def _layernorm(x, axis=-1, eps=1e-05):
    m = x.mean(dim=axis, keepdim=True)
    v = x.var(dim=axis, keepdim=True, unbiased=False)
    return (x - m) / torch.sqrt(v + eps)

def _scatter_add(tgt, idx, src, axis=0):
    return tgt.clone().index_add_(axis, idx, src)

def _segment_sum(src, seg, n):
    out = torch.zeros((n,) + src.shape[1:], dtype=src.dtype)
    return out.index_add_(0, seg, src)

def _pad(x, pw):
    flat = tuple((v for pair in reversed(pw) for v in pair))
    return torch.nn.functional.pad(x, flat)
kernel_name = 'gated_mix__linear_kernel_hedgehog__mixer_gmlp__prompt'

def setup_inputs():

    _w = lambda a: (lambda t: t.to(torch.bfloat16) if t.is_floating_point() else t)(torch.as_tensor(a))

    def _A_setup():
        B, S, D, H = (1, 2048, 448, 16)
        Dh = D // H
        return {'x': _w((lambda *s: torch.randn(*s, dtype=torch.bfloat16) * 0.05)(B, S, D)), 'wqkv': _w((lambda *s: torch.randn(*s, dtype=torch.bfloat16) * 1.6)(D, 3 * D)), 'w_phi': _w((lambda *s: torch.randn(*s, dtype=torch.bfloat16) * 1.6)(H, Dh, Dh) * Dh ** (-0.5)), 'wo': _w((lambda *s: torch.randn(*s, dtype=torch.bfloat16) * 0.1)(D, D))}
    _A_in = _A_setup()

    def _B_setup():
        B, S, D, F = (1, 2048, 448, 1792)
        Fh = F // 2
        return {'x': _w((lambda *s: torch.randn(*s, dtype=torch.bfloat16) * 0.05)(B, S, D)), 'w_in': _w((lambda *s: torch.randn(*s, dtype=torch.bfloat16) * 0.4)(D, 2 * Fh)), 'w_sp': _w(0.01 * (lambda *s: torch.randn(*s, dtype=torch.bfloat16) * 0.4)(S, S)), 'b_sp': _w(1.0 + 0.01 * (lambda *s: torch.randn(*s, dtype=torch.bfloat16) * 0.05)(S)), 'w_out': _w((lambda *s: torch.randn(*s, dtype=torch.bfloat16) * 0.05)(Fh, D))}
    _B_in = _B_setup()
    return {'A_x': _A_in['x'], 'A_wqkv': _A_in['wqkv'], 'A_w_phi': _A_in['w_phi'], 'A_wo': _A_in['wo'], 'B_x': _B_in['x'], 'B_w_in': _B_in['w_in'], 'B_w_sp': _B_in['w_sp'], 'B_b_sp': _B_in['b_sp'], 'B_w_out': _B_in['w_out'], 'gate_w': _w((lambda *s: torch.randn(*s, dtype=torch.bfloat16) * 0.05)(448) * 16.0)}

def reference(A_x, A_wqkv, A_w_phi, A_wo, B_x, B_w_in, B_w_sp, B_b_sp, B_w_out, gate_w):

    def _A_ref(x, wqkv, w_phi, wo):
        B, S, D = x.shape
        H = 16
        Dh = D // H
        qkv = (lambda x, *d: x.permute(*d))((x @ wqkv).reshape(B, S, 3, H, Dh), 2, 0, 3, 1, 4)
        q, k, v = (qkv[0], qkv[1], qkv[2])
        pq = torch.einsum('bhsd,hdf->bhsf', q, w_phi)
        pk = torch.einsum('bhsd,hdf->bhsf', k, w_phi)
        phi_q = torch.concatenate([_softmax(pq, axis=-1), _softmax(-pq, axis=-1)], axis=-1)
        phi_k = torch.concatenate([_softmax(pk, axis=-1), _softmax(-pk, axis=-1)], axis=-1)
        kv = torch.einsum('bhsf,bhsd->bhfd', phi_k, v)
        z = torch.einsum('bhsf->bhf', phi_k)
        num = torch.einsum('bhqf,bhfd->bhqd', phi_q, kv)
        den = torch.einsum('bhqf,bhf->bhq', phi_q, z)[..., None] + 1e-06
        o = num / den
        return (lambda x, *d: x.permute(*d))(o, 0, 2, 1, 3).reshape(B, S, D) @ wo

    def _B_ref(x, w_in, w_sp, b_sp, w_out):
        B, S, D = x.shape
        F = w_in.shape[-1]
        Fh = F // 2
        z = _gelu(torch.einsum('bsd,df->bsf', x, w_in))
        z1 = z[..., :Fh].clone()
        z2 = _layernorm(z[..., Fh:], axis=-1)
        g = torch.einsum('ts,bsf->btf', w_sp, z2) + b_sp[None, :, None]
        return torch.einsum('bsf,fd->bsd', z1 * g, w_out)
    x = A_x
    g = _sigmoid((x * gate_w).sum(-1, keepdims=True))
    a = _A_ref(x, A_wqkv, A_w_phi, A_wo)
    b = _B_ref(x, B_w_in, B_w_sp, B_b_sp, B_w_out)
    return g * a + (1 - g) * b
```

```asm
; @launch grid=(256,1,1) block=(256,1,1) lds=163840
.amdgcn_target "amdgcn-amd-amdhsa--gfx950"
.text
.globl gated_mix__linear_kernel_hedgehog__mixer_gmlp__prompt_kernel
.p2align 8
.type gated_mix__linear_kernel_hedgehog__mixer_gmlp__prompt_kernel,@function
gated_mix__linear_kernel_hedgehog__mixer_gmlp__prompt_kernel:
  s_load_dwordx2 s[4:5], s[0:1], 0
  s_load_dwordx2 s[12:13], s[0:1], 40
  s_load_dwordx2 s[8:9], s[0:1], 8
  s_load_dwordx2 s[16:17], s[0:1], 96
  s_lshr_b32 s50, s2, 5
  v_lshrrev_b32 v1, 6, v0
  s_cmp_gt_u32 s50, 7
  s_cbranch_scc1 Lexit
  s_getpc_b64 s[100:101]
Lpc1:
  s_sub_u32 s100, s100, Lpc1-gated_mix__linear_kernel_hedgehog__mixer_gmlp__prompt_kernel
  s_subb_u32 s101, s101, 0
  s_lshr_b32 s3, s2, 3
  v_lshl_add_u32 v2, s3, 2, v1
  v_and_b32 v3, 3, v0
  v_mad_u32_u24 v2, v2, 3, v3
  v_lshlrev_b32 v2, 7, v2
  v_min_u32 v2, Lexit-gated_mix__linear_kernel_hedgehog__mixer_gmlp__prompt_kernel, v2
  s_mov_b64 exec, 7
  global_load_dword v79, v2, s[100:101]
  s_mov_b64 exec, -1
  v_readfirstlane_b32 s51, v1
  s_and_b32 s49, s2, 1
  s_lshr_b32 s63, s2, 3
  s_and_b32 s63, s63, 3
  s_and_b32 s62, s2, 6
  s_lshl1_add_u32 s48, s62, s63
  s_lshl1_add_u32 s52, s50, s49
  v_and_b32 v0, 63, v0
  s_mov_b32 s6, 1835008
  s_mov_b32 s7, 0x20000
  s_lshl_b32 s58, s51, 14
  s_lshl_b32 s59, s51, 11
  s_lshl1_add_u32 s61, s63, s50
  s_sub_u32 s63, s61, 7
  s_min_u32 s61, s61, s63
  s_lshl_b32 s74, s61, 7
  s_cmp_eq_u32 s50, 7
  s_cbranch_scc1 Lhelper
  s_lshl2_add_u32 s62, s48, s51
  s_mul_i32 s62, s62, 28672
  v_lshrrev_b32 v1, 3, v0
  v_mul_u32_u24 v1, 896, v1
  v_add_u32 v1, s62, v1
  v_lshrrev_b32 v2, 4, v0
  v_xor_b32 v2, v0, v2
  v_and_b32 v2, 7, v2
  v_lshl_add_u32 v8, v2, 4, v1
  v_xor_b32 v2, 64, v8
  v_add_u32 v9, 6144, v2
  v_add_u32 v10, 12288, v8
  v_add_u32 v11, 18432, v2
  s_waitcnt lgkmcnt(0)
  s_add_u32 m0, s58, 0
  s_nop 0
  buffer_load_dwordx4 v8, s[4:7], s74 offen offset:0 lds
  buffer_load_dwordx4 v9, s[4:7], s74 offen offset:1024 lds
  buffer_load_dwordx4 v10, s[4:7], s74 offen offset:2048 lds
  buffer_load_dwordx4 v11, s[4:7], s74 offen offset:3072 lds
  s_mov_b32 s14, 1605632
  s_mov_b32 s15, s7
  s_lshl_b32 s65, s52, 7
  s_mul_i32 s62, s51, 57344
  s_add_u32 s62, s62, s65
  v_lshrrev_b32 v1, 3, v0
  v_mul_u32_u24 v1, 3584, v1
  v_add_u32 v1, s62, v1
  v_lshrrev_b32 v2, 2, v0
  v_and_b32 v2, 4, v2
  v_xor_b32 v2, v0, v2
  v_and_b32 v2, 7, v2
  v_lshl_add_u32 v16, v2, 4, v1
  v_add_u32 v17, 27648, v16
  s_mul_i32 s81, s74, 1792
  s_add_u32 m0, s59, 63744
  s_nop 0
  buffer_load_dwordx4 v16, s[12:15], s81 offen offset:1792 lds
  buffer_load_dwordx4 v17, s[12:15], s81 offen offset:2816 lds
  s_add_u32 s61, s61, 1
  s_sub_u32 s63, s61, 7
  s_min_u32 s61, s61, s63
  s_lshl_b32 s75, s61, 7
  s_mul_i32 s82, s75, 1792
  s_mov_b32 s18, 27262976
  s_mov_b32 s19, s7
  s_add_u32 m0, s59, 71936
  s_nop 0
  buffer_load_dwordx4 v16, s[12:15], s82 offen offset:1792 lds
  buffer_load_dwordx4 v17, s[12:15], s82 offen offset:2816 lds
  v_mov_b32 v47, 0
  buffer_load_dword v47, v47, s[16:19], 0 offen sc1
  s_load_dwordx2 s[20:21], s[0:1], 48
  s_load_dwordx2 s[36:37], s[0:1], 16
  s_load_dwordx2 s[44:45], s[0:1], 72
  s_load_dwordx2 s[40:41], s[0:1], 56
  s_load_dwordx2 s[24:25], s[0:1], 24
  s_load_dwordx2 s[28:29], s[0:1], 64
  s_load_dwordx2 s[32:33], s[0:1], 80
  s_add_u32 s61, s61, 1
  s_sub_u32 s63, s61, 7
  s_min_u32 s61, s61, s63
  s_lshl_b32 s76, s61, 7
  s_mul_i32 s83, s76, 1792
  s_add_u32 s61, s61, 1
  s_sub_u32 s63, s61, 7
  s_min_u32 s61, s61, s63
  s_lshl_b32 s77, s61, 7
  s_mul_i32 s84, s77, 1792
  s_add_u32 s61, s61, 1
  s_sub_u32 s63, s61, 7
  s_min_u32 s61, s61, s63
  s_lshl_b32 s78, s61, 7
  s_mul_i32 s85, s78, 1792
  s_add_u32 s61, s61, 1
  s_sub_u32 s63, s61, 7
  s_min_u32 s61, s61, s63
  s_lshl_b32 s79, s61, 7
  s_mul_i32 s86, s79, 1792
  s_add_u32 s61, s61, 1
  s_sub_u32 s63, s61, 7
  s_min_u32 s61, s61, s63
  s_lshl_b32 s80, s61, 7
  s_mul_i32 s87, s80, 1792
  v_and_b32 v1, 31, v0
  v_lshlrev_b32 v1, 7, v1
  v_add_u32 v1, s58, v1
  v_bfe_u32 v2, v0, 1, 3
  v_lshrrev_b32 v20, 5, v0
  v_xor_b32 v2, v2, v20
  v_lshl_add_u32 v20, v2, 4, v1
  v_xor_b32 v21, 32, v20
  v_xor_b32 v22, 64, v20
  v_xor_b32 v23, 96, v20
  v_bfe_u32 v3, v0, 2, 2
  v_and_b32 v4, 3, v0
  v_lshlrev_b32 v4, 3, v4
  v_and_b32 v5, 16, v0
  v_lshl_add_u32 v4, v5, 1, v4
  v_lshrrev_b32 v5, 5, v0
  v_lshl_add_u32 v1, v5, 3, v3
  v_lshl_add_u32 v24, v1, 7, v4
  v_and_b32 v1, 2, v3
  v_lshl_add_u32 v24, v1, 5, v24
  v_add_u32 v24, 65536, v24
  v_xor_b32 v25, 64, v24
  s_waitcnt lgkmcnt(0)
  s_mov_b32 s18, 27262976
  s_mov_b32 s19, s7
  s_mov_b32 s22, 8388608
  s_mov_b32 s23, s7
  s_mov_b32 s38, 25088
  s_mov_b32 s39, s7
  s_mov_b32 s46, 896
  s_mov_b32 s47, s7
  s_mov_b32 s42, 4096
  s_mov_b32 s43, s7
  s_mov_b32 s26, 401408
  s_mov_b32 s27, s7
  s_mov_b32 s30, 802816
  s_mov_b32 s31, s7
  s_mov_b32 s34, 1835008
  s_mov_b32 s35, s7
  s_lshl3_add_u32 s53, s49, s50
  s_lshl_b32 s60, s51, 12
  s_mov_b32 s70, 0x3fb8aa3b
  s_lshl2_add_u32 s62, s48, s51
  s_mul_i32 s62, s62, 131072
  v_lshrrev_b32 v1, 3, v0
  v_mul_u32_u24 v1, 4096, v1
  v_add_u32 v1, s62, v1
  v_lshrrev_b32 v2, 4, v0
  v_xor_b32 v2, v0, v2
  v_and_b32 v2, 7, v2
  v_lshl_add_u32 v12, v2, 4, v1
  v_xor_b32 v2, 64, v12
  v_add_u32 v13, 31744, v2
  v_add_u32 v14, 63488, v12
  v_add_u32 v15, 95232, v2
  s_lshl_b32 s62, s49, 11
  v_add_u32 v12, s62, v12
  v_add_u32 v13, s62, v13
  v_add_u32 v14, s62, v14
  v_add_u32 v15, s62, v15
  s_bitcmp1_b32 s48, 0
  s_mov_b32 s62, 1985160208
  s_mov_b32 s63, 1967534338
  s_cselect_b32 s62, 1984123393, s62
  s_cselect_b32 s63, 1702109488, s63
  s_bitcmp1_b32 s48, 1
  s_cselect_b32 s62, s63, s62
  s_mul_i32 s63, s50, 0x11111111
  s_add_u32 s62, s62, s63
  s_and_b32 s66, s62, 0x77777777
  v_lshlrev_b32 v28, 4, v0
  v_mov_b32 v60, 0xc0135761
  v_mov_b32 v61, 0xbdd2d3e8
  s_lshl2_add_u32 s62, s48, s51
  s_mul_i32 s62, s62, 7168
  s_add_u32 s98, s62, 262144
  s_add_u32 s99, s98, 4096
  s_lshl_b32 s62, s52, 9
  v_add_u32 v1, s62, v28
  v_lshlrev_b32 v2, 30, v5
  v_add_u32 v50, v1, v2
  v_bfe_u32 v1, v0, 2, 2
  v_and_b32 v2, 1, v0
  v_lshl_add_u32 v1, v1, 1, v2
  v_cmp_eq_u32 vcc, 7, v1
  v_bfe_u32 v2, v0, 1, 1
  v_mad_u32_u24 v1, v2, 7, v1
  v_lshrrev_b32 v2, 4, v0
  v_mad_u32_u24 v1, v2, 14, v1
  v_lshlrev_b32 v1, 2, v1
  v_mov_b32 v2, 1073741824
  v_cndmask_b32 v45, v1, v2, vcc
  s_cmp_eq_u32 s51, 3
  s_cselect_b32 s64, 1073741824, 0
  v_or_b32 v46, s64, v45
  s_mul_i32 s62, s53, 86016
  s_add_u32 s62, s62, 25165824
  s_lshl_b32 s67, s51, 10
  s_add_u32 s62, s62, s67
  v_add_u32 v18, s62, v28
  s_add_u32 s62, s67, 28672
  v_add_u32 v19, s62, v18
  s_lshl_b32 s88, s74, 6
  s_lshl_b32 s89, s75, 6
  s_lshl_b32 s90, s76, 6
  s_lshl_b32 s91, s77, 6
  s_lshl_b32 s92, s78, 6
  s_lshl_b32 s93, s79, 6
  s_lshl_b32 s94, s80, 6
  v_and_b32 v1, 15, v0
  v_lshlrev_b32 v1, 7, v1
  v_add_u32 v1, s58, v1
  v_bfe_u32 v2, v0, 1, 3
  v_lshrrev_b32 v39, 4, v0
  v_xor_b32 v2, v2, v39
  v_lshl_add_u32 v39, v2, 4, v1
  v_xor_b32 v40, 64, v39
  s_add_u32 m0, s58, 4096
  s_bfe_u32 s61, s66, 196608
  buffer_load_dwordx4 v8, s[4:7], s75 offen offset:0 lds
  s_lshl_b32 s61, s61, 8
  s_mul_i32 s65, s53, 1568
  s_mul_i32 s63, s51, 448
  s_add_u32 s63, s63, s65
  s_lshl_b32 s64, s51, 9
  s_lshl2_add_u32 s62, s48, s51
  s_lshl_b32 s62, s62, 6
  v_and_b32 v48, 31, v0
  v_lshlrev_b32 v48, 1, v48
  v_min_u32 v1, 6, v0
  buffer_load_dwordx4 v9, s[4:7], s75 offen offset:1024 lds
  buffer_load_dwordx4 v10, s[4:7], s75 offen offset:2048 lds
  buffer_load_dwordx4 v11, s[4:7], s75 offen offset:3072 lds
  s_add_u32 m0, s58, 8192
  s_nop 0
  buffer_load_dwordx4 v8, s[4:7], s76 offen offset:0 lds
  s_waitcnt vmcnt(10)
  ds_read_b128 a[0:3], v20 offset:0
  ds_read_b128 a[4:7], v21 offset:0
  ds_read_b128 a[8:11], v22 offset:0
  ds_read_b128 a[12:15], v23 offset:0
  buffer_load_dwordx4 v9, s[4:7], s76 offen offset:1024 lds
  buffer_load_dwordx4 v10, s[4:7], s76 offen offset:2048 lds
  s_waitcnt vmcnt(10)
  s_barrier
  ds_read_b64_tr_b16 a[112:113], v24 offset:0
  ds_read_b64_tr_b16 a[114:115], v24 offset:512
  ds_read_b64_tr_b16 a[116:117], v25 offset:0
  ds_read_b64_tr_b16 a[118:119], v25 offset:512
  ds_read_b64_tr_b16 a[120:121], v24 offset:2048
  ds_read_b64_tr_b16 a[122:123], v24 offset:2560
  ds_read_b64_tr_b16 a[124:125], v25 offset:2048
  ds_read_b64_tr_b16 a[126:127], v25 offset:2560
  ds_read_b64_tr_b16 a[128:129], v24 offset:4096
  ds_read_b64_tr_b16 a[130:131], v24 offset:4608
  ds_read_b64_tr_b16 a[132:133], v25 offset:4096
  ds_read_b64_tr_b16 a[134:135], v25 offset:4608
  ds_read_b64_tr_b16 a[136:137], v24 offset:6144
  ds_read_b64_tr_b16 a[138:139], v24 offset:6656
  ds_read_b64_tr_b16 a[140:141], v25 offset:6144
  ds_read_b64_tr_b16 a[142:143], v25 offset:6656
  s_waitcnt lgkmcnt(14)
  v_mfma_f32_32x32x16_bf16 v[112:127], a[112:115], a[0:3], 0
  s_waitcnt lgkmcnt(12)
  v_mfma_f32_32x32x16_bf16 v[128:143], a[116:119], a[0:3], 0
  s_waitcnt lgkmcnt(7)
  v_mfma_f32_32x32x16_bf16 v[112:127], a[120:123], a[4:7], v[112:127]
  v_mfma_f32_32x32x16_bf16 v[128:143], a[124:127], a[4:7], v[128:143]
  buffer_load_dwordx4 v11, s[4:7], s76 offen offset:3072 lds
  s_add_u32 m0, s59, 80128
  s_waitcnt lgkmcnt(0)
  v_mfma_f32_32x32x16_bf16 v[112:127], a[128:131], a[8:11], v[112:127]
  v_mfma_f32_32x32x16_bf16 v[128:143], a[132:135], a[8:11], v[128:143]
  v_mfma_f32_32x32x16_bf16 v[112:127], a[136:139], a[12:15], v[112:127]
  v_mfma_f32_32x32x16_bf16 v[128:143], a[140:143], a[12:15], v[128:143]
  buffer_load_dwordx4 v16, s[12:15], s83 offen offset:1792 lds
  s_waitcnt vmcnt(10)
  s_barrier
  ds_read_b64_tr_b16 a[112:113], v24 offset:8192
  ds_read_b64_tr_b16 a[114:115], v24 offset:8704
  ds_read_b64_tr_b16 a[116:117], v25 offset:8192
  ds_read_b64_tr_b16 a[118:119], v25 offset:8704
  ds_read_b64_tr_b16 a[120:121], v24 offset:10240
  ds_read_b64_tr_b16 a[122:123], v24 offset:10752
  ds_read_b64_tr_b16 a[124:125], v25 offset:10240
  ds_read_b64_tr_b16 a[126:127], v25 offset:10752
  ds_read_b64_tr_b16 a[128:129], v24 offset:12288
  buffer_load_dwordx4 v17, s[12:15], s83 offen offset:2816 lds
  s_add_u32 m0, s58, 12288
  ds_read_b64_tr_b16 a[130:131], v24 offset:12800
  ds_read_b64_tr_b16 a[132:133], v25 offset:12288
  ds_read_b64_tr_b16 a[134:135], v25 offset:12800
  s_waitcnt vmcnt(10)
  v_readfirstlane_b32 s54, v47
  ds_read_b64_tr_b16 a[136:137], v24 offset:14336
  ds_read_b64_tr_b16 a[138:139], v24 offset:14848
  s_add_u32 s54, s54, 2654435769
  ds_read_b64_tr_b16 a[140:141], v25 offset:14336
  s_lshr_b32 s55, s54, 8
  ds_read_b64_tr_b16 a[142:143], v25 offset:14848
  s_lshr_b32 s56, s54, 16
  s_lshr_b32 s57, s54, 24
  v_mov_b32 v53, s54
  buffer_load_dwordx4 v8, s[4:7], s77 offen offset:0 lds
  v_mov_b32 v74, s54
  v_mov_b32 v75, s54
  buffer_load_dwordx4 v9, s[4:7], s77 offen offset:1024 lds
  buffer_load_dwordx4 v10, s[4:7], s77 offen offset:2048 lds
  buffer_load_dwordx4 v11, s[4:7], s77 offen offset:3072 lds
  s_add_u32 m0, s59, 88320
  s_waitcnt vmcnt(10)
  ds_read_b128 a[16:19], v20 offset:4096
  ds_read_b128 a[20:23], v21 offset:4096
  ds_read_b128 a[24:27], v22 offset:4096
  ds_read_b128 a[28:31], v23 offset:4096
  buffer_load_dwordx4 v16, s[12:15], s84 offen offset:1792 lds
  s_waitcnt lgkmcnt(3)
  v_mfma_f32_32x32x16_bf16 v[112:127], a[112:115], a[16:19], v[112:127]
  v_mfma_f32_32x32x16_bf16 v[128:143], a[116:119], a[16:19], v[128:143]
  buffer_load_dwordx4 v17, s[12:15], s84 offen offset:2816 lds
  s_add_u32 m0, s58, 0
  s_waitcnt lgkmcnt(0)
  v_mfma_f32_32x32x16_bf16 v[112:127], a[120:123], a[20:23], v[112:127]
  v_mfma_f32_32x32x16_bf16 v[128:143], a[124:127], a[20:23], v[128:143]
  buffer_load_dwordx4 v8, s[4:7], s78 offen offset:0 lds
  v_mfma_f32_32x32x16_bf16 v[112:127], a[128:131], a[24:27], v[112:127]
  v_mfma_f32_32x32x16_bf16 v[128:143], a[132:135], a[24:27], v[128:143]
  buffer_load_dwordx4 v9, s[4:7], s78 offen offset:1024 lds
  s_waitcnt vmcnt(10)
  ds_read_b128 a[32:35], v20 offset:8192
  v_mfma_f32_32x32x16_bf16 v[112:127], a[136:139], a[28:31], v[112:127]
  ds_read_b128 a[36:39], v21 offset:8192
  ds_read_b128 a[40:43], v22 offset:8192
  ds_read_b128 a[44:47], v23 offset:8192
  v_mfma_f32_32x32x16_bf16 v[128:143], a[140:143], a[28:31], v[128:143]
  buffer_load_dwordx4 v10, s[4:7], s78 offen offset:2048 lds
  buffer_load_dwordx4 v11, s[4:7], s78 offen offset:3072 lds
  s_add_u32 m0, s59, 96512
  s_waitcnt vmcnt(10)
  s_barrier
  ds_read_b64_tr_b16 a[112:113], v24 offset:16384
  ds_read_b64_tr_b16 a[114:115], v24 offset:16896
  ds_read_b64_tr_b16 a[116:117], v25 offset:16384
  ds_read_b64_tr_b16 a[118:119], v25 offset:16896
  ds_read_b64_tr_b16 a[120:121], v24 offset:18432
  ds_read_b64_tr_b16 a[122:123], v24 offset:18944
  ds_read_b64_tr_b16 a[124:125], v25 offset:18432
  ds_read_b64_tr_b16 a[126:127], v25 offset:18944
  ds_read_b64_tr_b16 a[128:129], v24 offset:20480
  ds_read_b64_tr_b16 a[130:131], v24 offset:20992
  ds_read_b64_tr_b16 a[132:133], v25 offset:20480
  ds_read_b64_tr_b16 a[134:135], v25 offset:20992
  ds_read_b64_tr_b16 a[136:137], v24 offset:22528
  ds_read_b64_tr_b16 a[138:139], v24 offset:23040
  buffer_load_dwordx4 v16, s[12:15], s85 offen offset:1792 lds
  ds_read_b64_tr_b16 a[140:141], v25 offset:22528
  ds_read_b64_tr_b16 a[142:143], v25 offset:23040
  s_waitcnt lgkmcnt(14)
  v_mfma_f32_32x32x16_bf16 v[112:127], a[112:115], a[32:35], v[112:127]
  s_waitcnt lgkmcnt(12)
  v_mfma_f32_32x32x16_bf16 v[128:143], a[116:119], a[32:35], v[128:143]
  buffer_load_dwordx4 v17, s[12:15], s85 offen offset:2816 lds
  s_add_u32 m0, s58, 4096
  s_waitcnt lgkmcnt(4)
  v_mfma_f32_32x32x16_bf16 v[112:127], a[120:123], a[36:39], v[112:127]
  v_mfma_f32_32x32x16_bf16 v[128:143], a[124:127], a[36:39], v[128:143]
  buffer_load_dwordx4 v8, s[4:7], s79 offen offset:0 lds
  v_mfma_f32_32x32x16_bf16 v[112:127], a[128:131], a[40:43], v[112:127]
  v_mfma_f32_32x32x16_bf16 v[128:143], a[132:135], a[40:43], v[128:143]
  buffer_load_dwordx4 v9, s[4:7], s79 offen offset:1024 lds
  s_waitcnt vmcnt(10)
  ds_read_b128 a[48:51], v20 offset:12288
  s_waitcnt lgkmcnt(1)
  v_mfma_f32_32x32x16_bf16 v[112:127], a[136:139], a[44:47], v[112:127]
  ds_read_b128 a[52:55], v21 offset:12288
  ds_read_b128 a[56:59], v22 offset:12288
  ds_read_b128 a[60:63], v23 offset:12288
  v_mfma_f32_32x32x16_bf16 v[128:143], a[140:143], a[44:47], v[128:143]
  buffer_load_dwordx4 v10, s[4:7], s79 offen offset:2048 lds
  buffer_load_dwordx4 v11, s[4:7], s79 offen offset:3072 lds
  s_add_u32 m0, s59, 104704
  s_waitcnt vmcnt(10)
  s_barrier
  ds_read_b64_tr_b16 a[112:113], v24 offset:24576
  ds_read_b64_tr_b16 a[114:115], v24 offset:25088
  ds_read_b64_tr_b16 a[116:117], v25 offset:24576
  ds_read_b64_tr_b16 a[118:119], v25 offset:25088
  ds_read_b64_tr_b16 a[120:121], v24 offset:26624
  ds_read_b64_tr_b16 a[122:123], v24 offset:27136
  ds_read_b64_tr_b16 a[124:125], v25 offset:26624
  ds_read_b64_tr_b16 a[126:127], v25 offset:27136
  ds_read_b64_tr_b16 a[128:129], v24 offset:28672
  ds_read_b64_tr_b16 a[130:131], v24 offset:29184
  ds_read_b64_tr_b16 a[132:133], v25 offset:28672
  buffer_load_dwordx4 v16, s[12:15], s86 offen offset:1792 lds
  ds_read_b64_tr_b16 a[134:135], v25 offset:29184
  ds_read_b64_tr_b16 a[136:137], v24 offset:30720
  ds_read_b64_tr_b16 a[138:139], v24 offset:31232
  ds_read_b64_tr_b16 a[140:141], v25 offset:30720
  ds_read_b64_tr_b16 a[142:143], v25 offset:31232
  s_waitcnt lgkmcnt(14)
  v_mfma_f32_32x32x16_bf16 v[112:127], a[112:115], a[48:51], v[112:127]
  buffer_load_dwordx4 v17, s[12:15], s86 offen offset:2816 lds
  s_add_u32 m0, s58, 8192
  s_waitcnt lgkmcnt(10)
  v_mfma_f32_32x32x16_bf16 v[128:143], a[116:119], a[48:51], v[128:143]
  v_mfma_f32_32x32x16_bf16 v[112:127], a[120:123], a[52:55], v[112:127]
  buffer_load_dwordx4 v8, s[4:7], s80 offen offset:0 lds
  s_waitcnt lgkmcnt(0)
  v_mfma_f32_32x32x16_bf16 v[128:143], a[124:127], a[52:55], v[128:143]
  v_mfma_f32_32x32x16_bf16 v[112:127], a[128:131], a[56:59], v[112:127]
  buffer_load_dwordx4 v9, s[4:7], s80 offen offset:1024 lds
  s_waitcnt vmcnt(10)
  ds_read_b128 a[64:67], v20 offset:0
  v_mfma_f32_32x32x16_bf16 v[128:143], a[132:135], a[56:59], v[128:143]
  ds_read_b128 a[68:71], v21 offset:0
  ds_read_b128 a[72:75], v22 offset:0
  ds_read_b128 a[76:79], v23 offset:0
  v_mfma_f32_32x32x16_bf16 v[112:127], a[136:139], a[60:63], v[112:127]
  v_mfma_f32_32x32x16_bf16 v[128:143], a[140:143], a[60:63], v[128:143]
  buffer_load_dwordx4 v10, s[4:7], s80 offen offset:2048 lds
  buffer_load_dwordx4 v11, s[4:7], s80 offen offset:3072 lds
  s_add_u32 m0, s59, 112896
  s_waitcnt vmcnt(10)
  s_barrier
  ds_read_b64_tr_b16 a[112:113], v24 offset:32768
  ds_read_b64_tr_b16 a[114:115], v24 offset:33280
  ds_read_b64_tr_b16 a[116:117], v25 offset:32768
  ds_read_b64_tr_b16 a[118:119], v25 offset:33280
  ds_read_b64_tr_b16 a[120:121], v24 offset:34816
  ds_read_b64_tr_b16 a[122:123], v24 offset:35328
  ds_read_b64_tr_b16 a[124:125], v25 offset:34816
  ds_read_b64_tr_b16 a[126:127], v25 offset:35328
  ds_read_b64_tr_b16 a[128:129], v24 offset:36864
  ds_read_b64_tr_b16 a[130:131], v24 offset:37376
  ds_read_b64_tr_b16 a[132:133], v25 offset:36864
  buffer_load_dwordx4 v16, s[12:15], s87 offen offset:1792 lds
  ds_read_b64_tr_b16 a[134:135], v25 offset:37376
  ds_read_b64_tr_b16 a[136:137], v24 offset:38912
  ds_read_b64_tr_b16 a[138:139], v24 offset:39424
  ds_read_b64_tr_b16 a[140:141], v25 offset:38912
  ds_read_b64_tr_b16 a[142:143], v25 offset:39424
  s_waitcnt lgkmcnt(14)
  v_mfma_f32_32x32x16_bf16 v[112:127], a[112:115], a[64:67], v[112:127]
  buffer_load_dwordx4 v17, s[12:15], s87 offen offset:2816 lds
  s_add_u32 m0, s59, 122880
  s_waitcnt lgkmcnt(10)
  v_mfma_f32_32x32x16_bf16 v[128:143], a[116:119], a[64:67], v[128:143]
  v_mfma_f32_32x32x16_bf16 v[112:127], a[120:123], a[68:71], v[112:127]
  buffer_load_dwordx4 v16, s[12:15], s81 offen offset:0 lds
  s_waitcnt lgkmcnt(0)
  v_mfma_f32_32x32x16_bf16 v[128:143], a[124:127], a[68:71], v[128:143]
  v_mfma_f32_32x32x16_bf16 v[112:127], a[128:131], a[72:75], v[112:127]
  v_mfma_f32_32x32x16_bf16 v[128:143], a[132:135], a[72:75], v[128:143]
  buffer_load_dwordx4 v17, s[12:15], s81 offen offset:1024 lds
  s_add_u32 m0, s59, 65536
  s_waitcnt vmcnt(10)
  ds_read_b128 a[80:83], v20 offset:4096
  v_mfma_f32_32x32x16_bf16 v[112:127], a[136:139], a[76:79], v[112:127]
  ds_read_b128 a[84:87], v21 offset:4096
  ds_read_b128 a[88:91], v22 offset:4096
  ds_read_b128 a[92:95], v23 offset:4096
  v_mfma_f32_32x32x16_bf16 v[128:143], a[140:143], a[76:79], v[128:143]
  buffer_load_dwordx4 v16, s[12:15], s82 offen offset:0 lds
  buffer_load_dwordx4 v17, s[12:15], s82 offen offset:1024 lds
  s_add_u32 m0, s58, 12288
  s_waitcnt vmcnt(10)
  s_barrier
  ds_read_b64_tr_b16 a[112:113], v24 offset:40960
  ds_read_b64_tr_b16 a[114:115], v24 offset:41472
  ds_read_b64_tr_b16 a[116:117], v25 offset:40960
  ds_read_b64_tr_b16 a[118:119], v25 offset:41472
  ds_read_b64_tr_b16 a[120:121], v24 offset:43008
  ds_read_b64_tr_b16 a[122:123], v24 offset:43520
  ds_read_b64_tr_b16 a[124:125], v25 offset:43008
  ds_read_b64_tr_b16 a[126:127], v25 offset:43520
  ds_read_b64_tr_b16 a[128:129], v24 offset:45056
  ds_read_b64_tr_b16 a[130:131], v24 offset:45568
  ds_read_b64_tr_b16 a[132:133], v25 offset:45056
  buffer_load_dwordx4 v12, s[20:23], s61 offen offset:0 lds
  ds_read_b64_tr_b16 a[134:135], v25 offset:45568
  ds_read_b64_tr_b16 a[136:137], v24 offset:47104
  ds_read_b64_tr_b16 a[138:139], v24 offset:47616
  ds_read_b64_tr_b16 a[140:141], v25 offset:47104
  ds_read_b64_tr_b16 a[142:143], v25 offset:47616
  s_waitcnt lgkmcnt(14)
  v_mfma_f32_32x32x16_bf16 v[112:127], a[112:115], a[80:83], v[112:127]
  buffer_load_dwordx4 v13, s[20:23], s61 offen offset:1024 lds
  s_waitcnt lgkmcnt(11)
  v_mfma_f32_32x32x16_bf16 v[128:143], a[116:119], a[80:83], v[128:143]
  s_waitcnt lgkmcnt(7)
  v_mfma_f32_32x32x16_bf16 v[112:127], a[120:123], a[84:87], v[112:127]
  v_mfma_f32_32x32x16_bf16 v[128:143], a[124:127], a[84:87], v[128:143]
  buffer_load_dwordx4 v14, s[20:23], s61 offen offset:2048 lds
  s_waitcnt lgkmcnt(0)
  v_mfma_f32_32x32x16_bf16 v[112:127], a[128:131], a[88:91], v[112:127]
  v_mfma_f32_32x32x16_bf16 v[128:143], a[132:135], a[88:91], v[128:143]
  buffer_load_dwordx4 v15, s[20:23], s61 offen offset:3072 lds
  s_add_u32 m0, s64, 155648
  s_waitcnt vmcnt(10)
  ds_read_b128 a[96:99], v20 offset:8192
  v_mfma_f32_32x32x16_bf16 v[112:127], a[136:139], a[92:95], v[112:127]
  ds_read_b128 a[100:103], v21 offset:8192
  ds_read_b128 a[104:107], v22 offset:8192
  ds_read_b128 a[108:111], v23 offset:8192
  v_mfma_f32_32x32x16_bf16 v[128:143], a[140:143], a[92:95], v[128:143]
  buffer_load_dword v45, s[36:39], s63 offen lds
  s_add_u32 m0, s64, 155680
  s_nop 0
  buffer_load_dword v46, s[36:39], s63 offen offset:224 lds
  s_add_u32 m0, s59, 73728
  s_waitcnt vmcnt(10)
  s_barrier
  ds_read_b64_tr_b16 a[112:113], v24 offset:49152
  ds_read_b64_tr_b16 a[114:115], v24 offset:49664
  ds_read_b64_tr_b16 a[116:117], v25 offset:49152
  ds_read_b64_tr_b16 a[118:119], v25 offset:49664
  ds_read_b64_tr_b16 a[120:121], v24 offset:51200
  ds_read_b64_tr_b16 a[122:123], v24 offset:51712
  ds_read_b64_tr_b16 a[124:125], v25 offset:51200
  ds_read_b64_tr_b16 a[126:127], v25 offset:51712
  ds_read_b64_tr_b16 a[128:129], v24 offset:53248
  ds_read_b64_tr_b16 a[130:131], v24 offset:53760
  ds_read_b64_tr_b16 a[132:133], v25 offset:53248
  ds_read_b64_tr_b16 a[134:135], v25 offset:53760
  ds_read_b64_tr_b16 a[136:137], v24 offset:55296
  ds_read_b64_tr_b16 a[138:139], v24 offset:55808
  ds_read_b64_tr_b16 a[140:141], v25 offset:55296
  ds_read_b64_tr_b16 a[142:143], v25 offset:55808
  s_waitcnt lgkmcnt(14)
  v_mfma_f32_32x32x16_bf16 v[112:127], a[112:115], a[96:99], v[112:127]
  s_waitcnt lgkmcnt(12)
  v_mfma_f32_32x32x16_bf16 v[128:143], a[116:119], a[96:99], v[128:143]
  s_waitcnt lgkmcnt(7)
  v_mfma_f32_32x32x16_bf16 v[112:127], a[120:123], a[100:103], v[112:127]
  v_mfma_f32_32x32x16_bf16 v[128:143], a[124:127], a[100:103], v[128:143]
  s_waitcnt lgkmcnt(0)
  v_mfma_f32_32x32x16_bf16 v[112:127], a[128:131], a[104:107], v[112:127]
  v_mfma_f32_32x32x16_bf16 v[128:143], a[132:135], a[104:107], v[128:143]
  v_mfma_f32_32x32x16_bf16 v[112:127], a[136:139], a[108:111], v[112:127]
  v_mfma_f32_32x32x16_bf16 v[128:143], a[140:143], a[108:111], v[128:143]
  buffer_load_ushort v48, v48, s[40:43], s62 offen
  s_mul_i32 s62, s51, 896
  s_add_u32 s62, s62, 98304
  s_mov_b32 s3, s62
  s_add_u32 s100, s16, s62
  s_addc_u32 s101, s17, 0
  buffer_load_dwordx4 v16, s[12:15], s83 offen offset:0 lds
  buffer_load_dwordx4 v17, s[12:15], s83 offen offset:1024 lds
  s_add_u32 m0, s59, 81920
  s_nop 0
  buffer_load_dwordx4 v16, s[12:15], s84 offen offset:0 lds
  buffer_load_dwordx4 v17, s[12:15], s84 offen offset:1024 lds
  s_barrier
  s_add_u32 m0, s59, 90112
  v_pk_mul_f32 v[64:65], v[112:113], v[112:113]
  v_pk_fma_f32 v[64:65], v[64:65], v[60:61], v[60:61] op_sel:[0,1,0] op_sel_hi:[1,1,0]
  v_pk_mul_f32 v[64:65], v[64:65], v[112:113]
  v_exp_f32 v64, v64
  v_exp_f32 v65, v65
  v_pk_mul_f32 v[66:67], v[114:115], v[114:115]
  v_pk_add_f32 v[64:65], v[64:65], 1.0 op_sel_hi:[1,0]
  v_rcp_f32 v64, v64
  v_rcp_f32 v65, v65
  v_pk_fma_f32 v[66:67], v[66:67], v[60:61], v[60:61] op_sel:[0,1,0] op_sel_hi:[1,1,0]
  v_pk_mul_f32 v[112:113], v[112:113], v[64:65]
  v_pk_mul_f32 v[62:63], v[112:113], v[112:113]
  v_pk_mul_f32 v[66:67], v[66:67], v[114:115]
  v_exp_f32 v66, v66
  v_exp_f32 v67, v67
  v_pk_mul_f32 v[68:69], v[116:117], v[116:117]
  v_pk_add_f32 v[66:67], v[66:67], 1.0 op_sel_hi:[1,0]
  v_rcp_f32 v66, v66
  v_rcp_f32 v67, v67
  v_pk_fma_f32 v[68:69], v[68:69], v[60:61], v[60:61] op_sel:[0,1,0] op_sel_hi:[1,1,0]
  v_pk_mul_f32 v[114:115], v[114:115], v[66:67]
  v_pk_add_f32 v[72:73], v[112:113], v[114:115]
  v_pk_fma_f32 v[62:63], v[114:115], v[114:115], v[62:63]
  v_pk_mul_f32 v[68:69], v[68:69], v[116:117]
  v_exp_f32 v68, v68
  v_exp_f32 v69, v69
  v_pk_mul_f32 v[70:71], v[118:119], v[118:119]
  v_pk_add_f32 v[68:69], v[68:69], 1.0 op_sel_hi:[1,0]
  v_rcp_f32 v68, v68
  v_rcp_f32 v69, v69
  v_pk_fma_f32 v[70:71], v[70:71], v[60:61], v[60:61] op_sel:[0,1,0] op_sel_hi:[1,1,0]
  v_pk_mul_f32 v[116:117], v[116:117], v[68:69]
  v_pk_add_f32 v[72:73], v[72:73], v[116:117]
  v_pk_fma_f32 v[62:63], v[116:117], v[116:117], v[62:63]
  v_pk_mul_f32 v[70:71], v[70:71], v[118:119]
  v_exp_f32 v70, v70
  v_exp_f32 v71, v71
  v_pk_mul_f32 v[64:65], v[120:121], v[120:121]
  v_pk_add_f32 v[70:71], v[70:71], 1.0 op_sel_hi:[1,0]
  v_rcp_f32 v70, v70
  v_rcp_f32 v71, v71
  v_pk_fma_f32 v[64:65], v[64:65], v[60:61], v[60:61] op_sel:[0,1,0] op_sel_hi:[1,1,0]
  v_pk_mul_f32 v[118:119], v[118:119], v[70:71]
  v_pk_add_f32 v[72:73], v[72:73], v[118:119]
  v_pk_fma_f32 v[62:63], v[118:119], v[118:119], v[62:63]
  v_pk_mul_f32 v[64:65], v[64:65], v[120:121]
  v_exp_f32 v64, v64
  v_exp_f32 v65, v65
  v_pk_mul_f32 v[66:67], v[122:123], v[122:123]
  v_pk_add_f32 v[64:65], v[64:65], 1.0 op_sel_hi:[1,0]
  v_rcp_f32 v64, v64
  v_rcp_f32 v65, v65
  v_pk_fma_f32 v[66:67], v[66:67], v[60:61], v[60:61] op_sel:[0,1,0] op_sel_hi:[1,1,0]
  v_pk_mul_f32 v[120:121], v[120:121], v[64:65]
  v_pk_add_f32 v[72:73], v[72:73], v[120:121]
  v_pk_fma_f32 v[62:63], v[120:121], v[120:121], v[62:63]
  v_pk_mul_f32 v[66:67], v[66:67], v[122:123]
  v_exp_f32 v66, v66
  v_exp_f32 v67, v67
  v_pk_mul_f32 v[68:69], v[124:125], v[124:125]
  v_pk_add_f32 v[66:67], v[66:67], 1.0 op_sel_hi:[1,0]
  v_rcp_f32 v66, v66
  v_rcp_f32 v67, v67
  v_pk_fma_f32 v[68:69], v[68:69], v[60:61], v[60:61] op_sel:[0,1,0] op_sel_hi:[1,1,0]
  v_pk_mul_f32 v[122:123], v[122:123], v[66:67]
  v_pk_add_f32 v[72:73], v[72:73], v[122:123]
  v_pk_fma_f32 v[62:63], v[122:123], v[122:123], v[62:63]
  v_pk_mul_f32 v[68:69], v[68:69], v[124:125]
  v_exp_f32 v68, v68
  v_exp_f32 v69, v69
  v_pk_mul_f32 v[70:71], v[126:127], v[126:127]
  v_pk_add_f32 v[68:69], v[68:69], 1.0 op_sel_hi:[1,0]
  v_rcp_f32 v68, v68
  v_rcp_f32 v69, v69
  v_pk_fma_f32 v[70:71], v[70:71], v[60:61], v[60:61] op_sel:[0,1,0] op_sel_hi:[1,1,0]
  v_pk_mul_f32 v[124:125], v[124:125], v[68:69]
  v_pk_add_f32 v[72:73], v[72:73], v[124:125]
  v_pk_fma_f32 v[62:63], v[124:125], v[124:125], v[62:63]
  v_pk_mul_f32 v[70:71], v[70:71], v[126:127]
  v_exp_f32 v70, v70
  v_exp_f32 v71, v71
  v_pk_mul_f32 v[64:65], v[128:129], v[128:129]
  v_pk_add_f32 v[70:71], v[70:71], 1.0 op_sel_hi:[1,0]
  v_rcp_f32 v70, v70
  v_rcp_f32 v71, v71
  v_pk_fma_f32 v[64:65], v[64:65], v[60:61], v[60:61] op_sel:[0,1,0] op_sel_hi:[1,1,0]
  v_pk_mul_f32 v[126:127], v[126:127], v[70:71]
  v_pk_add_f32 v[72:73], v[72:73], v[126:127]
  v_pk_fma_f32 v[62:63], v[126:127], v[126:127], v[62:63]
  v_pk_mul_f32 v[64:65], v[64:65], v[128:129]
  v_exp_f32 v64, v64
  v_exp_f32 v65, v65
  v_pk_mul_f32 v[66:67], v[130:131], v[130:131]
  v_pk_add_f32 v[64:65], v[64:65], 1.0 op_sel_hi:[1,0]
  v_rcp_f32 v64, v64
  buffer_load_dwordx4 v16, s[12:15], s85 offen offset:0 lds
  v_rcp_f32 v65, v65
  v_pk_fma_f32 v[66:67], v[66:67], v[60:61], v[60:61] op_sel:[0,1,0] op_sel_hi:[1,1,0]
  v_pk_mul_f32 v[128:129], v[128:129], v[64:65]
  v_pk_add_f32 v[72:73], v[72:73], v[128:129]
  v_pk_fma_f32 v[62:63], v[128:129], v[128:129], v[62:63]
  v_pk_mul_f32 v[66:67], v[66:67], v[130:131]
  v_exp_f32 v66, v66
  v_exp_f32 v67, v67
  v_pk_mul_f32 v[68:69], v[132:133], v[132:133]
  v_pk_add_f32 v[66:67], v[66:67], 1.0 op_sel_hi:[1,0]
  v_rcp_f32 v66, v66
  v_rcp_f32 v67, v67
  v_pk_fma_f32 v[68:69], v[68:69], v[60:61], v[60:61] op_sel:[0,1,0] op_sel_hi:[1,1,0]
  v_pk_mul_f32 v[130:131], v[130:131], v[66:67]
  v_pk_add_f32 v[72:73], v[72:73], v[130:131]
  v_pk_fma_f32 v[62:63], v[130:131], v[130:131], v[62:63]
  v_pk_mul_f32 v[68:69], v[68:69], v[132:133]
  v_exp_f32 v68, v68
  v_exp_f32 v69, v69
  v_pk_mul_f32 v[70:71], v[134:135], v[134:135]
  v_pk_add_f32 v[68:69], v[68:69], 1.0 op_sel_hi:[1,0]
  v_rcp_f32 v68, v68
  v_rcp_f32 v69, v69
  v_pk_fma_f32 v[70:71], v[70:71], v[60:61], v[60:61] op_sel:[0,1,0] op_sel_hi:[1,1,0]
  v_pk_mul_f32 v[132:133], v[132:133], v[68:69]
  v_pk_add_f32 v[72:73], v[72:73], v[132:133]
  v_pk_fma_f32 v[62:63], v[132:133], v[132:133], v[62:63]
  v_pk_mul_f32 v[70:71], v[70:71], v[134:135]
  v_exp_f32 v70, v70
  v_exp_f32 v71, v71
  v_pk_mul_f32 v[64:65], v[136:137], v[136:137]
  v_pk_add_f32 v[70:71], v[70:71], 1.0 op_sel_hi:[1,0]
  v_rcp_f32 v70, v70
  v_rcp_f32 v71, v71
  v_pk_fma_f32 v[64:65], v[64:65], v[60:61], v[60:61] op_sel:[0,1,0] op_sel_hi:[1,1,0]
  v_pk_mul_f32 v[134:135], v[134:135], v[70:71]
  v_pk_add_f32 v[72:73], v[72:73], v[134:135]
  buffer_load_dwordx4 v17, s[12:15], s85 offen offset:1024 lds
  s_add_u32 m0, s59, 98304
  v_pk_fma_f32 v[62:63], v[134:135], v[134:135], v[62:63]
  v_pk_mul_f32 v[64:65], v[64:65], v[136:137]
  v_exp_f32 v64, v64
  v_exp_f32 v65, v65
  v_pk_mul_f32 v[66:67], v[138:139], v[138:139]
  v_pk_add_f32 v[64:65], v[64:65], 1.0 op_sel_hi:[1,0]
  v_rcp_f32 v64, v64
  v_rcp_f32 v65, v65
  v_pk_fma_f32 v[66:67], v[66:67], v[60:61], v[60:61] op_sel:[0,1,0] op_sel_hi:[1,1,0]
  v_pk_mul_f32 v[136:137], v[136:137], v[64:65]
  v_pk_add_f32 v[72:73], v[72:73], v[136:137]
  v_pk_fma_f32 v[62:63], v[136:137], v[136:137], v[62:63]
  v_pk_mul_f32 v[66:67], v[66:67], v[138:139]
  v_exp_f32 v66, v66
  v_exp_f32 v67, v67
  v_pk_mul_f32 v[68:69], v[140:141], v[140:141]
  v_pk_add_f32 v[66:67], v[66:67], 1.0 op_sel_hi:[1,0]
  v_rcp_f32 v66, v66
  v_rcp_f32 v67, v67
  v_pk_fma_f32 v[68:69], v[68:69], v[60:61], v[60:61] op_sel:[0,1,0] op_sel_hi:[1,1,0]
  v_pk_mul_f32 v[138:139], v[138:139], v[66:67]
  v_pk_add_f32 v[72:73], v[72:73], v[138:139]
  v_pk_fma_f32 v[62:63], v[138:139], v[138:139], v[62:63]
  v_pk_mul_f32 v[68:69], v[68:69], v[140:141]
  v_exp_f32 v68, v68
  v_exp_f32 v69, v69
  v_pk_mul_f32 v[70:71], v[142:143], v[142:143]
  v_pk_add_f32 v[68:69], v[68:69], 1.0 op_sel_hi:[1,0]
  v_rcp_f32 v68, v68
  v_rcp_f32 v69, v69
  v_pk_fma_f32 v[70:71], v[70:71], v[60:61], v[60:61] op_sel:[0,1,0] op_sel_hi:[1,1,0]
  v_pk_mul_f32 v[140:141], v[140:141], v[68:69]
  v_pk_add_f32 v[72:73], v[72:73], v[140:141]
  v_pk_fma_f32 v[62:63], v[140:141], v[140:141], v[62:63]
  v_pk_mul_f32 v[70:71], v[70:71], v[142:143]
  v_exp_f32 v70, v70
  v_exp_f32 v71, v71
  buffer_load_dwordx4 v16, s[12:15], s86 offen offset:0 lds
  v_pk_add_f32 v[70:71], v[70:71], 1.0 op_sel_hi:[1,0]
  v_rcp_f32 v70, v70
  v_rcp_f32 v71, v71
  s_nop 0
  v_pk_mul_f32 v[142:143], v[142:143], v[70:71]
  v_pk_add_f32 v[72:73], v[72:73], v[142:143]
  v_pk_fma_f32 v[62:63], v[142:143], v[142:143], v[62:63]
  v_add_f32 v72, v72, v73
  v_add_f32 v73, v62, v63
  buffer_load_dwordx4 v17, s[12:15], s86 offen offset:1024 lds
  s_nop 0
  v_permlane32_swap_b32 v72, v73
  v_add_f32 v72, v72, v73
  v_mov_b32 v73, v72
  s_nop 1
  v_permlane32_swap_b32 v72, v73
  buffer_store_dwordx4 v[72:75], v50, s[16:19], s98 offen sc1
  s_add_u32 m0, s59, 106496
  s_waitcnt vmcnt(18)
  s_barrier
  ds_read_b64_tr_b16 a[112:113], v24 offset:57344
  ds_read_b64_tr_b16 a[114:115], v24 offset:57856
  ds_read_b64_tr_b16 a[116:117], v25 offset:57344
  ds_read_b64_tr_b16 a[118:119], v25 offset:57856
  ds_read_b64_tr_b16 a[120:121], v24 offset:59392
  ds_read_b64_tr_b16 a[122:123], v24 offset:59904
  ds_read_b64_tr_b16 a[124:125], v25 offset:59392
  s_bfe_u32 s61, s66, 196612
  ds_read_b64_tr_b16 a[126:127], v25 offset:59904
  s_lshl_b32 s61, s61, 8
  ds_read_b64_tr_b16 a[128:129], v24 offset:61440
  s_lshr_b32 s65, s88, 1
  ds_read_b64_tr_b16 a[130:131], v24 offset:61952
  s_add_u32 s62, s60, 131072
  ds_read_b64_tr_b16 a[132:133], v25 offset:61440
  s_lshr_b32 s63, s51, 1
  ds_read_b64_tr_b16 a[134:135], v25 offset:61952
  s_lshl_b32 s64, s63, 11
  ds_read_b64_tr_b16 a[136:137], v24 offset:63488
  s_add_u32 s64, s64, 131072
  ds_read_b64_tr_b16 a[138:139], v24 offset:64000
  s_lshl1_add_u32 s63, s53, s63
  ds_read_b64_tr_b16 a[140:141], v25 offset:63488
  s_lshl_b32 s63, s63, 6
  ds_read_b64_tr_b16 a[142:143], v25 offset:64000
  s_waitcnt vmcnt(16)
  s_barrier
  s_waitcnt lgkmcnt(14)
  v_mfma_f32_32x32x16_bf16 v[80:95], a[112:115], a[0:3], 0
  s_add_u32 s63, s63, s48
  buffer_load_dwordx4 v16, s[12:15], s87 offen offset:0 lds
  ds_read_b64_tr_b16 a[112:113], v24 offset:0
  ds_read_b64_tr_b16 a[114:115], v24 offset:512
  s_waitcnt lgkmcnt(11)
  v_mfma_f32_32x32x16_bf16 v[96:111], a[116:119], a[0:3], 0
  s_lshl_b32 s63, s63, 10
  ds_read_b64_tr_b16 a[116:117], v25 offset:0
  ds_read_b64_tr_b16 a[118:119], v25 offset:512
  v_add_u32 v29, s60, v28
  v_add_u32 v30, 65536, v28
  buffer_load_dwordx4 v17, s[12:15], s87 offen offset:1024 lds
  v_mfma_f32_32x32x16_bf16 v[80:95], a[120:123], a[4:7], v[80:95]
  s_add_u32 m0, s58, 0
  ds_read_b64_tr_b16 a[120:121], v24 offset:2048
  ds_read_b64_tr_b16 a[122:123], v24 offset:2560
  v_lshl_add_u32 v1, v5, 3, v3
  v_lshl_add_u32 v26, v1, 6, v4
  v_add_u32 v26, 65536, v26
  s_add_u32 s95, s63, 1048576
  s_waitcnt lgkmcnt(6)
  v_mfma_f32_32x32x16_bf16 v[96:111], a[124:127], a[4:7], v[96:111]
  s_and_b32 s63, s51, 1
  ds_read_b64_tr_b16 a[124:125], v25 offset:2048
  buffer_load_dwordx4 v12, s[20:23], s61 offen offset:0 lds
  ds_read_b64_tr_b16 a[126:127], v25 offset:2560
  v_mfma_f32_32x32x16_bf16 v[80:95], a[128:131], a[8:11], v[80:95]
  s_sub_u32 s44, 0, s63
  ds_read_b64_tr_b16 a[128:129], v24 offset:4096
  ds_read_b64_tr_b16 a[130:131], v24 offset:4608
  v_lshl_add_u32 v1, v5, 2, v3
  v_lshl_add_u32 v27, v1, 6, v4
  v_add_u32 v27, 155648, v27
  s_mov_b32 s45, s44
  v_mfma_f32_32x32x16_bf16 v[96:111], a[132:135], a[8:11], v[96:111]
  s_lshl_b32 s63, s63, 15
  ds_read_b64_tr_b16 a[132:133], v25 offset:4096
  ds_read_b64_tr_b16 a[134:135], v25 offset:4608
  buffer_load_dwordx4 v13, s[20:23], s61 offen offset:1024 lds
  v_mfma_f32_32x32x16_bf16 v[80:95], a[136:139], a[12:15], v[80:95]
  s_add_u32 s95, s95, s63
  ds_read_b64_tr_b16 a[136:137], v24 offset:6144
  ds_read_b64_tr_b16 a[138:139], v24 offset:6656
  v_lshrrev_b32 v1, 3, v0
  v_and_b32 v1, 4, v1
  v_xor_b32 v1, v0, v1
  v_mfma_f32_32x32x16_bf16 v[96:111], a[140:143], a[12:15], v[96:111]
  ds_read_b64_tr_b16 a[140:141], v25 offset:6144
  ds_read_b64_tr_b16 a[142:143], v25 offset:6656
  buffer_load_dwordx4 v14, s[20:23], s61 offen offset:2048 lds
  s_waitcnt lgkmcnt(6)
  v_mfma_f32_32x32x16_bf16 v[80:95], a[112:115], a[16:19], v[80:95]
  s_waitcnt vmcnt(12)
  s_barrier
  ds_read_b64_tr_b16 a[112:113], v24 offset:8192
  ds_read_b64_tr_b16 a[114:115], v24 offset:8704
  v_lshlrev_b32 v1, 4, v1
  v_add_u32 v31, s62, v1
  s_lshl4_add_u32 s62, s52, s48
  v_mfma_f32_32x32x16_bf16 v[96:111], a[116:119], a[16:19], v[96:111]
  s_lshl_b32 s69, s62, 14
  ds_read_b64_tr_b16 a[116:117], v25 offset:8192
  ds_read_b64_tr_b16 a[118:119], v25 offset:8704
  buffer_load_dwordx4 v15, s[20:23], s61 offen offset:3072 lds
  v_mfma_f32_32x32x16_bf16 v[80:95], a[120:123], a[20:23], v[80:95]
  s_bfe_u32 s61, s66, 196616
  s_lshl_b32 s61, s61, 8
  s_add_u32 m0, s58, 4096
  ds_read_b64_tr_b16 a[120:121], v24 offset:10240
  ds_read_b64_tr_b16 a[122:123], v24 offset:10752
  v_xor_b32 v32, 1152, v31
  s_add_u32 s69, s69, 4194304
  v_mfma_f32_32x32x16_bf16 v[96:111], a[124:127], a[20:23], v[96:111]
  s_lshl_b32 s62, s62, 7
  ds_read_b64_tr_b16 a[124:125], v25 offset:10240
  ds_read_b64_tr_b16 a[126:127], v25 offset:10752
  v_bfe_u32 v1, v0, 4, 1
  v_and_b32 v2, 1, v0
  v_lshl_add_u32 v1, v1, 1, v2
  s_add_u32 s46, s62, 4096
  v_mfma_f32_32x32x16_bf16 v[80:95], a[128:131], a[24:27], v[80:95]
  s_lshl4_add_u32 s62, s48, s52
  ds_read_b64_tr_b16 a[128:129], v24 offset:12288
  ds_read_b64_tr_b16 a[130:131], v24 offset:12800
  buffer_load_dwordx4 v12, s[20:23], s61 offen offset:0 lds
  s_waitcnt lgkmcnt(6)
  v_mfma_f32_32x32x16_bf16 v[96:111], a[132:135], a[24:27], v[96:111]
  s_lshl_b32 s62, s62, 7
  ds_read_b64_tr_b16 a[132:133], v25 offset:12288
  ds_read_b64_tr_b16 a[134:135], v25 offset:12800
  v_lshrrev_b32 v2, 5, v0
  v_lshlrev_b32 v2, 0, v2
  v_xor_b32 v2, v2, v1
  s_add_u32 s47, s62, 65536
  v_mfma_f32_32x32x16_bf16 v[80:95], a[136:139], a[28:31], v[80:95]
  ds_read_b64_tr_b16 a[136:137], v24 offset:14336
  buffer_load_dwordx4 v13, s[20:23], s61 offen offset:1024 lds
  ds_read_b64_tr_b16 a[138:139], v24 offset:14848
  v_mfma_f32_32x32x16_bf16 v[96:111], a[140:143], a[28:31], v[96:111]
  ds_read_b64_tr_b16 a[140:141], v25 offset:14336
  ds_read_b64_tr_b16 a[142:143], v25 offset:14848
  s_waitcnt vmcnt(13)
  s_barrier
  v_lshlrev_b32 v33, 9, v1
  v_mfma_f32_32x32x16_bf16 v[80:95], a[112:115], a[32:35], v[80:95]
  ds_read_b64_tr_b16 a[112:113], v24 offset:16384
  ds_read_b64_tr_b16 a[114:115], v24 offset:16896
  buffer_load_dwordx4 v14, s[20:23], s61 offen offset:2048 lds
  v_mfma_f32_32x32x16_bf16 v[96:111], a[116:119], a[32:35], v[96:111]
  ds_read_b64_tr_b16 a[116:117], v25 offset:16384
  ds_read_b64_tr_b16 a[118:119], v25 offset:16896
  v_lshl_add_u32 v33, v2, 6, v33
  v_and_b32 v1, 14, v0
  v_lshl_add_u32 v33, v1, 2, v33
  s_waitcnt lgkmcnt(7)
  v_mfma_f32_32x32x16_bf16 v[80:95], a[120:123], a[36:39], v[80:95]
  ds_read_b64_tr_b16 a[120:121], v24 offset:18432
  ds_read_b64_tr_b16 a[122:123], v24 offset:18944
  v_add_u32 v33, s64, v33
  v_xor_b32 v34, 128, v33
  v_add_u32 v41, 147456, v28
  s_add_u32 s64, s60, 131072
  v_mfma_f32_32x32x16_bf16 v[96:111], a[124:127], a[36:39], v[96:111]
  ds_read_b64_tr_b16 a[124:125], v25 offset:18432
  ds_read_b64_tr_b16 a[126:127], v25 offset:18944
  v_add_u32 v42, s59, v41
  v_mov_b32 v43, 0x3f803f80
  v_mov_b32 v44, 0xff
  v_mfma_f32_32x32x16_bf16 v[80:95], a[128:131], a[40:43], v[80:95]
  ds_read_b64_tr_b16 a[128:129], v24 offset:20480
  ds_read_b64_tr_b16 a[130:131], v24 offset:20992
  v_and_b32 v1, 31, v0
  v_cmp_eq_u32 s[72:73], 28, v1
  v_add_u32 v49, 0x4000, v28
  v_mfma_f32_32x32x16_bf16 v[96:111], a[132:135], a[40:43], v[96:111]
  ds_read_b64_tr_b16 a[132:133], v25 offset:20480
  ds_read_b64_tr_b16 a[134:135], v25 offset:20992
  v_bfe_u32 v1, v0, 1, 1
  v_lshrrev_b32 v2, 3, v0
  v_and_b32 v2, 6, v2
  s_waitcnt lgkmcnt(7)
  v_mfma_f32_32x32x16_bf16 v[80:95], a[136:139], a[44:47], v[80:95]
  ds_read_b64_tr_b16 a[136:137], v24 offset:22528
  ds_read_b64_tr_b16 a[138:139], v24 offset:23040
  v_xor_b32 v2, v2, v1
  v_lshlrev_b32 v1, 9, v1
  v_lshl_add_u32 v1, v2, 6, v1
  v_mfma_f32_32x32x16_bf16 v[96:111], a[140:143], a[44:47], v[96:111]
  ds_read_b64_tr_b16 a[140:141], v25 offset:22528
  ds_read_b64_tr_b16 a[142:143], v25 offset:23040
  s_waitcnt vmcnt(12)
  s_barrier
  v_lshl_add_u32 v1, v3, 4, v1
  v_mfma_f32_32x32x16_bf16 v[80:95], a[112:115], a[48:51], v[80:95]
  ds_read_b64_tr_b16 a[112:113], v24 offset:24576
  ds_read_b64_tr_b16 a[114:115], v24 offset:25088
  v_and_b32 v2, 1, v0
  v_lshl_add_u32 v1, v2, 3, v1
  v_add_u32 v35, s64, v1
  v_mfma_f32_32x32x16_bf16 v[96:111], a[116:119], a[48:51], v[96:111]
  ds_read_b64_tr_b16 a[116:117], v25 offset:24576
  ds_read_b64_tr_b16 a[118:119], v25 offset:25088
  v_xor_b32 v36, 64, v35
  v_xor_b32 v37, 1152, v35
  v_xor_b32 v38, 1216, v35
  s_waitcnt lgkmcnt(7)
  v_mfma_f32_32x32x16_bf16 v[80:95], a[120:123], a[52:55], v[80:95]
  ds_read_b64_tr_b16 a[120:121], v24 offset:26624
  ds_read_b64_tr_b16 a[122:123], v24 offset:27136
  v_mfma_f32_32x32x16_bf16 v[96:111], a[124:127], a[52:55], v[96:111]
  ds_read_b64_tr_b16 a[124:125], v25 offset:26624
  ds_read_b64_tr_b16 a[126:127], v25 offset:27136
  v_mfma_f32_32x32x16_bf16 v[80:95], a[128:131], a[56:59], v[80:95]
  ds_read_b64_tr_b16 a[128:129], v24 offset:28672
  ds_read_b64_tr_b16 a[130:131], v24 offset:29184
  v_mfma_f32_32x32x16_bf16 v[96:111], a[132:135], a[56:59], v[96:111]
  ds_read_b64_tr_b16 a[132:133], v25 offset:28672
  ds_read_b64_tr_b16 a[134:135], v25 offset:29184
  buffer_load_dwordx4 v15, s[20:23], s61 offen offset:3072 lds
  s_waitcnt lgkmcnt(6)
  v_mfma_f32_32x32x16_bf16 v[80:95], a[136:139], a[60:63], v[80:95]
  s_add_u32 m0, s67, 98304
  ds_read_b64_tr_b16 a[136:137], v24 offset:30720
  ds_read_b64_tr_b16 a[138:139], v24 offset:31232
  v_mfma_f32_32x32x16_bf16 v[96:111], a[140:143], a[60:63], v[96:111]
  ds_read_b64_tr_b16 a[140:141], v25 offset:30720
  ds_read_b64_tr_b16 a[142:143], v25 offset:31232
  buffer_load_dwordx4 v[176:179], v28, s[16:19], s98 offen offset:0 sc1
  v_mfma_f32_32x32x16_bf16 v[80:95], a[112:115], a[64:67], v[80:95]
  s_waitcnt vmcnt(12)
  s_barrier
  s_load_dword s74, s[100:101], 0
  s_load_dword s75, s[100:101], 128
  s_load_dword s76, s[100:101], 256
  s_load_dword s77, s[100:101], 384
  s_load_dword s78, s[100:101], 512
  v_mfma_f32_32x32x16_bf16 v[96:111], a[116:119], a[64:67], v[96:111]
  s_load_dword s79, s[100:101], 640
  s_load_dword s80, s[100:101], 768
  ds_read_b64_tr_b16 a[112:113], v24 offset:32768
  buffer_load_dwordx4 v[180:183], v28, s[16:19], s98 offen offset:1024 sc1
  v_mfma_f32_32x32x16_bf16 v[80:95], a[120:123], a[68:71], v[80:95]
  ds_read_b64_tr_b16 a[114:115], v24 offset:33280
  ds_read_b64_tr_b16 a[116:117], v25 offset:32768
  ds_read_b64_tr_b16 a[118:119], v25 offset:33280
  ds_read_b64_tr_b16 a[120:121], v24 offset:34816
  ds_read_b64_tr_b16 a[122:123], v24 offset:35328
  s_waitcnt lgkmcnt(9)
  v_mfma_f32_32x32x16_bf16 v[96:111], a[124:127], a[68:71], v[96:111]
  ds_read_b64_tr_b16 a[124:125], v25 offset:34816
  ds_read_b64_tr_b16 a[126:127], v25 offset:35328
  buffer_load_dwordx4 v[184:187], v28, s[16:19], s98 offen offset:2048 sc1
  v_mfma_f32_32x32x16_bf16 v[80:95], a[128:131], a[72:75], v[80:95]
  ds_read_b64_tr_b16 a[128:129], v24 offset:36864
  ds_read_b64_tr_b16 a[130:131], v24 offset:37376
  v_mfma_f32_32x32x16_bf16 v[96:111], a[132:135], a[72:75], v[96:111]
  ds_read_b64_tr_b16 a[132:133], v25 offset:36864
  ds_read_b64_tr_b16 a[134:135], v25 offset:37376
  buffer_load_dwordx4 v[188:191], v28, s[16:19], s98 offen offset:3072 sc1
  s_waitcnt lgkmcnt(9)
  v_mfma_f32_32x32x16_bf16 v[80:95], a[136:139], a[76:79], v[80:95]
  ds_read_b64_tr_b16 a[136:137], v24 offset:38912
  ds_read_b64_tr_b16 a[138:139], v24 offset:39424
  v_mfma_f32_32x32x16_bf16 v[96:111], a[140:143], a[76:79], v[96:111]
  ds_read_b64_tr_b16 a[140:141], v25 offset:38912
  ds_read_b64_tr_b16 a[142:143], v25 offset:39424
  buffer_load_dwordx4 v[192:195], v28, s[16:19], s99 offen offset:0 sc1
  v_mfma_f32_32x32x16_bf16 v[80:95], a[112:115], a[80:83], v[80:95]
  s_waitcnt vmcnt(13)
  s_barrier
  ds_read_b64_tr_b16 a[112:113], v24 offset:40960
  ds_read_b64_tr_b16 a[114:115], v24 offset:41472
  s_waitcnt lgkmcnt(9)
  v_mfma_f32_32x32x16_bf16 v[96:111], a[116:119], a[80:83], v[96:111]
  ds_read_b64_tr_b16 a[116:117], v25 offset:40960
  ds_read_b64_tr_b16 a[118:119], v25 offset:41472
  v_mfma_f32_32x32x16_bf16 v[80:95], a[120:123], a[84:87], v[80:95]
  ds_read_b64_tr_b16 a[120:121], v24 offset:43008
  ds_read_b64_tr_b16 a[122:123], v24 offset:43520
  buffer_load_dwordx4 v[196:199], v28, s[16:19], s99 offen offset:1024 sc1
  v_mfma_f32_32x32x16_bf16 v[96:111], a[124:127], a[84:87], v[96:111]
  ds_read_b64_tr_b16 a[124:125], v25 offset:43008
  ds_read_b64_tr_b16 a[126:127], v25 offset:43520
  s_waitcnt lgkmcnt(9)
  v_mfma_f32_32x32x16_bf16 v[80:95], a[128:131], a[88:91], v[80:95]
  ds_read_b64_tr_b16 a[128:129], v24 offset:45056
  ds_read_b64_tr_b16 a[130:131], v24 offset:45568
  buffer_load_dwordx4 v[200:203], v28, s[16:19], s99 offen offset:2048 sc1
  v_mfma_f32_32x32x16_bf16 v[96:111], a[132:135], a[88:91], v[96:111]
  ds_read_b64_tr_b16 a[132:133], v25 offset:45056
  ds_read_b64_tr_b16 a[134:135], v25 offset:45568
  v_mfma_f32_32x32x16_bf16 v[80:95], a[136:139], a[92:95], v[80:95]
  ds_read_b64_tr_b16 a[136:137], v24 offset:47104
  ds_read_b64_tr_b16 a[138:139], v24 offset:47616
  s_waitcnt lgkmcnt(9)
  v_mfma_f32_32x32x16_bf16 v[96:111], a[140:143], a[92:95], v[96:111]
  ds_read_b64_tr_b16 a[140:141], v25 offset:47104
  ds_read_b64_tr_b16 a[142:143], v25 offset:47616
  v_mfma_f32_32x32x16_bf16 v[80:95], a[112:115], a[96:99], v[80:95]
  v_mfma_f32_32x32x16_bf16 v[96:111], a[116:119], a[96:99], v[96:111]
  s_waitcnt lgkmcnt(9)
  v_mfma_f32_32x32x16_bf16 v[80:95], a[120:123], a[100:103], v[80:95]
  s_waitcnt lgkmcnt(0)
  s_xor_b32 s74, s74, s54
  s_xor_b32 s75, s75, s54
  s_xor_b32 s76, s76, s54
  v_mfma_f32_32x32x16_bf16 v[96:111], a[124:127], a[100:103], v[96:111]
  s_xor_b32 s77, s77, s54
  s_xor_b32 s78, s78, s54
  s_xor_b32 s79, s79, s54
  s_xor_b32 s80, s80, s54
  s_or_b32 s74, s74, s75
  s_or_b32 s74, s74, s76
  s_or_b32 s74, s74, s77
  v_mfma_f32_32x32x16_bf16 v[80:95], a[128:131], a[104:107], v[80:95]
  s_or_b32 s74, s74, s78
  s_or_b32 s74, s74, s79
  s_or_b32 s74, s74, s80
  s_cbranch_scc1 Lslow_fw_2
Lback_fw_2:
  s_barrier
  buffer_load_dwordx4 v18, s[16:19], s65 offen sc1 lds
  v_mfma_f32_32x32x16_bf16 v[96:111], a[132:135], a[104:107], v[96:111]
  s_add_u32 m0, s67, 102400
  s_lshr_b32 s65, s89, 1
  buffer_load_dwordx4 v18, s[16:19], s65 offen sc1 lds
  s_add_u32 m0, s67, 106496
  v_mfma_f32_32x32x16_bf16 v[80:95], a[136:139], a[108:111], v[80:95]
  s_lshr_b32 s65, s90, 1
  buffer_load_dwordx4 v18, s[16:19], s65 offen sc1 lds
  s_add_u32 m0, s67, 110592
  s_lshr_b32 s65, s91, 1
  v_mfma_f32_32x32x16_bf16 v[96:111], a[140:143], a[108:111], v[96:111]
  s_nop 6
  v_pk_mul_f32 v[64:65], v[80:81], v[80:81]
  v_pk_fma_f32 v[64:65], v[64:65], v[60:61], v[60:61] op_sel:[0,1,0] op_sel_hi:[1,1,0]
  v_pk_mul_f32 v[64:65], v[64:65], v[80:81]
  v_exp_f32 v64, v64
  v_exp_f32 v65, v65
  v_pk_mul_f32 v[66:67], v[82:83], v[82:83]
  v_pk_add_f32 v[64:65], v[64:65], 1.0 op_sel_hi:[1,0]
  v_rcp_f32 v64, v64
  v_rcp_f32 v65, v65
  v_pk_fma_f32 v[66:67], v[66:67], v[60:61], v[60:61] op_sel:[0,1,0] op_sel_hi:[1,1,0]
  v_pk_mul_f32 v[80:81], v[80:81], v[64:65]
  v_pk_mul_f32 v[66:67], v[66:67], v[82:83]
  v_exp_f32 v66, v66
  v_exp_f32 v67, v67
  v_pk_mul_f32 v[68:69], v[84:85], v[84:85]
  v_pk_add_f32 v[66:67], v[66:67], 1.0 op_sel_hi:[1,0]
  v_rcp_f32 v66, v66
  buffer_load_dwordx4 v18, s[16:19], s65 offen sc1 lds
  s_add_u32 m0, s67, 114688
  s_lshr_b32 s65, s92, 1
  v_rcp_f32 v67, v67
  v_pk_fma_f32 v[68:69], v[68:69], v[60:61], v[60:61] op_sel:[0,1,0] op_sel_hi:[1,1,0]
  v_pk_mul_f32 v[82:83], v[82:83], v[66:67]
  v_pk_mul_f32 v[68:69], v[68:69], v[84:85]
  v_exp_f32 v68, v68
  v_exp_f32 v69, v69
  buffer_load_dwordx4 v18, s[16:19], s65 offen sc1 lds
  s_add_u32 m0, s67, 118784
  s_lshr_b32 s65, s93, 1
  v_pk_add_f32 v[68:69], v[68:69], 1.0 op_sel_hi:[1,0]
  v_rcp_f32 v68, v68
  v_rcp_f32 v69, v69
  v_pk_mul_f32 v[70:71], v[86:87], v[86:87]
  v_pk_mul_f32 v[84:85], v[84:85], v[68:69]
  v_pk_fma_f32 v[70:71], v[70:71], v[60:61], v[60:61] op_sel:[0,1,0] op_sel_hi:[1,1,0]
  v_pk_mul_f32 v[70:71], v[70:71], v[86:87]
  v_exp_f32 v70, v70
  buffer_load_dwordx4 v18, s[16:19], s65 offen sc1 lds
  s_add_u32 m0, s67, 122880
  s_lshr_b32 s65, s94, 1
  v_exp_f32 v71, v71
  v_pk_mul_f32 v[64:65], v[88:89], v[88:89]
  v_pk_add_f32 v[70:71], v[70:71], 1.0 op_sel_hi:[1,0]
  v_rcp_f32 v70, v70
  v_rcp_f32 v71, v71
  v_pk_fma_f32 v[64:65], v[64:65], v[60:61], v[60:61] op_sel:[0,1,0] op_sel_hi:[1,1,0]
  v_pk_mul_f32 v[86:87], v[86:87], v[70:71]
  buffer_load_dwordx4 v18, s[16:19], s65 offen sc1 lds
  s_add_u32 m0, s59, 65536
  v_pk_mul_f32 v[64:65], v[64:65], v[88:89]
  v_exp_f32 v64, v64
  v_exp_f32 v65, v65
  v_pk_mul_f32 v[66:67], v[90:91], v[90:91]
  v_pk_add_f32 v[64:65], v[64:65], 1.0 op_sel_hi:[1,0]
  v_rcp_f32 v64, v64
  v_rcp_f32 v65, v65
  v_pk_fma_f32 v[66:67], v[66:67], v[60:61], v[60:61] op_sel:[0,1,0] op_sel_hi:[1,1,0]
  buffer_load_dwordx4 v19, s[16:19], s88 offen offset:0 sc1 lds
  v_pk_mul_f32 v[88:89], v[88:89], v[64:65]
  v_pk_mul_f32 v[66:67], v[66:67], v[90:91]
  v_exp_f32 v66, v66
  v_exp_f32 v67, v67
  v_pk_mul_f32 v[68:69], v[92:93], v[92:93]
  v_pk_add_f32 v[66:67], v[66:67], 1.0 op_sel_hi:[1,0]
  v_rcp_f32 v66, v66
  v_rcp_f32 v67, v67
  v_pk_fma_f32 v[68:69], v[68:69], v[60:61], v[60:61] op_sel:[0,1,0] op_sel_hi:[1,1,0]
  v_pk_mul_f32 v[90:91], v[90:91], v[66:67]
  v_pk_mul_f32 v[68:69], v[68:69], v[92:93]
  v_exp_f32 v68, v68
  v_exp_f32 v69, v69
  v_pk_mul_f32 v[70:71], v[94:95], v[94:95]
  v_pk_add_f32 v[68:69], v[68:69], 1.0 op_sel_hi:[1,0]
  v_rcp_f32 v68, v68
  v_rcp_f32 v69, v69
  v_pk_fma_f32 v[70:71], v[70:71], v[60:61], v[60:61] op_sel:[0,1,0] op_sel_hi:[1,1,0]
  v_pk_mul_f32 v[92:93], v[92:93], v[68:69]
  v_pk_mul_f32 v[70:71], v[70:71], v[94:95]
  v_exp_f32 v70, v70
  v_exp_f32 v71, v71
  v_pk_mul_f32 v[64:65], v[96:97], v[96:97]
  v_pk_add_f32 v[70:71], v[70:71], 1.0 op_sel_hi:[1,0]
  v_rcp_f32 v70, v70
  v_rcp_f32 v71, v71
  v_pk_fma_f32 v[64:65], v[64:65], v[60:61], v[60:61] op_sel:[0,1,0] op_sel_hi:[1,1,0]
  v_pk_mul_f32 v[94:95], v[94:95], v[70:71]
  v_pk_mul_f32 v[64:65], v[64:65], v[96:97]
  v_exp_f32 v64, v64
  v_exp_f32 v65, v65
  v_pk_mul_f32 v[66:67], v[98:99], v[98:99]
  v_pk_add_f32 v[64:65], v[64:65], 1.0 op_sel_hi:[1,0]
  v_rcp_f32 v64, v64
  v_rcp_f32 v65, v65
  v_pk_fma_f32 v[66:67], v[66:67], v[60:61], v[60:61] op_sel:[0,1,0] op_sel_hi:[1,1,0]
  v_pk_mul_f32 v[96:97], v[96:97], v[64:65]
  v_pk_mul_f32 v[66:67], v[66:67], v[98:99]
  v_exp_f32 v66, v66
  v_exp_f32 v67, v67
  v_pk_mul_f32 v[68:69], v[100:101], v[100:101]
  v_pk_add_f32 v[66:67], v[66:67], 1.0 op_sel_hi:[1,0]
  v_rcp_f32 v66, v66
  v_rcp_f32 v67, v67
  v_pk_fma_f32 v[68:69], v[68:69], v[60:61], v[60:61] op_sel:[0,1,0] op_sel_hi:[1,1,0]
  buffer_load_dwordx4 v19, s[16:19], s88 offen offset:1024 sc1 lds
  s_add_u32 m0, s59, 73728
  v_pk_mul_f32 v[98:99], v[98:99], v[66:67]
  v_pk_mul_f32 v[68:69], v[68:69], v[100:101]
  v_exp_f32 v68, v68
  v_exp_f32 v69, v69
  v_pk_mul_f32 v[70:71], v[102:103], v[102:103]
  v_pk_add_f32 v[68:69], v[68:69], 1.0 op_sel_hi:[1,0]
  v_rcp_f32 v68, v68
  v_rcp_f32 v69, v69
  buffer_load_dwordx4 v19, s[16:19], s89 offen offset:0 sc1 lds
  v_pk_mul_f32 v[100:101], v[100:101], v[68:69]
  v_pk_fma_f32 v[70:71], v[70:71], v[60:61], v[60:61] op_sel:[0,1,0] op_sel_hi:[1,1,0]
  v_pk_mul_f32 v[70:71], v[70:71], v[102:103]
  v_exp_f32 v70, v70
  v_exp_f32 v71, v71
  s_nop 0
  v_pk_add_f32 v[70:71], v[70:71], 1.0 op_sel_hi:[1,0]
  v_rcp_f32 v70, v70
  v_rcp_f32 v71, v71
  s_nop 0
  v_pk_mul_f32 v[102:103], v[102:103], v[70:71]
  buffer_load_dwordx4 v19, s[16:19], s89 offen offset:1024 sc1 lds
  s_add_u32 m0, s59, 81920
  s_nop 0
  buffer_load_dwordx4 v19, s[16:19], s90 offen offset:0 sc1 lds
  buffer_load_dwordx4 v19, s[16:19], s90 offen offset:1024 sc1 lds
  s_add_u32 m0, s59, 90112
  s_nop 0
  buffer_load_dwordx4 v19, s[16:19], s91 offen offset:0 sc1 lds
  buffer_load_dwordx4 v19, s[16:19], s91 offen offset:1024 sc1 lds
  s_waitcnt vmcnt(21)
  v_xor_b32 v52, s54, v178
  s_waitcnt vmcnt(20)
  v_bitop3_b32 v52, v182, s54, v52 bitop3:0xbe
  s_waitcnt vmcnt(19)
  v_bitop3_b32 v52, v186, s54, v52 bitop3:0xbe
  s_waitcnt vmcnt(18)
  v_bitop3_b32 v52, v190, s54, v52 bitop3:0xbe
  s_waitcnt vmcnt(17)
  v_bitop3_b32 v52, v194, s54, v52 bitop3:0xbe
  s_waitcnt vmcnt(16)
  v_bitop3_b32 v52, v198, s54, v52 bitop3:0xbe
  s_waitcnt vmcnt(15)
  v_bitop3_b32 v52, v202, s54, v52 bitop3:0xbe
  v_cmp_ne_u32 vcc, 0, v52
  s_nop 0
  s_cbranch_vccnz Lslow_stats_3
Lback_stats_3:
  v_pk_add_f32 v[62:63], v[176:177], v[180:181]
  v_pk_add_f32 v[62:63], v[62:63], v[184:185]
  v_pk_add_f32 v[62:63], v[62:63], v[188:189]
  v_pk_add_f32 v[62:63], v[62:63], v[192:193]
  v_pk_add_f32 v[62:63], v[62:63], v[196:197]
  v_pk_add_f32 v[62:63], v[62:63], v[200:201]
  s_nop 1
  v_permlane32_swap_b32 v62, v63
  v_add_f32 v62, v62, v63
  v_mul_f32 v62, 0x3a924925, v62
  v_mov_b32 v63, v62
  s_nop 1
  v_permlane32_swap_b32 v62, v63
  v_fma_f32 v63, -v62, v62, v63
  v_max_f32 v63, 0, v63
  v_add_f32 v63, 0x3727c5ac, v63
  v_rsq_f32 v63, v63
  s_nop 0
  v_mul_f32_e64 v62, -v62, v63
  v_pk_fma_f32 v[112:113], v[112:113], v[62:63], v[62:63] op_sel:[0,1,0] op_sel_hi:[1,1,0]
  v_pk_fma_f32 v[114:115], v[114:115], v[62:63], v[62:63] op_sel:[0,1,0] op_sel_hi:[1,1,0]
  v_pk_fma_f32 v[116:117], v[116:117], v[62:63], v[62:63] op_sel:[0,1,0] op_sel_hi:[1,1,0]
  v_pk_fma_f32 v[118:119], v[118:119], v[62:63], v[62:63] op_sel:[0,1,0] op_sel_hi:[1,1,0]
  v_cvt_pk_bf16_f32 v144, v112, v113
  v_cvt_pk_bf16_f32 v145, v114, v115
  v_cvt_pk_bf16_f32 v146, v116, v117
  v_cvt_pk_bf16_f32 v147, v118, v119
  ds_write_b128 v31, v[144:147] offset:0
  v_pk_fma_f32 v[120:121], v[120:121], v[62:63], v[62:63] op_sel:[0,1,0] op_sel_hi:[1,1,0]
  v_pk_fma_f32 v[122:123], v[122:123], v[62:63], v[62:63] op_sel:[0,1,0] op_sel_hi:[1,1,0]
  v_pk_fma_f32 v[124:125], v[124:125], v[62:63], v[62:63] op_sel:[0,1,0] op_sel_hi:[1,1,0]
  v_pk_fma_f32 v[126:127], v[126:127], v[62:63], v[62:63] op_sel:[0,1,0] op_sel_hi:[1,1,0]
  v_cvt_pk_bf16_f32 v148, v120, v121
  v_cvt_pk_bf16_f32 v149, v122, v123
  v_cvt_pk_bf16_f32 v150, v124, v125
  v_cvt_pk_bf16_f32 v151, v126, v127
  ds_write_b128 v32, v[148:151] offset:0
  v_pk_fma_f32 v[128:129], v[128:129], v[62:63], v[62:63] op_sel:[0,1,0] op_sel_hi:[1,1,0]
  v_pk_fma_f32 v[130:131], v[130:131], v[62:63], v[62:63] op_sel:[0,1,0] op_sel_hi:[1,1,0]
  v_pk_fma_f32 v[132:133], v[132:133], v[62:63], v[62:63] op_sel:[0,1,0] op_sel_hi:[1,1,0]
  v_pk_fma_f32 v[134:135], v[134:135], v[62:63], v[62:63] op_sel:[0,1,0] op_sel_hi:[1,1,0]
  v_cvt_pk_bf16_f32 v152, v128, v129
  v_cvt_pk_bf16_f32 v153, v130, v131
  v_cvt_pk_bf16_f32 v154, v132, v133
  v_cvt_pk_bf16_f32 v155, v134, v135
  ds_write_b128 v31, v[152:155] offset:2048
  v_pk_fma_f32 v[136:137], v[136:137], v[62:63], v[62:63] op_sel:[0,1,0] op_sel_hi:[1,1,0]
  v_pk_fma_f32 v[138:139], v[138:139], v[62:63], v[62:63] op_sel:[0,1,0] op_sel_hi:[1,1,0]
  v_pk_fma_f32 v[140:141], v[140:141], v[62:63], v[62:63] op_sel:[0,1,0] op_sel_hi:[1,1,0]
  v_pk_fma_f32 v[142:143], v[142:143], v[62:63], v[62:63] op_sel:[0,1,0] op_sel_hi:[1,1,0]
  v_cvt_pk_bf16_f32 v156, v136, v137
  v_cvt_pk_bf16_f32 v157, v138, v139
  v_cvt_pk_bf16_f32 v158, v140, v141
  v_cvt_pk_bf16_f32 v159, v142, v143
  ds_write_b128 v32, v[156:159] offset:2048
  ds_read_b64_tr_b16 v[160:161], v35 offset:0
  ds_read_b64_tr_b16 v[162:163], v36 offset:0
  ds_read_b64_tr_b16 v[164:165], v37 offset:0
  ds_read_b64_tr_b16 v[166:167], v38 offset:0
  ds_read_b64_tr_b16 v[168:169], v35 offset:2048
  ds_read_b64_tr_b16 v[170:171], v36 offset:2048
  ds_read_b64_tr_b16 v[172:173], v37 offset:2048
  ds_read_b64_tr_b16 v[174:175], v38 offset:2048
  s_waitcnt lgkmcnt(6)
  buffer_store_dwordx4 v[160:163], v29, s[16:19], s69 offen offset:0 sc1
  s_waitcnt lgkmcnt(3)
  buffer_store_dwordx4 v[164:167], v29, s[16:19], s69 offen offset:1024 sc1
  s_waitcnt lgkmcnt(0)
  buffer_store_dwordx4 v[168:171], v29, s[16:19], s69 offen offset:2048 sc1
  buffer_store_dwordx4 v[172:175], v29, s[16:19], s69 offen offset:3072 sc1
  s_bfe_u32 s61, s66, 196608
  s_lshl_b32 s61, s61, 8
  s_addk_i32 s61, 128
  s_add_u32 m0, s58, 8192
  s_waitcnt vmcnt(15)
  s_barrier
  ds_read_b64_tr_b16 a[112:113], v26 offset:32768
  ds_read_b64_tr_b16 a[114:115], v26 offset:33024
  ds_read_b64_tr_b16 a[116:117], v26 offset:33792
  ds_read_b64_tr_b16 a[118:119], v26 offset:34048
  ds_read_b64_tr_b16 a[120:121], v26 offset:34816
  ds_read_b64_tr_b16 a[122:123], v26 offset:35072
  ds_read_b64_tr_b16 a[124:125], v26 offset:35840
  s_lshl2_add_u32 s62, s50, s49
  ds_read_b64_tr_b16 a[126:127], v26 offset:36096
  s_and_b32 s63, s51, 2
  ds_read_b64_tr_b16 a[128:129], v26 offset:36864
  s_add_u32 s62, s62, s63
  ds_read_b64_tr_b16 a[130:131], v26 offset:37120
  s_and_b32 s63, s51, 1
  ds_read_b64_tr_b16 a[132:133], v26 offset:37888
  s_lshl1_add_u32 s62, s62, s63
  ds_read_b64_tr_b16 a[134:135], v26 offset:38144
  s_lshl_b32 s62, s62, 9
  ds_read_b64_tr_b16 a[136:137], v26 offset:38912
  s_add_u32 s62, s62, 4096
  ds_read_b64_tr_b16 a[138:139], v26 offset:39168
  s_mov_b32 s3, s62
  ds_read_b64_tr_b16 a[140:141], v26 offset:39936
  s_add_u32 s100, s16, s62
  s_addc_u32 s101, s17, 0
  ds_read_b64_tr_b16 a[142:143], v26 offset:40192
  s_waitcnt lgkmcnt(14)
  v_mfma_f32_32x32x16_bf16 v[112:127], a[112:115], a[0:3], 0
  s_xor_b32 s62, s52, 1
  ds_read_b64_tr_b16 a[112:113], v26 offset:40960
  ds_read_b64_tr_b16 a[114:115], v26 offset:41216
  ds_read_b64_tr_b16 v[64:65], v27 offset:0
  ds_read_b64_tr_b16 v[66:67], v27 offset:512
  s_lshl1_add_u32 s62, s62, s49
  ds_read_b64_tr_b16 v[68:69], v27 offset:1024
  s_waitcnt lgkmcnt(14)
  v_mfma_f32_32x32x16_bf16 v[112:127], a[116:119], a[4:7], v[112:127]
  s_lshl_b32 s62, s62, 17
  ds_read_b64_tr_b16 a[116:117], v26 offset:41984
  ds_read_b64_tr_b16 a[118:119], v26 offset:42240
  ds_read_b64_tr_b16 v[70:71], v27 offset:1536
  s_add_u32 s62, s62, 4194304
  v_add_u32 v29, s62, v29
  v_xor_b32 v8, 0x40000, v29
  v_mfma_f32_32x32x16_bf16 v[112:127], a[120:123], a[8:11], v[112:127]
  s_bfe_u32 s8, s66, 196608
  ds_read_b64_tr_b16 a[120:121], v26 offset:43008
  ds_read_b64_tr_b16 a[122:123], v26 offset:43264
  v_lshlrev_b32 v48, 16, v48
  s_lshl_b32 s8, s8, 14
  s_bfe_u32 s9, s66, 196612
  s_lshl_b32 s9, s9, 14
  s_waitcnt lgkmcnt(11)
  v_mfma_f32_32x32x16_bf16 v[112:127], a[124:127], a[12:15], v[112:127]
  s_bfe_u32 s10, s66, 196616
  ds_read_b64_tr_b16 a[124:125], v26 offset:44032
  ds_read_b64_tr_b16 a[126:127], v26 offset:44288
  s_lshl_b32 s10, s10, 14
  buffer_load_dwordx4 v12, s[20:23], s61 offen offset:0 lds
  v_mfma_f32_32x32x16_bf16 v[112:127], a[128:131], a[16:19], v[112:127]
  s_bfe_u32 s11, s66, 196620
  ds_read_b64_tr_b16 a[128:129], v26 offset:45056
  ds_read_b64_tr_b16 a[130:131], v26 offset:45312
  s_lshl_b32 s11, s11, 14
  s_bfe_u32 s12, s66, 196624
  s_lshl_b32 s12, s12, 14
  s_bfe_u32 s13, s66, 196628
  v_mfma_f32_32x32x16_bf16 v[112:127], a[132:135], a[20:23], v[112:127]
  s_lshl_b32 s13, s13, 14
  ds_read_b64_tr_b16 a[132:133], v26 offset:46080
  ds_read_b64_tr_b16 a[134:135], v26 offset:46336
  s_bfe_u32 s14, s66, 196632
  s_lshl_b32 s14, s14, 14
  s_bfe_u32 s15, s66, 196636
  s_lshl_b32 s15, s15, 14
  v_mfma_f32_32x32x16_bf16 v[112:127], a[136:139], a[24:27], v[112:127]
  ds_read_b64_tr_b16 a[136:137], v26 offset:47104
  ds_read_b64_tr_b16 a[138:139], v26 offset:47360
  s_waitcnt lgkmcnt(8)
  v_mfma_f32_32x32x16_bf16 v[112:127], a[140:143], a[28:31], v[112:127]
  ds_read_b64_tr_b16 a[140:141], v26 offset:48128
  ds_read_b64_tr_b16 a[142:143], v26 offset:48384
  s_waitcnt vmcnt(13)
  s_barrier
  v_mfma_f32_32x32x16_bf16 v[112:127], a[112:115], a[32:35], v[112:127]
  ds_read_b64_tr_b16 a[112:113], v26 offset:49152
  ds_read_b64_tr_b16 a[114:115], v26 offset:49408
  v_mfma_f32_32x32x16_bf16 v[112:127], a[116:119], a[36:39], v[112:127]
  ds_read_b64_tr_b16 a[116:117], v26 offset:50176
  ds_read_b64_tr_b16 a[118:119], v26 offset:50432
  v_mfma_f32_32x32x16_bf16 v[112:127], a[120:123], a[40:43], v[112:127]
  ds_read_b64_tr_b16 a[120:121], v26 offset:51200
  buffer_load_dwordx4 v13, s[20:23], s61 offen offset:1024 lds
  ds_read_b64_tr_b16 a[122:123], v26 offset:51456
  s_waitcnt lgkmcnt(6)
  v_mfma_f32_32x32x16_bf16 v[112:127], a[124:127], a[44:47], v[112:127]
  ds_read_b64_tr_b16 a[124:125], v26 offset:52224
  ds_read_b64_tr_b16 a[126:127], v26 offset:52480
  v_mfma_f32_32x32x16_bf16 v[112:127], a[128:131], a[48:51], v[112:127]
  buffer_load_dwordx4 v14, s[20:23], s61 offen offset:2048 lds
  ds_read_b64_tr_b16 a[128:129], v26 offset:53248
  ds_read_b64_tr_b16 a[130:131], v26 offset:53504
  v_mfma_f32_32x32x16_bf16 v[112:127], a[132:135], a[52:55], v[112:127]
  ds_read_b64_tr_b16 a[132:133], v26 offset:54272
  ds_read_b64_tr_b16 a[134:135], v26 offset:54528
  v_mfma_f32_32x32x16_bf16 v[112:127], a[136:139], a[56:59], v[112:127]
  ds_read_b64_tr_b16 a[136:137], v26 offset:55296
  buffer_load_dwordx4 v15, s[20:23], s61 offen offset:3072 lds
  ds_read_b64_tr_b16 a[138:139], v26 offset:55552
  v_mfma_f32_32x32x16_bf16 v[112:127], a[140:143], a[60:63], v[112:127]
  s_bfe_u32 s61, s66, 196612
  ds_read_b64_tr_b16 a[140:141], v26 offset:56320
  ds_read_b64_tr_b16 a[142:143], v26 offset:56576
  ds_read_b128 a[144:147], v39 offset:12288
  ds_read_b128 a[148:151], v39 offset:14336
  s_lshl_b32 s61, s61, 8
  s_addk_i32 s61, 128
  s_waitcnt lgkmcnt(10)
  v_mfma_f32_32x32x16_bf16 v[112:127], a[112:115], a[64:67], v[112:127]
  s_add_u32 m0, s58, 12288
  ds_read_b64_tr_b16 a[112:113], v26 offset:57344
  ds_read_b64_tr_b16 a[114:115], v26 offset:57600
  ds_read_b128 a[152:155], v40 offset:12288
  ds_read_b128 a[156:159], v40 offset:14336
  v_mfma_f32_32x32x16_bf16 v[112:127], a[116:119], a[68:71], v[112:127]
  ds_read_b64_tr_b16 a[116:117], v26 offset:58368
  ds_read_b64_tr_b16 a[118:119], v26 offset:58624
  v_mfma_f32_32x32x16_bf16 v[112:127], a[120:123], a[72:75], v[112:127]
  ds_read_b64_tr_b16 a[120:121], v26 offset:59392
  ds_read_b64_tr_b16 a[122:123], v26 offset:59648
  v_mfma_f32_32x32x16_bf16 v[112:127], a[124:127], a[76:79], v[112:127]
  ds_read_b64_tr_b16 a[124:125], v26 offset:60416
  ds_read_b64_tr_b16 a[126:127], v26 offset:60672
  s_waitcnt vmcnt(14)
  s_barrier
  s_waitcnt lgkmcnt(10)
  v_mfma_f32_32x32x16_bf16 v[112:127], a[128:131], a[80:83], v[112:127]
  ds_read_b64_tr_b16 a[128:129], v26 offset:0
  ds_read_b64_tr_b16 a[130:131], v26 offset:256
  v_mfma_f32_32x32x16_bf16 v[112:127], a[132:135], a[84:87], v[112:127]
  ds_read_b64_tr_b16 a[132:133], v26 offset:1024
  ds_read_b64_tr_b16 a[134:135], v26 offset:1280
  v_mfma_f32_32x32x16_bf16 v[112:127], a[136:139], a[88:91], v[112:127]
  ds_read_b64_tr_b16 a[136:137], v26 offset:2048
  ds_read_b64_tr_b16 a[138:139], v26 offset:2304
  v_mfma_f32_32x32x16_bf16 v[112:127], a[140:143], a[92:95], v[112:127]
  ds_read_b64_tr_b16 a[140:141], v26 offset:3072
  ds_read_b64_tr_b16 a[142:143], v26 offset:3328
  s_waitcnt lgkmcnt(8)
  v_mfma_f32_32x32x16_bf16 v[112:127], a[112:115], a[96:99], v[112:127]
  ds_read_b64_tr_b16 a[112:113], v26 offset:4096
  ds_read_b64_tr_b16 a[114:115], v26 offset:4352
  v_mfma_f32_32x32x16_bf16 v[112:127], a[116:119], a[100:103], v[112:127]
  ds_read_b64_tr_b16 a[116:117], v26 offset:5120
  ds_read_b64_tr_b16 a[118:119], v26 offset:5376
  v_mfma_f32_32x32x16_bf16 v[112:127], a[120:123], a[104:107], v[112:127]
  ds_read_b64_tr_b16 a[120:121], v26 offset:6144
  ds_read_b64_tr_b16 a[122:123], v26 offset:6400
  v_mfma_f32_32x32x16_bf16 v[112:127], a[124:127], a[108:111], v[112:127]
  ds_read_b64_tr_b16 a[124:125], v26 offset:7168
  ds_read_b64_tr_b16 a[126:127], v26 offset:7424
  s_waitcnt vmcnt(12)
  s_barrier
  buffer_load_dwordx4 v12, s[20:23], s61 offen offset:0 lds
  s_waitcnt lgkmcnt(6)
  v_mfma_f32_32x32x16_bf16 v[128:143], a[0:3], a[128:131], 0
  ds_read_b64_tr_b16 a[128:129], v26 offset:8192
  ds_read_b64_tr_b16 a[130:131], v26 offset:8448
  buffer_load_dwordx4 v13, s[20:23], s61 offen offset:1024 lds
  v_mfma_f32_32x32x16_bf16 v[208:223], a[132:135], a[0:3], 0
  ds_read_b64_tr_b16 a[132:133], v26 offset:9216
  v_mov_b32 v57, v124
  v_mov_b32 v1, v124
  v_cvt_pk_bf16_f32 v144, v112, v113
  v_cvt_pk_bf16_f32 v145, v114, v115
  v_cvt_pk_bf16_f32 v146, v116, v117
  v_mfma_f32_32x32x16_bf16 v[128:143], a[4:7], a[136:139], v[128:143]
  v_cvt_pk_bf16_f32 v147, v118, v119
  v_cvt_pk_bf16_f32 v148, v120, v121
  v_cvt_pk_bf16_f32 v149, v122, v123
  v_cvt_pk_bf16_f32 v150, v124, v125
  v_cvt_pk_bf16_f32 v151, v126, v127
  ds_read_b64_tr_b16 a[134:135], v26 offset:9472
  v_mfma_f32_32x32x16_bf16 v[208:223], a[140:143], a[4:7], v[208:223]
  ds_read_b64_tr_b16 a[136:137], v26 offset:10240
  ds_read_b64_tr_b16 a[138:139], v26 offset:10496
  ds_read_b64_tr_b16 a[140:141], v26 offset:11264
  ds_read_b64_tr_b16 a[142:143], v26 offset:11520
  v_mfma_f32_32x32x16_bf16 v[128:143], a[8:11], a[112:115], v[128:143]
  ds_read_b64_tr_b16 a[112:113], v26 offset:12288
  ds_read_b64_tr_b16 a[114:115], v26 offset:12544
  v_permlane32_swap_b32 v1, v57
  s_waitcnt lgkmcnt(8)
  v_mfma_f32_32x32x16_bf16 v[208:223], a[116:119], a[8:11], v[208:223]
  ds_read_b64_tr_b16 a[116:117], v26 offset:13312
  ds_read_b64_tr_b16 a[118:119], v26 offset:13568
  v_mfma_f32_32x32x16_bf16 v[128:143], a[12:15], a[120:123], v[128:143]
  ds_read_b64_tr_b16 a[120:121], v26 offset:14336
  ds_read_b64_tr_b16 a[122:123], v26 offset:14592
  buffer_load_dwordx4 v14, s[20:23], s61 offen offset:2048 lds
  v_mfma_f32_32x32x16_bf16 v[208:223], a[124:127], a[12:15], v[208:223]
  ds_read_b64_tr_b16 a[124:125], v26 offset:15360
  ds_read_b64_tr_b16 a[126:127], v26 offset:15616
  v_mfma_f32_32x32x16_bf16 v[160:175], v[64:67], v[144:147], 0
  v_mfma_f32_32x32x16_bf16 v[160:175], v[68:71], v[148:151], v[160:175]
  v_mfma_f32_32x32x16_bf16 v[128:143], a[16:19], a[128:131], v[128:143]
  s_waitcnt lgkmcnt(2)
  v_mfma_f32_32x32x16_bf16 v[208:223], a[132:135], a[16:19], v[208:223]
  buffer_load_dwordx4 v15, s[20:23], s61 offen offset:3072 lds
  s_add_u32 m0, s59, 65536
  s_bfe_u32 s61, s66, 196616
  v_mfma_f32_32x32x16_bf16 v[128:143], a[20:23], a[136:139], v[128:143]
  s_lshl_b32 s61, s61, 8
  s_addk_i32 s61, 128
  s_nop 2
  v_max3_f32 v62, v160, v161, v162
  v_mfma_f32_32x32x16_bf16 v[208:223], a[140:143], a[20:23], v[208:223]
  v_max3_f32 v63, -v160, -v161, -v162
  v_max3_f32 v62, v62, v163, v164
  v_max3_f32 v63, v63, -v163, -v164
  v_max3_f32 v62, v62, v165, v166
  v_max3_f32 v63, v63, -v165, -v166
  v_mfma_f32_32x32x16_bf16 v[128:143], a[24:27], a[112:115], v[128:143]
  v_max3_f32 v62, v62, v167, v168
  v_max3_f32 v63, v63, -v167, -v168
  v_max3_f32 v62, v62, v169, v170
  v_max3_f32 v63, v63, -v169, -v170
  v_max3_f32 v62, v62, v171, v172
  v_mfma_f32_32x32x16_bf16 v[208:223], a[116:119], a[24:27], v[208:223]
  v_max3_f32 v63, v63, -v171, -v172
  v_max_f32 v62, v62, v173
  v_max_f32_e64 v63, v63, -v173
  v_mov_b32 v175, 0
  v_mfma_f32_32x32x16_bf16 v[128:143], a[28:31], a[120:123], v[128:143]
  v_permlane32_swap_b32 v62, v63
  v_max_f32 v62, v62, v63
  v_mul_f32 v62, 0xbfb8aa3b, v62
  v_mov_b32 v63, v62
  s_waitcnt lgkmcnt(0)
  v_mfma_f32_32x32x16_bf16 v[208:223], a[124:127], a[28:31], v[208:223]
  v_permlane32_swap_b32 v62, v63
  v_fma_f32 v176, v160, s70, v62
  v_fma_f32 v190, -v160, s70, v63
  v_fma_f32 v177, v161, s70, v62
  v_fma_f32 v191, -v161, s70, v63
  v_fma_f32 v178, v162, s70, v62
  v_fma_f32 v192, -v162, s70, v63
  v_fma_f32 v179, v163, s70, v62
  v_fma_f32 v193, -v163, s70, v63
  v_fma_f32 v180, v164, s70, v62
  v_fma_f32 v194, -v164, s70, v63
  v_fma_f32 v181, v165, s70, v62
  v_fma_f32 v195, -v165, s70, v63
  v_fma_f32 v182, v166, s70, v62
  v_fma_f32 v196, -v166, s70, v63
  v_fma_f32 v183, v167, s70, v62
  v_fma_f32 v197, -v167, s70, v63
  v_fma_f32 v184, v168, s70, v62
  v_fma_f32 v198, -v168, s70, v63
  v_fma_f32 v185, v169, s70, v62
  v_fma_f32 v199, -v169, s70, v63
  v_fma_f32 v186, v170, s70, v62
  v_fma_f32 v200, -v170, s70, v63
  v_fma_f32 v187, v171, s70, v62
  v_fma_f32 v201, -v171, s70, v63
  v_fma_f32 v188, v172, s70, v62
  v_fma_f32 v202, -v172, s70, v63
  v_fma_f32 v189, v173, s70, v62
  v_fma_f32 v203, -v173, s70, v63
  v_exp_f32 v176, v176
  v_exp_f32 v190, v190
  v_exp_f32 v177, v177
  v_exp_f32 v191, v191
  v_exp_f32 v178, v178
  s_waitcnt vmcnt(8)
  s_barrier
  s_cmp_lg_u32 s51, 0
  s_cbranch_scc1 Lsf1
  s_atomic_swap s54, s[16:17], s46
Lsf1:
  buffer_load_dwordx4 v19, s[16:19], s92 offen offset:0 sc1 lds
  ds_read_b64_tr_b16 a[128:129], v26 offset:16384
  ds_read_b64_tr_b16 a[130:131], v26 offset:16640
  ds_read_b64_tr_b16 a[132:133], v26 offset:17408
  ds_read_b64_tr_b16 a[134:135], v26 offset:17664
  buffer_load_dwordx4 v19, s[16:19], s92 offen offset:1024 sc1 lds
  ds_read_b64_tr_b16 a[136:137], v26 offset:18432
  ds_read_b64_tr_b16 a[138:139], v26 offset:18688
  ds_read_b64_tr_b16 a[140:141], v26 offset:19456
  ds_read_b64_tr_b16 a[142:143], v26 offset:19712
  ds_read_b64_tr_b16 a[112:113], v26 offset:20480
  ds_read_b64_tr_b16 a[114:115], v26 offset:20736
  ds_read_b64_tr_b16 a[116:117], v26 offset:21504
  s_add_u32 m0, s58, 0
  ds_read_b64_tr_b16 a[118:119], v26 offset:21760
  ds_read_b64_tr_b16 a[120:121], v26 offset:22528
  ds_read_b64_tr_b16 a[122:123], v26 offset:22784
  ds_read_b64_tr_b16 a[124:125], v26 offset:23552
  ds_read_b64_tr_b16 a[126:127], v26 offset:23808
  s_barrier
  s_waitcnt lgkmcnt(14)
  v_mfma_f32_32x32x16_bf16 v[128:143], a[32:35], a[128:131], v[128:143]
  ds_read_b128 a[160:163], v39 offset:0
  ds_read_b128 a[164:167], v39 offset:2048
  v_exp_f32 v192, v192
  v_add_f32 v62, v176, v177
  ds_read_b128 a[168:171], v40 offset:0
  s_waitcnt lgkmcnt(15)
  v_mfma_f32_32x32x16_bf16 v[208:223], a[132:135], a[32:35], v[208:223]
  ds_read_b128 a[172:175], v40 offset:2048
  v_exp_f32 v179, v179
  v_exp_f32 v193, v193
  ds_read_b64_tr_b16 a[128:129], v26 offset:24576
  s_waitcnt lgkmcnt(10)
  v_mfma_f32_32x32x16_bf16 v[128:143], a[36:39], a[136:139], v[128:143]
  ds_read_b64_tr_b16 a[130:131], v26 offset:24832
  ds_read_b64_tr_b16 a[132:133], v26 offset:25600
  ds_read_b64_tr_b16 a[134:135], v26 offset:25856
  ds_read_b64_tr_b16 a[136:137], v26 offset:26624
  v_add_f32 v63, v190, v191
  ds_read_b64_tr_b16 a[138:139], v26 offset:26880
  v_mfma_f32_32x32x16_bf16 v[208:223], a[140:143], a[36:39], v[208:223]
  ds_read_b64_tr_b16 a[140:141], v26 offset:27648
  ds_read_b64_tr_b16 a[142:143], v26 offset:27904
  v_exp_f32 v180, v180
  v_add_f32 v62, v62, v178
  v_mfma_f32_32x32x16_bf16 v[128:143], a[40:43], a[112:115], v[128:143]
  s_waitcnt lgkmcnt(8)
  buffer_load_dwordx4 v12, s[20:23], s61 offen offset:0 lds
  ds_read_b64_tr_b16 a[112:113], v26 offset:28672
  ds_read_b64_tr_b16 a[114:115], v26 offset:28928
  v_mfma_f32_32x32x16_bf16 v[208:223], a[116:119], a[40:43], v[208:223]
  ds_read_b64_tr_b16 a[116:117], v26 offset:29696
  ds_read_b64_tr_b16 a[118:119], v26 offset:29952
  v_exp_f32 v194, v194
  v_add_f32 v63, v63, v192
  v_mfma_f32_32x32x16_bf16 v[128:143], a[44:47], a[120:123], v[128:143]
  ds_read_b64_tr_b16 a[120:121], v26 offset:30720
  ds_read_b64_tr_b16 a[122:123], v26 offset:30976
  v_exp_f32 v181, v181
  v_add_f32 v62, v62, v179
  v_mfma_f32_32x32x16_bf16 v[208:223], a[124:127], a[44:47], v[208:223]
  ds_read_b64_tr_b16 a[124:125], v26 offset:31744
  ds_read_b64_tr_b16 a[126:127], v26 offset:32000
  v_exp_f32 v195, v195
  v_add_f32 v63, v63, v193
  s_waitcnt lgkmcnt(9)
  v_mfma_f32_32x32x16_bf16 v[128:143], a[48:51], a[128:131], v[128:143]
  v_exp_f32 v182, v182
  v_exp_f32 v196, v196
  v_add_f32 v62, v62, v180
  v_mfma_f32_32x32x16_bf16 v[208:223], a[132:135], a[48:51], v[208:223]
  v_exp_f32 v183, v183
  v_exp_f32 v197, v197
  v_add_f32 v63, v63, v194
  v_mfma_f32_32x32x16_bf16 v[128:143], a[52:55], a[136:139], v[128:143]
  v_exp_f32 v184, v184
  v_exp_f32 v198, v198
  v_add_f32 v62, v62, v181
  s_waitcnt lgkmcnt(8)
  v_mfma_f32_32x32x16_bf16 v[208:223], a[140:143], a[52:55], v[208:223]
  v_exp_f32 v185, v185
  v_exp_f32 v199, v199
  v_add_f32 v63, v63, v195
  s_waitcnt lgkmcnt(6)
  v_mfma_f32_32x32x16_bf16 v[128:143], a[56:59], a[112:115], v[128:143]
  v_exp_f32 v186, v186
  v_exp_f32 v200, v200
  v_add_f32 v62, v62, v182
  s_waitcnt lgkmcnt(4)
  v_mfma_f32_32x32x16_bf16 v[208:223], a[116:119], a[56:59], v[208:223]
  v_exp_f32 v187, v187
  v_exp_f32 v201, v201
  v_add_f32 v63, v63, v196
  s_waitcnt lgkmcnt(2)
  v_mfma_f32_32x32x16_bf16 v[128:143], a[60:63], a[120:123], v[128:143]
  v_exp_f32 v188, v188
  v_exp_f32 v202, v202
  v_add_f32 v62, v62, v183
  s_waitcnt lgkmcnt(0)
  v_mfma_f32_32x32x16_bf16 v[208:223], a[124:127], a[60:63], v[208:223]
  v_exp_f32 v189, v189
  v_exp_f32 v203, v203
  buffer_load_dwordx4 v13, s[20:23], s61 offen offset:1024 lds
  v_add_f32 v63, v63, v197
  v_add_f32 v62, v62, v184
  v_add_f32 v63, v63, v198
  v_add_f32 v62, v62, v185
  v_add_f32 v63, v63, v199
  v_add_f32 v62, v62, v186
  v_add_f32 v63, v63, v200
  v_add_f32 v62, v62, v187
  v_add_f32 v63, v63, v201
  v_add_f32 v62, v62, v188
  v_add_f32 v63, v63, v202
  v_add_f32 v62, v62, v189
  v_add_f32 v63, v63, v203
  s_nop 1
  v_permlane32_swap_b32 v62, v63
  v_add_f32 v62, v62, v63
  v_rcp_f32 v62, v62
  s_nop 0
  v_mov_b32 v63, v62
  s_nop 1
  v_permlane32_swap_b32 v62, v63
  v_mul_f32 v176, v176, v62
  v_mul_f32 v177, v177, v62
  v_mul_f32 v178, v178, v62
  v_mul_f32 v179, v179, v62
  v_mul_f32 v180, v180, v62
  v_mul_f32 v181, v181, v62
  v_mul_f32 v182, v182, v62
  v_mul_f32 v183, v183, v62
  v_mul_f32 v184, v184, v62
  v_mul_f32 v185, v185, v62
  v_mul_f32 v186, v186, v62
  v_mul_f32 v187, v187, v62
  v_mul_f32 v188, v188, v62
  v_mul_f32 v189, v189, v62
  v_mul_f32 v190, v190, v63
  buffer_load_dwordx4 v14, s[20:23], s61 offen offset:2048 lds
  v_mul_f32 v191, v191, v63
  v_mul_f32 v192, v192, v63
  v_mul_f32 v193, v193, v63
  v_mul_f32 v194, v194, v63
  v_mul_f32 v195, v195, v63
  v_mul_f32 v196, v196, v63
  v_mul_f32 v197, v197, v63
  v_mul_f32 v198, v198, v63
  v_mul_f32 v199, v199, v63
  v_mul_f32 v200, v200, v63
  v_mul_f32 v201, v201, v63
  v_mul_f32 v202, v202, v63
  v_mul_f32 v203, v203, v63
  v_cvt_pk_bf16_f32 v160, v176, v177
  v_cvt_pk_bf16_f32 v161, v178, v179
  v_cvt_pk_bf16_f32 v162, v180, v181
  v_cvt_pk_bf16_f32 v163, v182, v183
  ds_write_b128 v31, v[160:163] offset:0
  v_cvt_pk_bf16_f32 v164, v184, v185
  v_cvt_pk_bf16_f32 v165, v186, v187
  v_cvt_pk_bf16_f32 v166, v188, v189
  v_mov_b32 v167, 0
  ds_write_b128 v32, v[164:167] offset:0
  v_cvt_pk_bf16_f32 v168, v190, v191
  v_cvt_pk_bf16_f32 v169, v192, v193
  v_cvt_pk_bf16_f32 v170, v194, v195
  v_cvt_pk_bf16_f32 v171, v196, v197
  ds_write_b128 v31, v[168:171] offset:2048
  v_cvt_pk_bf16_f32 v172, v198, v199
  v_cvt_pk_bf16_f32 v173, v200, v201
  v_cvt_pk_bf16_f32 v174, v202, v203
  ds_write_b128 v32, v[172:175] offset:2048
  buffer_load_dwordx4 v15, s[20:23], s61 offen offset:3072 lds
  s_add_u32 m0, s59, 73728
  s_bfe_u32 s61, s66, 196620
  s_lshl_b32 s61, s61, 8
  buffer_load_dwordx4 v19, s[16:19], s93 offen offset:0 sc1 lds
  buffer_load_dwordx4 v19, s[16:19], s93 offen offset:1024 sc1 lds
  s_add_u32 m0, s59, 81920
  s_waitcnt vmcnt(6)
  s_barrier
  s_load_dword s74, s[100:101], 0
  s_load_dword s75, s[100:101], 128
  s_load_dword s76, s[100:101], 256
  s_load_dword s77, s[100:101], 384
  buffer_load_dwordx4 v19, s[16:19], s94 offen offset:0 sc1 lds
  ds_read_b64_tr_b16 a[128:129], v26 offset:0
  ds_read_b64_tr_b16 a[130:131], v26 offset:256
  ds_read_b64_tr_b16 a[132:133], v26 offset:1024
  ds_read_b64_tr_b16 a[134:135], v26 offset:1280
  buffer_load_dwordx4 v19, s[16:19], s94 offen offset:1024 sc1 lds
  ds_read_b128 a[176:179], v39 offset:4096
  ds_read_b128 a[180:183], v39 offset:6144
  ds_read_b128 a[184:187], v40 offset:4096
  s_add_u32 m0, s58, 4096
  ds_read_b128 a[188:191], v40 offset:6144
  ds_read_b64_tr_b16 a[136:137], v26 offset:2048
  ds_read_b64_tr_b16 a[138:139], v26 offset:2304
  ds_read_b64_tr_b16 a[140:141], v26 offset:3072
  ds_read_b64_tr_b16 a[142:143], v26 offset:3328
  s_waitcnt lgkmcnt(10)
  v_mfma_f32_32x32x16_bf16 v[128:143], a[64:67], a[128:131], v[128:143]
  ds_read_b64_tr_b16 a[112:113], v26 offset:4096
  ds_read_b64_tr_b16 a[114:115], v26 offset:4352
  ds_read_b64_tr_b16 a[116:117], v26 offset:5120
  ds_read_b64_tr_b16 a[118:119], v26 offset:5376
  ds_read_b64_tr_b16 a[120:121], v26 offset:6144
  s_waitcnt lgkmcnt(13)
  v_mfma_f32_32x32x16_bf16 v[208:223], a[132:135], a[64:67], v[208:223]
  s_waitcnt lgkmcnt(9)
  buffer_load_dwordx4 v12, s[20:23], s61 offen offset:0 lds
  ds_read_b64_tr_b16 a[122:123], v26 offset:6400
  ds_read_b64_tr_b16 a[124:125], v26 offset:7168
  s_waitcnt lgkmcnt(9)
  v_mfma_f32_32x32x16_bf16 v[128:143], a[68:71], a[136:139], v[128:143]
  buffer_load_dwordx4 v13, s[20:23], s61 offen offset:1024 lds
  ds_read_b64_tr_b16 a[126:127], v26 offset:7424
  s_waitcnt lgkmcnt(8)
  v_mfma_f32_32x32x16_bf16 v[208:223], a[140:143], a[68:71], v[208:223]
  buffer_load_dwordx4 v14, s[20:23], s61 offen offset:2048 lds
  s_waitcnt lgkmcnt(6)
  v_mfma_f32_32x32x16_bf16 v[128:143], a[72:75], a[112:115], v[128:143]
  buffer_load_dwordx4 v15, s[20:23], s61 offen offset:3072 lds
  ds_read_b128 a[192:195], v39 offset:8192
  ds_read_b128 a[196:199], v39 offset:10240
  s_waitcnt lgkmcnt(6)
  v_mfma_f32_32x32x16_bf16 v[208:223], a[116:119], a[72:75], v[208:223]
  s_bfe_u32 s61, s66, 196620
  ds_read_b128 a[200:203], v40 offset:8192
  ds_read_b128 a[204:207], v40 offset:10240
  s_lshl_b32 s61, s61, 8
  s_addk_i32 s61, 128
  s_add_u32 m0, s58, 8192
  s_waitcnt lgkmcnt(6)
  v_mfma_f32_32x32x16_bf16 v[128:143], a[76:79], a[120:123], v[128:143]
  s_waitcnt lgkmcnt(4)
  v_mfma_f32_32x32x16_bf16 v[208:223], a[124:127], a[76:79], v[208:223]
  s_waitcnt lgkmcnt(0)
  s_waitcnt vmcnt(6)
  s_barrier
  buffer_load_dwordx4 v12, s[20:23], s61 offen offset:0 lds
  ds_read_b64_tr_b16 a[128:129], v26 offset:8192
  ds_read_b64_tr_b16 a[130:131], v26 offset:8448
  ds_read_b64_tr_b16 a[132:133], v26 offset:9216
  ds_read_b64_tr_b16 a[134:135], v26 offset:9472
  buffer_load_dwordx4 v13, s[20:23], s61 offen offset:1024 lds
  ds_read_b64_tr_b16 a[136:137], v26 offset:10240
  ds_read_b64_tr_b16 a[138:139], v26 offset:10496
  ds_read_b64_tr_b16 a[140:141], v26 offset:11264
  ds_read_b64_tr_b16 a[142:143], v26 offset:11520
  buffer_load_dwordx4 v14, s[20:23], s61 offen offset:2048 lds
  ds_read_b64_tr_b16 a[112:113], v26 offset:12288
  ds_read_b64_tr_b16 a[114:115], v26 offset:12544
  ds_read_b64_tr_b16 a[116:117], v26 offset:13312
  ds_read_b64_tr_b16 a[118:119], v26 offset:13568
  buffer_load_dwordx4 v15, s[20:23], s61 offen offset:3072 lds
  ds_read_b128 a[208:211], v39 offset:12288
  ds_read_b128 a[212:215], v39 offset:14336
  s_waitcnt lgkmcnt(12)
  v_mfma_f32_32x32x16_bf16 v[128:143], a[80:83], a[128:131], v[128:143]
  s_bfe_u32 s61, s66, 196624
  ds_read_b128 a[216:219], v40 offset:12288
  ds_read_b128 a[220:223], v40 offset:14336
  s_lshl_b32 s61, s61, 8
  s_add_u32 m0, s58, 12288
  s_xor_b32 s74, s74, s54
  ds_read_b64_tr_b16 a[120:121], v26 offset:14336
  s_waitcnt lgkmcnt(13)
  v_mfma_f32_32x32x16_bf16 v[208:223], a[132:135], a[80:83], v[208:223]
  s_xor_b32 s75, s75, s54
  ds_read_b64_tr_b16 a[122:123], v26 offset:14592
  ds_read_b64_tr_b16 a[124:125], v26 offset:15360
  ds_read_b64_tr_b16 a[126:127], v26 offset:15616
  s_xor_b32 s76, s76, s54
  s_xor_b32 s77, s77, s54
  s_or_b32 s74, s74, s75
  s_waitcnt lgkmcnt(12)
  v_mfma_f32_32x32x16_bf16 v[128:143], a[84:87], a[136:139], v[128:143]
  s_or_b32 s74, s74, s76
  s_or_b32 s74, s74, s77
  s_cbranch_scc1 Lslow_fz_4
Lback_fz_4:
  s_waitcnt vmcnt(8)
  s_barrier
  ds_read_b64_tr_b16 a[128:129], v26 offset:16384
  ds_read_b64_tr_b16 a[130:131], v26 offset:16640
  v_mfma_f32_32x32x16_bf16 v[208:223], a[140:143], a[84:87], v[208:223]
  s_waitcnt lgkmcnt(6)
  buffer_load_dwordx4 v12, s[20:23], s61 offen offset:0 lds
  ds_read_b64_tr_b16 a[132:133], v26 offset:17408
  ds_read_b64_tr_b16 a[134:135], v26 offset:17664
  v_mfma_f32_32x32x16_bf16 v[128:143], a[88:91], a[112:115], v[128:143]
  buffer_load_dwordx4 v13, s[20:23], s61 offen offset:1024 lds
  ds_read_b64_tr_b16 a[136:137], v26 offset:18432
  ds_read_b64_tr_b16 a[138:139], v26 offset:18688
  v_mfma_f32_32x32x16_bf16 v[208:223], a[116:119], a[88:91], v[208:223]
  buffer_load_dwordx4 v14, s[20:23], s61 offen offset:2048 lds
  ds_read_b64_tr_b16 a[140:141], v26 offset:19456
  ds_read_b64_tr_b16 a[142:143], v26 offset:19712
  s_waitcnt lgkmcnt(8)
  v_mfma_f32_32x32x16_bf16 v[128:143], a[92:95], a[120:123], v[128:143]
  buffer_load_dwordx4 v15, s[20:23], s61 offen offset:3072 lds
  s_add_u32 m0, s60, 98304
  ds_read_b64_tr_b16 a[112:113], v26 offset:20480
  v_mfma_f32_32x32x16_bf16 v[208:223], a[124:127], a[92:95], v[208:223]
  s_bfe_u32 s61, s66, 196624
  buffer_load_dwordx4 v29, s[16:19], s8 offen offset:0 sc1 lds
  ds_read_b64_tr_b16 a[114:115], v26 offset:20736
  ds_read_b64_tr_b16 a[116:117], v26 offset:21504
  s_waitcnt lgkmcnt(7)
  v_mfma_f32_32x32x16_bf16 v[128:143], a[96:99], a[128:131], v[128:143]
  s_lshl_b32 s61, s61, 8
  ds_read_b64_tr_b16 a[118:119], v26 offset:21760
  ds_read_b64_tr_b16 a[120:121], v26 offset:22528
  buffer_load_dwordx4 v29, s[16:19], s8 offen offset:1024 sc1 lds
  v_mfma_f32_32x32x16_bf16 v[208:223], a[132:135], a[96:99], v[208:223]
  s_addk_i32 s61, 128
  ds_read_b64_tr_b16 a[122:123], v26 offset:22784
  ds_read_b64_tr_b16 a[124:125], v26 offset:23552
  ds_read_b64_tr_b16 a[126:127], v26 offset:23808
  s_waitcnt lgkmcnt(8)
  v_mfma_f32_32x32x16_bf16 v[128:143], a[100:103], a[136:139], v[128:143]
  buffer_load_dwordx4 v29, s[16:19], s8 offen offset:2048 sc1 lds
  v_mfma_f32_32x32x16_bf16 v[208:223], a[140:143], a[100:103], v[208:223]
  s_waitcnt lgkmcnt(6)
  v_mfma_f32_32x32x16_bf16 v[128:143], a[104:107], a[112:115], v[128:143]
  s_waitcnt lgkmcnt(3)
  v_mfma_f32_32x32x16_bf16 v[208:223], a[116:119], a[104:107], v[208:223]
  buffer_load_dwordx4 v29, s[16:19], s8 offen offset:3072 sc1 lds
  s_add_u32 m0, s60, 114688
  s_waitcnt lgkmcnt(0)
  v_mfma_f32_32x32x16_bf16 v[128:143], a[108:111], a[120:123], v[128:143]
  v_mfma_f32_32x32x16_bf16 v[208:223], a[124:127], a[108:111], v[208:223]
  buffer_load_dwordx4 v29, s[16:19], s9 offen offset:0 sc1 lds
  s_nop 9
  v_cvt_pk_bf16_f32 v152, v128, v129
  v_cvt_pk_bf16_f32 v153, v130, v131
  v_cvt_pk_bf16_f32 v154, v132, v133
  v_cvt_pk_bf16_f32 v155, v134, v135
  v_cndmask_b32 v152, v152, v43, s[72:73]
  buffer_load_dwordx4 v29, s[16:19], s9 offen offset:1024 sc1 lds
  v_cndmask_b32 v153, v153, v43, s[72:73]
  v_cndmask_b32 v154, v154, v43, s[72:73]
  v_cndmask_b32 v155, v155, v43, s[72:73]
  ds_write_b128 v42, v[152:155] offset:0
  v_cvt_pk_bf16_f32 v156, v136, v137
  v_cvt_pk_bf16_f32 v157, v138, v139
  v_cvt_pk_bf16_f32 v158, v140, v141
  v_cvt_pk_bf16_f32 v159, v142, v143
  v_cndmask_b32 v156, v156, v43, s[72:73]
  v_cndmask_b32 v157, v157, v43, s[72:73]
  buffer_load_dwordx4 v29, s[16:19], s9 offen offset:2048 sc1 lds
  v_cndmask_b32 v158, v158, v43, s[72:73]
  v_cndmask_b32 v159, v159, v43, s[72:73]
  ds_write_b128 v42, v[156:159] offset:1024
  v_cvt_pk_bf16_f32 v144, v208, v209
  v_cvt_pk_bf16_f32 v145, v210, v211
  v_cvt_pk_bf16_f32 v146, v212, v213
  v_cvt_pk_bf16_f32 v147, v214, v215
  v_cvt_pk_bf16_f32 v148, v216, v217
  v_cvt_pk_bf16_f32 v149, v218, v219
  buffer_load_dwordx4 v29, s[16:19], s9 offen offset:3072 sc1 lds
  v_cvt_pk_bf16_f32 v150, v220, v221
  v_cvt_pk_bf16_f32 v151, v222, v223
  v_mfma_f32_32x32x16_bf16 v[208:223], v[64:67], v[144:147], 0
  s_add_u32 m0, s60, 65536
  v_mfma_f32_32x32x16_bf16 v[208:223], v[68:71], v[148:151], v[208:223]
  s_waitcnt lgkmcnt(0)
  s_barrier
  ds_read_b64_tr_b16 a[128:129], v33 offset:0
  ds_read_b64_tr_b16 a[130:131], v34 offset:0
  ds_read_b128 a[132:135], v41 offset:0
  ds_read_b64_tr_b16 a[136:137], v33 offset:256
  ds_read_b64_tr_b16 a[138:139], v34 offset:256
  ds_read_b128 a[140:143], v41 offset:1024
  buffer_load_dwordx4 v29, s[16:19], s10 offen offset:0 sc1 lds
  ds_read_b64_tr_b16 a[112:113], v33 offset:4096
  ds_read_b64_tr_b16 a[114:115], v34 offset:4096
  ds_read_b128 a[116:119], v41 offset:2048
  ds_read_b64_tr_b16 a[120:121], v33 offset:4352
  ds_read_b64_tr_b16 a[122:123], v34 offset:4352
  ds_read_b128 a[124:127], v41 offset:3072
  buffer_load_dwordx4 v29, s[16:19], s10 offen offset:1024 sc1 lds
  s_waitcnt lgkmcnt(9)
  v_mfma_f32_32x32x16_bf16 v[176:191], a[128:131], a[132:135], 0
  ds_read_b64_tr_b16 a[128:129], v33 offset:8192
  ds_read_b64_tr_b16 a[130:131], v34 offset:8192
  ds_read_b128 a[132:135], v41 offset:4096
  s_waitcnt lgkmcnt(9)
  v_mfma_f32_32x32x16_bf16 v[176:191], a[136:139], a[140:143], v[176:191]
  ds_read_b64_tr_b16 a[136:137], v33 offset:8448
  ds_read_b64_tr_b16 a[138:139], v34 offset:8448
  ds_read_b128 a[140:143], v41 offset:5120
  s_waitcnt lgkmcnt(9)
  v_mfma_f32_32x32x16_bf16 v[176:191], a[112:115], a[116:119], v[176:191]
  ds_read_b64_tr_b16 a[112:113], v33 offset:12288
  ds_read_b64_tr_b16 a[114:115], v34 offset:12288
  ds_read_b128 a[116:119], v41 offset:6144
  s_waitcnt lgkmcnt(9)
  v_mfma_f32_32x32x16_bf16 v[176:191], a[120:123], a[124:127], v[176:191]
  ds_read_b64_tr_b16 a[120:121], v33 offset:12544
  ds_read_b64_tr_b16 a[122:123], v34 offset:12544
  ds_read_b128 a[124:127], v41 offset:7168
  s_waitcnt lgkmcnt(9)
  v_mfma_f32_32x32x16_bf16 v[176:191], a[128:131], a[132:135], v[176:191]
  s_waitcnt lgkmcnt(6)
  v_mfma_f32_32x32x16_bf16 v[176:191], a[136:139], a[140:143], v[176:191]
  s_waitcnt lgkmcnt(3)
  v_mfma_f32_32x32x16_bf16 v[176:191], a[112:115], a[116:119], v[176:191]
  s_waitcnt lgkmcnt(0)
  v_mfma_f32_32x32x16_bf16 v[176:191], a[120:123], a[124:127], v[176:191]
  buffer_load_dwordx4 v29, s[16:19], s10 offen offset:2048 sc1 lds
  s_nop 10
  v_cndmask_b32 v176, v176, v184, s[44:45]
  buffer_load_dwordx4 v29, s[16:19], s10 offen offset:3072 sc1 lds
  v_bfi_b32 v176, v44, s54, v176
  v_cndmask_b32 v177, v177, v185, s[44:45]
  v_bfi_b32 v177, v44, s55, v177
  v_cndmask_b32 v178, v178, v186, s[44:45]
  v_bfi_b32 v178, v44, s56, v178
  v_cndmask_b32 v179, v179, v187, s[44:45]
  v_bfi_b32 v179, v44, s57, v179
  v_cndmask_b32 v180, v180, v188, s[44:45]
  v_bfi_b32 v180, v44, s54, v180
  v_cndmask_b32 v181, v181, v189, s[44:45]
  v_bfi_b32 v181, v44, s55, v181
  v_cndmask_b32 v182, v182, v190, s[44:45]
  buffer_store_dwordx4 v[176:179], v28, s[16:19], s95 offen sc1
  v_bfi_b32 v182, v44, s56, v182
  v_cndmask_b32 v183, v183, v191, s[44:45]
  v_bfi_b32 v183, v44, s57, v183
  s_add_u32 m0, s58, 0
  buffer_store_dwordx4 v[180:183], v49, s[16:19], s95 offen sc1
  ds_read_b128 a[224:227], v39 offset:0
  ds_read_b128 a[228:231], v39 offset:2048
  ds_read_b128 a[232:235], v40 offset:0
  ds_read_b128 a[236:239], v40 offset:2048
  s_waitcnt lgkmcnt(0)
  buffer_load_dwordx4 v12, s[20:23], s61 offen offset:0 lds
  buffer_load_dwordx4 v13, s[20:23], s61 offen offset:1024 lds
  buffer_load_dwordx4 v14, s[20:23], s61 offen offset:2048 lds
  buffer_load_dwordx4 v15, s[20:23], s61 offen offset:3072 lds
  s_waitcnt vmcnt(14)
  s_barrier
  s_add_u32 m0, s60, 81920
  ds_read_b128 a[128:131], v30 offset:32768
  buffer_load_dwordx4 v29, s[16:19], s11 offen offset:0 sc1 lds
  ds_read_b128 a[132:135], v30 offset:33792
  ds_read_b128 a[136:139], v30 offset:34816
  ds_read_b128 a[140:143], v30 offset:35840
  s_bfe_u32 s61, s66, 196628
  s_lshl_b32 s61, s61, 8
  s_mul_i32 s62, s48, 14
  ds_read_b128 a[112:115], v30 offset:36864
  s_add_u32 s62, s62, s52
  s_lshl2_add_u32 s62, s62, s51
  s_lshl_b32 s62, s62, 13
  ds_read_b128 a[116:119], v30 offset:37888
  s_add_u32 s40, s62, 16777216
  s_add_u32 s41, s40, 4096
  s_xor_b32 s42, s40, 0x8000
  ds_read_b128 a[120:123], v30 offset:38912
  s_add_u32 s43, s42, 4096
  s_lshl_b32 s62, s53, 13
  s_add_u32 s62, s62, s59
  ds_read_b128 a[124:127], v30 offset:39936
  s_add_u32 s36, s62, 3145728
  s_waitcnt lgkmcnt(7)
  v_mfma_f32_16x16x32_bf16 v[144:147], a[128:131], a[144:147], 0
  s_lshl2_add_u32 s62, s48, s51
  v_mul_f32 v57, s70, v57
  v_min_f32 v58, 0x42c80000, v57
  v_mfma_f32_16x16x32_bf16 v[148:151], a[128:131], a[148:151], 0
  s_lshl4_add_u32 s62, s62, s53
  ds_read_b128 a[128:131], v30 offset:40960
  v_lshlrev_b32 v50, 3, v0
  s_waitcnt lgkmcnt(7)
  v_mfma_f32_16x16x32_bf16 v[152:155], a[132:135], a[144:147], 0
  s_lshl_b32 s62, s62, 11
  v_exp_f32 v58, v58
  v_mfma_f32_16x16x32_bf16 v[156:159], a[132:135], a[148:151], 0
  s_add_u32 s37, s62, 8388608
  ds_read_b128 a[132:135], v30 offset:41984
  v_add_f32 v58, 1.0, v58
  s_waitcnt lgkmcnt(5)
  v_mfma_f32_16x16x32_bf16 v[160:163], a[136:139], a[144:147], 0
  s_lshl4_add_u32 s62, s48, s53
  v_exp_f32_e64 v57, -v57
  v_mfma_f32_16x16x32_bf16 v[164:167], a[136:139], a[148:151], 0
  s_lshl_b32 s62, s62, 7
  ds_read_b128 a[136:139], v30 offset:43008
  v_add_f32 v57, 1.0, v57
  v_mfma_f32_16x16x32_bf16 v[168:171], a[140:143], a[144:147], 0
  s_add_u32 s38, s62, 131072
  v_rcp_f32 v57, v57
  v_mfma_f32_16x16x32_bf16 v[172:175], a[140:143], a[148:151], 0
  s_lshl_b32 s65, s50, 7
  buffer_load_dwordx4 v29, s[16:19], s11 offen offset:1024 sc1 lds
  v_mfma_f32_16x16x32_bf16 v[144:147], a[112:115], a[152:155], v[144:147]
  s_mul_i32 s62, s51, 14336
  ds_read_b128 a[140:143], v30 offset:44032
  v_mov_b32 v136, v48
  v_mfma_f32_16x16x32_bf16 v[148:151], a[112:115], a[156:159], v[148:151]
  s_add_u32 s62, s62, s65
  ds_read_b128 a[112:115], v30 offset:45056
  s_mov_b32 s65, 172032
  s_waitcnt lgkmcnt(3)
  v_mfma_f32_16x16x32_bf16 v[152:155], a[116:119], a[152:155], v[152:155]
  s_lshr_b32 s92, s51, 1
  v_permlane16_swap_b32 v136, v48
  v_mfma_f32_16x16x32_bf16 v[156:159], a[116:119], a[156:159], v[156:159]
  s_mul_i32 s63, s92, 28672
  ds_read_b128 a[116:119], v30 offset:46080
  v_mov_b32 v137, v136
  v_mfma_f32_16x16x32_bf16 v[160:163], a[120:123], a[152:155], v[160:163]
  s_add_u32 s63, s63, 106496
  v_mov_b32 v138, v136
  v_mov_b32 v139, v136
  v_mfma_f32_16x16x32_bf16 v[164:167], a[120:123], a[156:159], v[164:167]
  buffer_load_dwordx4 v29, s[16:19], s11 offen offset:2048 sc1 lds
  v_mfma_f32_16x16x32_bf16 v[168:171], a[124:127], a[152:155], v[168:171]
  ds_read_b128 a[120:123], v30 offset:47104
  v_mov_b32 v140, v48
  v_mfma_f32_16x16x32_bf16 v[172:175], a[124:127], a[156:159], v[172:175]
  ds_read_b128 a[124:127], v30 offset:48128
  v_mov_b32 v141, v48
  v_mfma_f32_16x16x32_bf16 v[144:147], a[128:131], a[192:195], v[144:147]
  v_mov_b32 v142, v48
  v_mov_b32 v143, v48
  v_mfma_f32_16x16x32_bf16 v[148:151], a[128:131], a[196:199], v[148:151]
  v_add_u32 v45, 155648, v28
  v_add_u32 v46, s59, v45
  v_mfma_f32_16x16x32_bf16 v[152:155], a[132:135], a[192:195], v[152:155]
  v_cmp_eq_u32 s[72:73], 0, v5
  v_max3_f32 v62, v208, v209, v210
  v_mfma_f32_16x16x32_bf16 v[156:159], a[132:135], a[196:199], v[156:159]
  buffer_load_dwordx4 v29, s[16:19], s11 offen offset:3072 sc1 lds
  s_waitcnt lgkmcnt(2)
  v_mfma_f32_16x16x32_bf16 v[160:163], a[136:139], a[192:195], v[160:163]
  s_add_u32 m0, s58, 4096
  ds_read_b128 a[240:243], v39 offset:4096
  ds_read_b128 a[244:247], v39 offset:6144
  v_mfma_f32_16x16x32_bf16 v[164:167], a[136:139], a[196:199], v[164:167]
  ds_read_b128 a[248:251], v40 offset:4096
  s_waitcnt vmcnt(14) lgkmcnt(3)
  s_barrier
  v_mfma_f32_16x16x32_bf16 v[168:171], a[140:143], a[192:195], v[168:171]
  ds_read_b128 a[252:255], v40 offset:6144
  ds_read_b128 a[128:131], v30 offset:49152
  v_mfma_f32_16x16x32_bf16 v[172:175], a[140:143], a[196:199], v[172:175]
  v_max3_f32 v63, -v208, -v209, -v210
  ds_read_b128 a[132:135], v30 offset:50176
  v_mfma_f32_16x16x32_bf16 v[144:147], a[112:115], a[200:203], v[144:147]
  v_max3_f32 v62, v62, v211, v212
  ds_read_b128 a[136:139], v30 offset:51200
  v_mfma_f32_16x16x32_bf16 v[148:151], a[112:115], a[204:207], v[148:151]
  v_max3_f32 v63, v63, -v211, -v212
  ds_read_b128 a[140:143], v30 offset:52224
  v_mfma_f32_16x16x32_bf16 v[152:155], a[116:119], a[200:203], v[152:155]
  v_max3_f32 v62, v62, v213, v214
  ds_read_b128 a[112:115], v30 offset:53248
  v_mfma_f32_16x16x32_bf16 v[156:159], a[116:119], a[204:207], v[156:159]
  v_max3_f32 v63, v63, -v213, -v214
  ds_read_b128 a[116:119], v30 offset:54272
  v_mfma_f32_16x16x32_bf16 v[160:163], a[120:123], a[200:203], v[160:163]
  v_max3_f32 v62, v62, v215, v216
  s_waitcnt lgkmcnt(6)
  buffer_load_dwordx4 v12, s[20:23], s61 offen offset:0 lds
  v_mfma_f32_16x16x32_bf16 v[164:167], a[120:123], a[204:207], v[164:167]
  ds_read_b128 a[120:123], v30 offset:55296
  buffer_load_dwordx4 v13, s[20:23], s61 offen offset:1024 lds
  v_mfma_f32_16x16x32_bf16 v[168:171], a[124:127], a[200:203], v[168:171]
  v_max3_f32 v63, v63, -v215, -v216
  v_max3_f32 v62, v62, v217, v218
  v_mfma_f32_16x16x32_bf16 v[172:175], a[124:127], a[204:207], v[172:175]
  buffer_load_dwordx4 v14, s[20:23], s61 offen offset:2048 lds
  s_waitcnt lgkmcnt(2)
  v_mfma_f32_16x16x32_bf16 v[144:147], a[128:131], a[160:163], v[144:147]
  buffer_load_dwordx4 v15, s[20:23], s61 offen offset:3072 lds
  v_mfma_f32_16x16x32_bf16 v[148:151], a[128:131], a[164:167], v[148:151]
  s_add_u32 m0, s60, 98304
  ds_read_b128 a[124:127], v30 offset:56320
  ds_read_b128 a[128:131], v30 offset:57344
  v_mfma_f32_16x16x32_bf16 v[152:155], a[132:135], a[160:163], v[152:155]
  s_bfe_u32 s61, s66, 196628
  buffer_load_dwordx4 v29, s[16:19], s12 offen offset:0 sc1 lds
  v_mfma_f32_16x16x32_bf16 v[156:159], a[132:135], a[164:167], v[156:159]
  s_lshl_b32 s61, s61, 8
  ds_read_b128 a[132:135], v30 offset:58368
  s_addk_i32 s61, 128
  v_mfma_f32_16x16x32_bf16 v[160:163], a[136:139], a[160:163], v[160:163]
  v_max3_f32 v63, v63, -v217, -v218
  v_max3_f32 v62, v62, v219, v220
  v_mfma_f32_16x16x32_bf16 v[164:167], a[136:139], a[164:167], v[164:167]
  ds_read_b128 a[136:139], v30 offset:59392
  v_max3_f32 v63, v63, -v219, -v220
  v_mfma_f32_16x16x32_bf16 v[168:171], a[140:143], a[160:163], v[168:171]
  v_max_f32 v62, v62, v221
  v_max_f32_e64 v63, v63, -v221
  v_mfma_f32_16x16x32_bf16 v[172:175], a[140:143], a[164:167], v[172:175]
  buffer_load_dwordx4 v29, s[16:19], s12 offen offset:1024 sc1 lds
  v_mfma_f32_16x16x32_bf16 v[144:147], a[112:115], a[168:171], v[144:147]
  ds_read_b128 a[140:143], v30 offset:60416
  v_mov_b32 v223, 0
  v_mfma_f32_16x16x32_bf16 v[148:151], a[112:115], a[172:175], v[148:151]
  ds_read_b128 a[112:115], v30 offset:61440
  v_lshrrev_b32 v1, 3, v0
  s_waitcnt lgkmcnt(4)
  v_mfma_f32_16x16x32_bf16 v[152:155], a[116:119], a[168:171], v[152:155]
  v_permlane32_swap_b32 v62, v63
  v_mfma_f32_16x16x32_bf16 v[156:159], a[116:119], a[172:175], v[156:159]
  ds_read_b128 a[116:119], v30 offset:62464
  v_max_f32 v62, v62, v63
  v_mfma_f32_16x16x32_bf16 v[160:163], a[120:123], a[168:171], v[160:163]
  v_mul_f32 v62, 0xbfb8aa3b, v62
  v_mov_b32 v63, v62
  v_mfma_f32_16x16x32_bf16 v[164:167], a[120:123], a[172:175], v[164:167]
  buffer_load_dwordx4 v29, s[16:19], s12 offen offset:2048 sc1 lds
  v_mfma_f32_16x16x32_bf16 v[168:171], a[124:127], a[168:171], v[168:171]
  ds_read_b128 a[120:123], v30 offset:63488
  v_mul_u32_u24 v1, 896, v1
  v_mfma_f32_16x16x32_bf16 v[172:175], a[124:127], a[172:175], v[172:175]
  ds_read_b128 a[124:127], v30 offset:64512
  v_add_u32 v1, s62, v1
  v_mfma_f32_16x16x32_bf16 v[144:147], a[128:131], a[208:211], v[144:147]
  s_lshl2_add_u32 s62, s48, s51
  v_permlane32_swap_b32 v62, v63
  v_mfma_f32_16x16x32_bf16 v[148:151], a[128:131], a[212:215], v[148:151]
  s_mul_i32 s62, s62, 14
  v_fma_f32 v176, v208, s70, v62
  v_fma_f32 v190, -v208, s70, v63
  s_waitcnt lgkmcnt(3)
  v_mfma_f32_16x16x32_bf16 v[152:155], a[132:135], a[208:211], v[152:155]
  s_add_u32 s62, s62, s52
  v_fma_f32 v177, v209, s70, v62
  v_fma_f32 v191, -v209, s70, v63
  v_mfma_f32_16x16x32_bf16 v[156:159], a[132:135], a[212:215], v[156:159]
  s_lshl_b32 s62, s62, 12
  buffer_load_dwordx4 v29, s[16:19], s12 offen offset:3072 sc1 lds
  v_mfma_f32_16x16x32_bf16 v[160:163], a[136:139], a[208:211], v[160:163]
  s_add_u32 m0, s58, 8192
  ds_read_b128 v[224:227], v39 offset:8192
  ds_read_b128 v[228:231], v39 offset:10240
  v_mfma_f32_16x16x32_bf16 v[164:167], a[136:139], a[212:215], v[164:167]
  s_add_u32 s62, s62, 10485760
  ds_read_b128 v[232:235], v40 offset:8192
  s_waitcnt vmcnt(18) lgkmcnt(3)
  s_barrier
  v_mfma_f32_16x16x32_bf16 v[168:171], a[140:143], a[208:211], v[168:171]
  ds_read_b128 v[236:239], v40 offset:10240
  ds_read_b128 a[128:131], v30 offset:0
  v_mfma_f32_16x16x32_bf16 v[172:175], a[140:143], a[212:215], v[172:175]
  v_fma_f32 v178, v210, s70, v62
  ds_read_b128 a[132:135], v30 offset:1024
  v_mfma_f32_16x16x32_bf16 v[144:147], a[112:115], a[216:219], v[144:147]
  v_fma_f32 v192, -v210, s70, v63
  ds_read_b128 a[136:139], v30 offset:2048
  v_mfma_f32_16x16x32_bf16 v[148:151], a[112:115], a[220:223], v[148:151]
  v_fma_f32 v179, v211, s70, v62
  ds_read_b128 a[140:143], v30 offset:3072
  v_mfma_f32_16x16x32_bf16 v[152:155], a[116:119], a[216:219], v[152:155]
  v_fma_f32 v193, -v211, s70, v63
  ds_read_b128 a[112:115], v30 offset:4096
  v_mfma_f32_16x16x32_bf16 v[156:159], a[116:119], a[220:223], v[156:159]
  v_fma_f32 v180, v212, s70, v62
  ds_read_b128 a[116:119], v30 offset:5120
  v_mfma_f32_16x16x32_bf16 v[160:163], a[120:123], a[216:219], v[160:163]
  v_fma_f32 v194, -v212, s70, v63
  s_waitcnt lgkmcnt(6)
  buffer_load_dwordx4 v12, s[20:23], s61 offen offset:0 lds
  v_mfma_f32_16x16x32_bf16 v[164:167], a[120:123], a[220:223], v[164:167]
  ds_read_b128 a[120:123], v30 offset:6144
  buffer_load_dwordx4 v13, s[20:23], s61 offen offset:1024 lds
  v_mfma_f32_16x16x32_bf16 v[168:171], a[124:127], a[216:219], v[168:171]
  v_fma_f32 v181, v213, s70, v62
  v_fma_f32 v195, -v213, s70, v63
  v_mfma_f32_16x16x32_bf16 v[172:175], a[124:127], a[220:223], v[172:175]
  buffer_load_dwordx4 v14, s[20:23], s61 offen offset:2048 lds
  s_waitcnt lgkmcnt(2)
  v_mfma_f32_16x16x32_bf16 v[144:147], a[128:131], a[176:179], v[144:147]
  buffer_load_dwordx4 v15, s[20:23], s61 offen offset:3072 lds
  v_mfma_f32_16x16x32_bf16 v[148:151], a[128:131], a[180:183], v[148:151]
  s_add_u32 m0, s60, 114688
  ds_read_b128 a[124:127], v30 offset:7168
  ds_read_b128 a[128:131], v30 offset:8192
  v_mfma_f32_16x16x32_bf16 v[152:155], a[132:135], a[176:179], v[152:155]
  s_bfe_u32 s61, s66, 196632
  buffer_load_dwordx4 v29, s[16:19], s13 offen offset:0 sc1 lds
  v_mfma_f32_16x16x32_bf16 v[156:159], a[132:135], a[180:183], v[156:159]
  s_lshl_b32 s61, s61, 8
  ds_read_b128 a[132:135], v30 offset:9216
  v_fma_f32 v182, v214, s70, v62
  v_mfma_f32_16x16x32_bf16 v[160:163], a[136:139], a[176:179], v[160:163]
  v_fma_f32 v196, -v214, s70, v63
  v_fma_f32 v183, v215, s70, v62
  v_mfma_f32_16x16x32_bf16 v[164:167], a[136:139], a[180:183], v[164:167]
  ds_read_b128 a[136:139], v30 offset:10240
  v_fma_f32 v197, -v215, s70, v63
  v_mfma_f32_16x16x32_bf16 v[168:171], a[140:143], a[176:179], v[168:171]
  v_fma_f32 v184, v216, s70, v62
  v_fma_f32 v198, -v216, s70, v63
  v_mfma_f32_16x16x32_bf16 v[172:175], a[140:143], a[180:183], v[172:175]
  buffer_load_dwordx4 v29, s[16:19], s13 offen offset:1024 sc1 lds
  v_mfma_f32_16x16x32_bf16 v[144:147], a[112:115], a[184:187], v[144:147]
  ds_read_b128 a[140:143], v30 offset:11264
  v_fma_f32 v185, v217, s70, v62
  v_mfma_f32_16x16x32_bf16 v[148:151], a[112:115], a[188:191], v[148:151]
  ds_read_b128 a[112:115], v30 offset:12288
  v_fma_f32 v199, -v217, s70, v63
  s_waitcnt lgkmcnt(4)
  v_mfma_f32_16x16x32_bf16 v[152:155], a[116:119], a[184:187], v[152:155]
  v_fma_f32 v186, v218, s70, v62
  v_fma_f32 v200, -v218, s70, v63
  v_mfma_f32_16x16x32_bf16 v[156:159], a[116:119], a[188:191], v[156:159]
  ds_read_b128 a[116:119], v30 offset:13312
  v_fma_f32 v187, v219, s70, v62
  v_mfma_f32_16x16x32_bf16 v[160:163], a[120:123], a[184:187], v[160:163]
  v_fma_f32 v201, -v219, s70, v63
  v_fma_f32 v188, v220, s70, v62
  v_mfma_f32_16x16x32_bf16 v[164:167], a[120:123], a[188:191], v[164:167]
  buffer_load_dwordx4 v29, s[16:19], s13 offen offset:2048 sc1 lds
  v_mfma_f32_16x16x32_bf16 v[168:171], a[124:127], a[184:187], v[168:171]
  ds_read_b128 a[120:123], v30 offset:14336
  v_fma_f32 v202, -v220, s70, v63
  v_mfma_f32_16x16x32_bf16 v[172:175], a[124:127], a[188:191], v[172:175]
  ds_read_b128 a[124:127], v30 offset:15360
  v_fma_f32 v189, v221, s70, v62
  v_mfma_f32_16x16x32_bf16 v[144:147], a[128:131], a[224:227], v[144:147]
  v_fma_f32 v203, -v221, s70, v63
  v_mov_b32 v215, 0
  v_mfma_f32_16x16x32_bf16 v[148:151], a[128:131], a[228:231], v[148:151]
  v_exp_f32 v176, v176
  s_waitcnt lgkmcnt(3)
  v_mfma_f32_16x16x32_bf16 v[152:155], a[132:135], a[224:227], v[152:155]
  v_exp_f32 v190, v190
  v_mfma_f32_16x16x32_bf16 v[156:159], a[132:135], a[228:231], v[156:159]
  buffer_load_dwordx4 v29, s[16:19], s13 offen offset:3072 sc1 lds
  v_mfma_f32_16x16x32_bf16 v[160:163], a[136:139], a[224:227], v[160:163]
  s_add_u32 m0, s58, 12288
  ds_read_b128 v[240:243], v39 offset:12288
  ds_read_b128 v[244:247], v39 offset:14336
  v_mfma_f32_16x16x32_bf16 v[164:167], a[136:139], a[228:231], v[164:167]
  ds_read_b128 v[248:251], v40 offset:12288
  s_waitcnt vmcnt(16) lgkmcnt(3)
  s_barrier
  v_mfma_f32_16x16x32_bf16 v[168:171], a[140:143], a[224:227], v[168:171]
  ds_read_b128 v[252:255], v40 offset:14336
  ds_read_b128 a[128:131], v30 offset:16384
  v_mfma_f32_16x16x32_bf16 v[172:175], a[140:143], a[228:231], v[172:175]
  v_exp_f32 v177, v177
  v_mfma_f32_16x16x32_bf16 v[144:147], a[112:115], a[232:235], v[144:147]
  ds_read_b128 a[132:135], v30 offset:17408
  ds_read_b128 a[136:139], v30 offset:18432
  v_mfma_f32_16x16x32_bf16 v[148:151], a[112:115], a[236:239], v[148:151]
  v_exp_f32 v191, v191
  v_mfma_f32_16x16x32_bf16 v[152:155], a[116:119], a[232:235], v[152:155]
  ds_read_b128 a[140:143], v30 offset:19456
  ds_read_b128 a[112:115], v30 offset:20480
  v_mfma_f32_16x16x32_bf16 v[156:159], a[116:119], a[236:239], v[156:159]
  v_exp_f32 v178, v178
  v_mfma_f32_16x16x32_bf16 v[160:163], a[120:123], a[232:235], v[160:163]
  ds_read_b128 a[116:119], v30 offset:21504
  s_waitcnt lgkmcnt(6)
  buffer_load_dwordx4 v12, s[20:23], s61 offen offset:0 lds
  v_mfma_f32_16x16x32_bf16 v[164:167], a[120:123], a[236:239], v[164:167]
  ds_read_b128 a[120:123], v30 offset:22528
  buffer_load_dwordx4 v13, s[20:23], s61 offen offset:1024 lds
  v_mfma_f32_16x16x32_bf16 v[168:171], a[124:127], a[232:235], v[168:171]
  v_exp_f32 v192, v192
  v_mfma_f32_16x16x32_bf16 v[172:175], a[124:127], a[236:239], v[172:175]
  buffer_load_dwordx4 v14, s[20:23], s61 offen offset:2048 lds
  s_waitcnt lgkmcnt(2)
  v_mfma_f32_16x16x32_bf16 v[144:147], a[128:131], a[240:243], v[144:147]
  buffer_load_dwordx4 v15, s[20:23], s61 offen offset:3072 lds
  v_mfma_f32_16x16x32_bf16 v[148:151], a[128:131], a[244:247], v[148:151]
  s_add_u32 m0, s60, 65536
  ds_read_b128 a[124:127], v30 offset:23552
  ds_read_b128 a[128:131], v30 offset:24576
  v_mfma_f32_16x16x32_bf16 v[152:155], a[132:135], a[240:243], v[152:155]
  s_bfe_u32 s61, s66, 196632
  buffer_load_dwordx4 v29, s[16:19], s14 offen offset:0 sc1 lds
  v_mfma_f32_16x16x32_bf16 v[156:159], a[132:135], a[244:247], v[156:159]
  s_lshl_b32 s61, s61, 8
  ds_read_b128 a[132:135], v30 offset:25600
  s_addk_i32 s61, 128
  v_mfma_f32_16x16x32_bf16 v[160:163], a[136:139], a[240:243], v[160:163]
  v_exp_f32 v179, v179
  v_mfma_f32_16x16x32_bf16 v[164:167], a[136:139], a[244:247], v[164:167]
  ds_read_b128 a[136:139], v30 offset:26624
  v_add_f32 v62, v176, v177
  v_mfma_f32_16x16x32_bf16 v[168:171], a[140:143], a[240:243], v[168:171]
  v_exp_f32 v193, v193
  v_mfma_f32_16x16x32_bf16 v[172:175], a[140:143], a[244:247], v[172:175]
  buffer_load_dwordx4 v29, s[16:19], s14 offen offset:1024 sc1 lds
  v_mfma_f32_16x16x32_bf16 v[144:147], a[112:115], a[248:251], v[144:147]
  ds_read_b128 a[140:143], v30 offset:27648
  v_add_f32 v63, v190, v191
  v_mfma_f32_16x16x32_bf16 v[148:151], a[112:115], a[252:255], v[148:151]
  ds_read_b128 a[112:115], v30 offset:28672
  v_add_f32 v62, v62, v178
  s_waitcnt lgkmcnt(4)
  v_mfma_f32_16x16x32_bf16 v[152:155], a[116:119], a[248:251], v[152:155]
  v_exp_f32 v180, v180
  v_mfma_f32_16x16x32_bf16 v[156:159], a[116:119], a[252:255], v[156:159]
  ds_read_b128 a[116:119], v30 offset:29696
  v_add_f32 v63, v63, v192
  v_mfma_f32_16x16x32_bf16 v[160:163], a[120:123], a[248:251], v[160:163]
  v_exp_f32 v194, v194
  v_mfma_f32_16x16x32_bf16 v[164:167], a[120:123], a[252:255], v[164:167]
  buffer_load_dwordx4 v29, s[16:19], s14 offen offset:2048 sc1 lds
  v_mfma_f32_16x16x32_bf16 v[168:171], a[124:127], a[248:251], v[168:171]
  ds_read_b128 a[120:123], v30 offset:30720
  v_add_f32 v62, v62, v179
  v_mfma_f32_16x16x32_bf16 v[172:175], a[124:127], a[252:255], v[172:175]
  ds_read_b128 a[124:127], v30 offset:31744
  v_add_f32 v63, v63, v193
  v_mfma_f32_16x16x32_bf16 v[144:147], a[128:131], v[224:227], v[144:147]
  v_exp_f32 v181, v181
  v_mfma_f32_16x16x32_bf16 v[148:151], a[128:131], v[228:231], v[148:151]
  v_exp_f32 v195, v195
  s_waitcnt lgkmcnt(3)
  v_mfma_f32_16x16x32_bf16 v[152:155], a[132:135], v[224:227], v[152:155]
  v_exp_f32 v182, v182
  v_mfma_f32_16x16x32_bf16 v[156:159], a[132:135], v[228:231], v[156:159]
  buffer_load_dwordx4 v29, s[16:19], s14 offen offset:3072 sc1 lds
  v_mfma_f32_16x16x32_bf16 v[160:163], a[136:139], v[224:227], v[160:163]
  s_add_u32 m0, s58, 0
  ds_read_b128 a[0:3], v39 offset:0
  ds_read_b128 a[4:7], v39 offset:2048
  v_mfma_f32_16x16x32_bf16 v[164:167], a[136:139], v[228:231], v[164:167]
  ds_read_b128 a[8:11], v40 offset:0
  s_waitcnt vmcnt(16) lgkmcnt(3)
  s_barrier
  v_mfma_f32_16x16x32_bf16 v[168:171], a[140:143], v[224:227], v[168:171]
  ds_read_b128 a[12:15], v40 offset:2048
  ds_read_b128 a[128:131], v30 offset:32768
  v_mfma_f32_16x16x32_bf16 v[172:175], a[140:143], v[228:231], v[172:175]
  v_exp_f32 v196, v196
  v_mfma_f32_16x16x32_bf16 v[144:147], a[112:115], v[232:235], v[144:147]
  ds_read_b128 a[132:135], v30 offset:33792
  ds_read_b128 a[136:139], v30 offset:34816
  v_mfma_f32_16x16x32_bf16 v[148:151], a[112:115], v[236:239], v[148:151]
  v_exp_f32 v183, v183
  v_mfma_f32_16x16x32_bf16 v[152:155], a[116:119], v[232:235], v[152:155]
  ds_read_b128 a[140:143], v30 offset:35840
  ds_read_b128 a[112:115], v30 offset:36864
  v_mfma_f32_16x16x32_bf16 v[156:159], a[116:119], v[236:239], v[156:159]
  v_exp_f32 v197, v197
  v_mfma_f32_16x16x32_bf16 v[160:163], a[120:123], v[232:235], v[160:163]
  ds_read_b128 a[116:119], v30 offset:37888
  s_waitcnt lgkmcnt(6)
  buffer_load_dwordx4 v12, s[20:23], s61 offen offset:0 lds
  v_mfma_f32_16x16x32_bf16 v[164:167], a[120:123], v[236:239], v[164:167]
  ds_read_b128 a[120:123], v30 offset:38912
  buffer_load_dwordx4 v13, s[20:23], s61 offen offset:1024 lds
  v_mfma_f32_16x16x32_bf16 v[168:171], a[124:127], v[232:235], v[168:171]
  v_exp_f32 v184, v184
  v_mfma_f32_16x16x32_bf16 v[172:175], a[124:127], v[236:239], v[172:175]
  buffer_load_dwordx4 v14, s[20:23], s61 offen offset:2048 lds
  s_waitcnt lgkmcnt(2)
  v_mfma_f32_16x16x32_bf16 v[144:147], a[128:131], v[240:243], v[144:147]
  buffer_load_dwordx4 v15, s[20:23], s61 offen offset:3072 lds
  v_mfma_f32_16x16x32_bf16 v[148:151], a[128:131], v[244:247], v[148:151]
  s_bfe_u32 s61, s66, 196636
  ds_read_b128 a[16:19], v39 offset:4096
  ds_read_b128 a[20:23], v39 offset:6144
  v_mfma_f32_16x16x32_bf16 v[152:155], a[132:135], v[240:243], v[152:155]
  s_lshl_b32 s61, s61, 8
  ds_read_b128 a[24:27], v40 offset:4096
  s_add_u32 m0, s58, 4096
  v_mfma_f32_16x16x32_bf16 v[156:159], a[132:135], v[244:247], v[156:159]
  ds_read_b128 a[28:31], v40 offset:6144
  v_add_f32 v62, v62, v180
  v_mfma_f32_16x16x32_bf16 v[160:163], a[136:139], v[240:243], v[160:163]
  ds_read_b128 a[124:127], v30 offset:39936
  v_add_f32 v63, v63, v194
  v_mfma_f32_16x16x32_bf16 v[164:167], a[136:139], v[244:247], v[164:167]
  ds_read_b128 a[128:131], v30 offset:40960
  v_add_f32 v62, v62, v181
  v_mfma_f32_16x16x32_bf16 v[168:171], a[140:143], v[240:243], v[168:171]
  ds_read_b128 a[132:135], v30 offset:41984
  v_add_f32 v63, v63, v195
  v_mfma_f32_16x16x32_bf16 v[172:175], a[140:143], v[244:247], v[172:175]
  ds_read_b128 a[136:139], v30 offset:43008
  v_add_f32 v62, v62, v182
  v_mfma_f32_16x16x32_bf16 v[144:147], a[112:115], v[248:251], v[144:147]
  ds_read_b128 a[140:143], v30 offset:44032
  v_add_f32 v63, v63, v196
  v_mfma_f32_16x16x32_bf16 v[148:151], a[112:115], v[252:255], v[148:151]
  ds_read_b128 a[112:115], v30 offset:45056
  s_waitcnt lgkmcnt(6)
  buffer_load_dwordx4 v12, s[20:23], s61 offen offset:0 lds
  v_mfma_f32_16x16x32_bf16 v[152:155], a[116:119], v[248:251], v[152:155]
  v_exp_f32 v198, v198
  v_mfma_f32_16x16x32_bf16 v[156:159], a[116:119], v[252:255], v[156:159]
  buffer_load_dwordx4 v13, s[20:23], s61 offen offset:1024 lds
  v_mfma_f32_16x16x32_bf16 v[160:163], a[120:123], v[248:251], v[160:163]
  ds_read_b128 a[116:119], v30 offset:46080
  buffer_load_dwordx4 v14, s[20:23], s61 offen offset:2048 lds
  v_mfma_f32_16x16x32_bf16 v[164:167], a[120:123], v[252:255], v[164:167]
  ds_read_b128 a[120:123], v30 offset:47104
  v_add_f32 v62, v62, v183
  s_waitcnt lgkmcnt(3)
  v_mfma_f32_16x16x32_bf16 v[168:171], a[124:127], v[248:251], v[168:171]
  buffer_load_dwordx4 v15, s[20:23], s61 offen offset:3072 lds
  v_mfma_f32_16x16x32_bf16 v[172:175], a[124:127], v[252:255], v[172:175]
  s_bfe_u32 s61, s66, 196636
  s_waitcnt vmcnt(20)
  ds_read_b128 a[32:35], v39 offset:8192
  v_mfma_f32_16x16x32_bf16 v[144:147], a[128:131], a[0:3], v[144:147]
  s_lshl_b32 s61, s61, 8
  ds_read_b128 a[36:39], v39 offset:10240
  ds_read_b128 a[40:43], v40 offset:8192
  v_mfma_f32_16x16x32_bf16 v[148:151], a[128:131], a[4:7], v[148:151]
  s_addk_i32 s61, 128
  ds_read_b128 a[44:47], v40 offset:10240
  s_add_u32 m0, s58, 8192
  v_mfma_f32_16x16x32_bf16 v[152:155], a[132:135], a[0:3], v[152:155]
  ds_read_b128 a[124:127], v30 offset:48128
  v_add_f32 v63, v63, v197
  v_mfma_f32_16x16x32_bf16 v[156:159], a[132:135], a[4:7], v[156:159]
  v_exp_f32 v185, v185
  v_mfma_f32_16x16x32_bf16 v[160:163], a[136:139], a[0:3], v[160:163]
  v_exp_f32 v199, v199
  v_mfma_f32_16x16x32_bf16 v[164:167], a[136:139], a[4:7], v[164:167]
  v_exp_f32 v186, v186
  v_mfma_f32_16x16x32_bf16 v[168:171], a[140:143], a[0:3], v[168:171]
  v_exp_f32 v200, v200
  v_mfma_f32_16x16x32_bf16 v[172:175], a[140:143], a[4:7], v[172:175]
  v_exp_f32 v187, v187
  s_waitcnt lgkmcnt(2)
  v_mfma_f32_16x16x32_bf16 v[144:147], a[112:115], a[8:11], v[144:147]
  s_waitcnt lgkmcnt(1)
  buffer_load_dwordx4 v12, s[20:23], s61 offen offset:0 lds
  v_mfma_f32_16x16x32_bf16 v[148:151], a[112:115], a[12:15], v[148:151]
  s_waitcnt vmcnt(17) lgkmcnt(0)
  s_barrier
  buffer_load_dwordx4 v13, s[20:23], s61 offen offset:1024 lds
  v_mfma_f32_16x16x32_bf16 v[152:155], a[116:119], a[8:11], v[152:155]
  ds_read_b128 a[128:131], v30 offset:49152
  ds_read_b128 a[132:135], v30 offset:50176
  v_mfma_f32_16x16x32_bf16 v[156:159], a[116:119], a[12:15], v[156:159]
  buffer_load_dwordx4 v14, s[20:23], s61 offen offset:2048 lds
  v_mfma_f32_16x16x32_bf16 v[160:163], a[120:123], a[8:11], v[160:163]
  ds_read_b128 a[136:139], v30 offset:51200
  buffer_load_dwordx4 v15, s[20:23], s61 offen offset:3072 lds
  v_mfma_f32_16x16x32_bf16 v[164:167], a[120:123], a[12:15], v[164:167]
  s_add_u32 m0, s60, 81920
  ds_read_b128 a[140:143], v30 offset:52224
  ds_read_b128 a[112:115], v30 offset:53248
  v_mfma_f32_16x16x32_bf16 v[168:171], a[124:127], a[8:11], v[168:171]
  buffer_load_dwordx4 v29, s[16:19], s15 offen offset:0 sc1 lds
  v_mfma_f32_16x16x32_bf16 v[172:175], a[124:127], a[12:15], v[172:175]
  ds_read_b128 a[116:119], v30 offset:54272
  ds_read_b128 a[120:123], v30 offset:55296
  s_waitcnt lgkmcnt(6)
  v_mfma_f32_16x16x32_bf16 v[144:147], a[128:131], a[16:19], v[144:147]
  ds_read_b128 a[124:127], v30 offset:56320
  v_add_f32 v62, v62, v184
  v_mfma_f32_16x16x32_bf16 v[148:151], a[128:131], a[20:23], v[148:151]
  ds_read_b128 a[128:131], v30 offset:57344
  v_add_f32 v63, v63, v198
  s_waitcnt lgkmcnt(7)
  v_mfma_f32_16x16x32_bf16 v[152:155], a[132:135], a[16:19], v[152:155]
  v_exp_f32 v201, v201
  v_mfma_f32_16x16x32_bf16 v[156:159], a[132:135], a[20:23], v[156:159]
  buffer_load_dwordx4 v29, s[16:19], s15 offen offset:1024 sc1 lds
  s_waitcnt lgkmcnt(4)
  v_mfma_f32_16x16x32_bf16 v[160:163], a[136:139], a[16:19], v[160:163]
  ds_read_b128 a[132:135], v30 offset:58368
  v_add_f32 v62, v62, v185
  v_mfma_f32_16x16x32_bf16 v[164:167], a[136:139], a[20:23], v[164:167]
  ds_read_b128 a[136:139], v30 offset:59392
  v_add_f32 v63, v63, v199
  v_mfma_f32_16x16x32_bf16 v[168:171], a[140:143], a[16:19], v[168:171]
  v_exp_f32 v188, v188
  v_mfma_f32_16x16x32_bf16 v[172:175], a[140:143], a[20:23], v[172:175]
  buffer_load_dwordx4 v29, s[16:19], s15 offen offset:2048 sc1 lds
  v_mfma_f32_16x16x32_bf16 v[144:147], a[112:115], a[24:27], v[144:147]
  ds_read_b128 a[140:143], v30 offset:60416
  v_add_f32 v62, v62, v186
  v_mfma_f32_16x16x32_bf16 v[148:151], a[112:115], a[28:31], v[148:151]
  ds_read_b128 a[112:115], v30 offset:61440
  v_add_f32 v63, v63, v200
  s_waitcnt lgkmcnt(4)
  v_mfma_f32_16x16x32_bf16 v[152:155], a[116:119], a[24:27], v[152:155]
  v_exp_f32 v202, v202
  v_mfma_f32_16x16x32_bf16 v[156:159], a[116:119], a[28:31], v[156:159]
  buffer_load_dwordx4 v29, s[16:19], s15 offen offset:3072 sc1 lds
  v_mfma_f32_16x16x32_bf16 v[160:163], a[120:123], a[24:27], v[160:163]
  s_add_u32 m0, s60, 98304
  ds_read_b128 a[116:119], v30 offset:62464
  v_add_f32 v62, v62, v187
  v_mfma_f32_16x16x32_bf16 v[164:167], a[120:123], a[28:31], v[164:167]
  ds_read_b128 a[120:123], v30 offset:63488
  v_add_f32 v63, v63, v201
  v_mfma_f32_16x16x32_bf16 v[168:171], a[124:127], a[24:27], v[168:171]
  v_exp_f32 v189, v189
  v_mfma_f32_16x16x32_bf16 v[172:175], a[124:127], a[28:31], v[172:175]
  buffer_load_dwordx4 v8, s[16:19], s8 offen offset:0 sc1 lds
  v_mfma_f32_16x16x32_bf16 v[144:147], a[128:131], a[32:35], v[144:147]
  ds_read_b128 a[124:127], v30 offset:64512
  v_add_f32 v62, v62, v188
  v_mfma_f32_16x16x32_bf16 v[148:151], a[128:131], a[36:39], v[148:151]
  v_exp_f32 v203, v203
  s_waitcnt lgkmcnt(3)
  v_mfma_f32_16x16x32_bf16 v[152:155], a[132:135], a[32:35], v[152:155]
  v_add_f32 v63, v63, v202
  v_add_f32 v62, v62, v189
  v_mfma_f32_16x16x32_bf16 v[156:159], a[132:135], a[36:39], v[156:159]
  buffer_load_dwordx4 v8, s[16:19], s8 offen offset:1024 sc1 lds
  v_mfma_f32_16x16x32_bf16 v[160:163], a[136:139], a[32:35], v[160:163]
  s_waitcnt vmcnt(22)
  ds_read_b128 a[48:51], v39 offset:12288
  ds_read_b128 a[52:55], v39 offset:14336
  v_mfma_f32_16x16x32_bf16 v[164:167], a[136:139], a[36:39], v[164:167]
  ds_read_b128 a[56:59], v40 offset:12288
  v_add_f32 v63, v63, v203
  v_mfma_f32_16x16x32_bf16 v[168:171], a[140:143], a[32:35], v[168:171]
  ds_read_b128 a[60:63], v40 offset:14336
  s_waitcnt vmcnt(18) lgkmcnt(4)
  s_barrier
  v_mfma_f32_16x16x32_bf16 v[172:175], a[140:143], a[36:39], v[172:175]
  buffer_load_dwordx4 v8, s[16:19], s8 offen offset:2048 sc1 lds
  v_mfma_f32_16x16x32_bf16 v[144:147], a[112:115], a[40:43], v[144:147]
  s_waitcnt vmcnt(15)
  ds_read_b128 a[64:67], v39 offset:0
  ds_read_b128 a[68:71], v39 offset:2048
  v_mfma_f32_16x16x32_bf16 v[148:151], a[112:115], a[44:47], v[148:151]
  ds_read_b128 a[72:75], v40 offset:0
  v_cvt_pk_bf16_f32 v208, v176, v177
  v_mfma_f32_16x16x32_bf16 v[152:155], a[116:119], a[40:43], v[152:155]
  ds_read_b128 a[76:79], v40 offset:2048
  v_cvt_pk_bf16_f32 v209, v178, v179
  v_mfma_f32_16x16x32_bf16 v[156:159], a[116:119], a[44:47], v[156:159]
  buffer_load_dwordx4 v8, s[16:19], s8 offen offset:3072 sc1 lds
  v_mfma_f32_16x16x32_bf16 v[160:163], a[120:123], a[40:43], v[160:163]
  s_add_u32 m0, s60, 114688
  ds_read_b128 a[128:131], v30 offset:0
  buffer_load_dwordx4 v8, s[16:19], s9 offen offset:0 sc1 lds
  v_mfma_f32_16x16x32_bf16 v[164:167], a[120:123], a[44:47], v[164:167]
  ds_read_b128 a[132:135], v30 offset:1024
  ds_read_b128 a[136:139], v30 offset:2048
  v_mfma_f32_16x16x32_bf16 v[168:171], a[124:127], a[40:43], v[168:171]
  ds_read_b128 a[140:143], v30 offset:3072
  v_mov_b32 v179, s54
  v_mfma_f32_16x16x32_bf16 v[172:175], a[124:127], a[44:47], v[172:175]
  ds_read_b128 a[112:115], v30 offset:4096
  v_cvt_pk_bf16_f32 v210, v180, v181
  ds_read_b128 a[116:119], v30 offset:5120
  ds_read_b128 a[120:123], v30 offset:6144
  s_waitcnt lgkmcnt(6)
  v_mfma_f32_16x16x32_bf16 v[144:147], a[128:131], a[48:51], v[144:147]
  ds_read_b128 a[124:127], v30 offset:7168
  v_cvt_pk_bf16_f32 v211, v182, v183
  v_mfma_f32_16x16x32_bf16 v[148:151], a[128:131], a[52:55], v[148:151]
  ds_read_b128 a[128:131], v30 offset:8192
  v_mov_b32 v183, s54
  s_waitcnt lgkmcnt(7)
  v_mfma_f32_16x16x32_bf16 v[152:155], a[132:135], a[48:51], v[152:155]
  v_permlane32_swap_b32 v62, v63
  v_mfma_f32_16x16x32_bf16 v[156:159], a[132:135], a[52:55], v[156:159]
  ds_read_b128 a[132:135], v30 offset:9216
  v_add_f32 v62, v62, v63
  s_waitcnt lgkmcnt(6)
  v_mfma_f32_16x16x32_bf16 v[160:163], a[136:139], a[48:51], v[160:163]
  v_mov_b32 v63, v62
  v_cvt_pk_bf16_f32 v212, v184, v185
  v_mfma_f32_16x16x32_bf16 v[164:167], a[136:139], a[52:55], v[164:167]
  ds_read_b128 a[136:139], v30 offset:10240
  v_cvt_pk_bf16_f32 v213, v186, v187
  v_mfma_f32_16x16x32_bf16 v[168:171], a[140:143], a[48:51], v[168:171]
  v_mov_b32 v187, s54
  v_cvt_pk_bf16_f32 v214, v188, v189
  v_mfma_f32_16x16x32_bf16 v[172:175], a[140:143], a[52:55], v[172:175]
  buffer_load_dwordx4 v8, s[16:19], s9 offen offset:1024 sc1 lds
  s_waitcnt lgkmcnt(2)
  v_mfma_f32_16x16x32_bf16 v[144:147], a[112:115], a[56:59], v[144:147]
  ds_read_b128 a[140:143], v30 offset:11264
  v_lshrrev_b32 v2, 2, v0
  v_mfma_f32_16x16x32_bf16 v[148:151], a[112:115], a[60:63], v[148:151]
  ds_read_b128 a[112:115], v30 offset:12288
  v_and_b32 v2, 4, v2
  v_mfma_f32_16x16x32_bf16 v[152:155], a[116:119], a[56:59], v[152:155]
  v_permlane32_swap_b32 v62, v63
  v_mfma_f32_16x16x32_bf16 v[156:159], a[116:119], a[60:63], v[156:159]
  ds_read_b128 a[116:119], v30 offset:13312
  v_mov_b32 v59, v62
  v_mfma_f32_16x16x32_bf16 v[160:163], a[120:123], a[56:59], v[160:163]
  v_rcp_f32 v63, v63
  v_mfma_f32_16x16x32_bf16 v[164:167], a[120:123], a[60:63], v[164:167]
  ds_read_b128 a[120:123], v30 offset:14336
  v_mul_f32 v63, v63, v62
  v_mfma_f32_16x16x32_bf16 v[168:171], a[124:127], a[56:59], v[168:171]
  v_mul_f32 v190, v190, v63
  v_mul_f32 v191, v191, v63
  v_mfma_f32_16x16x32_bf16 v[172:175], a[124:127], a[60:63], v[172:175]
  buffer_load_dwordx4 v8, s[16:19], s9 offen offset:2048 sc1 lds
  v_mfma_f32_16x16x32_bf16 v[144:147], a[128:131], a[64:67], v[144:147]
  ds_read_b128 a[124:127], v30 offset:15360
  v_mul_f32 v192, v192, v63
  v_mfma_f32_16x16x32_bf16 v[148:151], a[128:131], a[68:71], v[148:151]
  v_mul_f32 v193, v193, v63
  v_mul_f32 v194, v194, v63
  s_waitcnt lgkmcnt(3)
  v_mfma_f32_16x16x32_bf16 v[152:155], a[132:135], a[64:67], v[152:155]
  v_mul_f32 v195, v195, v63
  v_mul_f32 v196, v196, v63
  v_mfma_f32_16x16x32_bf16 v[156:159], a[132:135], a[68:71], v[156:159]
  s_waitcnt vmcnt(15)
  ds_read_b128 a[80:83], v39 offset:4096
  ds_read_b128 a[84:87], v39 offset:6144
  v_mfma_f32_16x16x32_bf16 v[160:163], a[136:139], a[64:67], v[160:163]
  ds_read_b128 a[88:91], v40 offset:4096
  v_mul_f32 v197, v197, v63
  v_mfma_f32_16x16x32_bf16 v[164:167], a[136:139], a[68:71], v[164:167]
  ds_read_b128 a[92:95], v40 offset:6144
  v_mul_f32 v198, v198, v63
  v_mfma_f32_16x16x32_bf16 v[168:171], a[140:143], a[64:67], v[168:171]
  s_waitcnt vmcnt(11)
  ds_read_b128 a[96:99], v39 offset:8192
  s_waitcnt vmcnt(7) lgkmcnt(5)
  s_barrier
  v_mfma_f32_16x16x32_bf16 v[172:175], a[140:143], a[68:71], v[172:175]
  buffer_load_dwordx4 v8, s[16:19], s9 offen offset:3072 sc1 lds
  v_mfma_f32_16x16x32_bf16 v[144:147], a[112:115], a[72:75], v[144:147]
  s_add_u32 m0, s60, 65536
  ds_read_b128 a[100:103], v39 offset:10240
  ds_read_b128 a[104:107], v40 offset:8192
  v_mfma_f32_16x16x32_bf16 v[148:151], a[112:115], a[76:79], v[148:151]
  ds_read_b128 a[108:111], v40 offset:10240
  buffer_load_dwordx4 v8, s[16:19], s10 offen offset:0 sc1 lds
  v_mfma_f32_16x16x32_bf16 v[152:155], a[116:119], a[72:75], v[152:155]
  ds_read_b128 a[128:131], v30 offset:16384
  ds_read_b128 a[132:135], v30 offset:17408
  v_mfma_f32_16x16x32_bf16 v[156:159], a[116:119], a[76:79], v[156:159]
  ds_read_b128 a[136:139], v30 offset:18432
  v_mul_f32 v199, v199, v63
  v_mfma_f32_16x16x32_bf16 v[160:163], a[120:123], a[72:75], v[160:163]
  ds_read_b128 a[140:143], v30 offset:19456
  v_mul_f32 v200, v200, v63
  v_mfma_f32_16x16x32_bf16 v[164:167], a[120:123], a[76:79], v[164:167]
  ds_read_b128 a[112:115], v30 offset:20480
  v_mul_f32 v201, v201, v63
  v_mfma_f32_16x16x32_bf16 v[168:171], a[124:127], a[72:75], v[168:171]
  ds_read_b128 a[116:119], v30 offset:21504
  v_mul_f32 v202, v202, v63
  v_mfma_f32_16x16x32_bf16 v[172:175], a[124:127], a[76:79], v[172:175]
  ds_read_b128 a[120:123], v30 offset:22528
  v_mul_f32 v203, v203, v63
  ds_read_b128 a[124:127], v30 offset:23552
  s_waitcnt lgkmcnt(7)
  v_mfma_f32_16x16x32_bf16 v[144:147], a[128:131], a[80:83], v[144:147]
  v_cvt_pk_bf16_f32 v216, v190, v191
  v_mov_b32 v191, s54
  v_mfma_f32_16x16x32_bf16 v[148:151], a[128:131], a[84:87], v[148:151]
  ds_read_b128 a[128:131], v30 offset:24576
  v_cvt_pk_bf16_f32 v217, v192, v193
  s_waitcnt lgkmcnt(6)
  v_mfma_f32_16x16x32_bf16 v[152:155], a[132:135], a[80:83], v[152:155]
  v_cvt_pk_bf16_f32 v218, v194, v195
  v_mov_b32 v195, s54
  v_mfma_f32_16x16x32_bf16 v[156:159], a[132:135], a[84:87], v[156:159]
  ds_read_b128 a[132:135], v30 offset:25600
  v_cvt_pk_bf16_f32 v219, v196, v197
  v_mfma_f32_16x16x32_bf16 v[160:163], a[136:139], a[80:83], v[160:163]
  v_mov_b32 v197, s54
  v_cvt_pk_bf16_f32 v220, v198, v199
  v_mfma_f32_16x16x32_bf16 v[164:167], a[136:139], a[84:87], v[164:167]
  ds_read_b128 a[136:139], v30 offset:26624
  v_cvt_pk_bf16_f32 v221, v200, v201
  s_waitcnt lgkmcnt(3)
  v_mfma_f32_16x16x32_bf16 v[168:171], a[140:143], a[80:83], v[168:171]
  v_cvt_pk_bf16_f32 v222, v202, v203
  v_xor_b32 v2, v0, v2
  v_mfma_f32_16x16x32_bf16 v[172:175], a[140:143], a[84:87], v[172:175]
  buffer_load_dwordx4 v8, s[16:19], s10 offen offset:1024 sc1 lds
  v_mfma_f32_16x16x32_bf16 v[144:147], a[112:115], a[88:91], v[144:147]
  ds_read_b128 a[140:143], v30 offset:27648
  v_and_b32 v2, 7, v2
  v_mfma_f32_16x16x32_bf16 v[148:151], a[112:115], a[92:95], v[148:151]
  ds_read_b128 a[112:115], v30 offset:28672
  v_lshl_add_u32 v16, v2, 4, v1
  v_mfma_f32_16x16x32_bf16 v[152:155], a[116:119], a[88:91], v[152:155]
  v_add_u32 v17, 6144, v16
  v_lshl_add_u32 v1, v5, 2, v3
  v_mfma_f32_16x16x32_bf16 v[156:159], a[116:119], a[92:95], v[156:159]
  ds_read_b128 a[116:119], v30 offset:29696
  v_lshl_add_u32 v24, v1, 7, v4
  v_mfma_f32_16x16x32_bf16 v[160:163], a[120:123], a[88:91], v[160:163]
  v_and_b32 v1, 2, v3
  v_lshl_add_u32 v24, v1, 5, v24
  v_mfma_f32_16x16x32_bf16 v[164:167], a[120:123], a[92:95], v[164:167]
  ds_read_b128 a[120:123], v30 offset:30720
  v_add_u32 v24, s63, v24
  v_mfma_f32_16x16x32_bf16 v[168:171], a[124:127], a[88:91], v[168:171]
  s_mul_i32 s63, s92, 57344
  v_xor_b32 v25, 64, v24
  v_lshlrev_b32 v1, 9, v5
  v_mfma_f32_16x16x32_bf16 v[172:175], a[124:127], a[92:95], v[172:175]
  buffer_load_dwordx4 v8, s[16:19], s10 offen offset:2048 sc1 lds
  s_waitcnt lgkmcnt(3)
  v_mfma_f32_16x16x32_bf16 v[144:147], a[128:131], a[96:99], v[144:147]
  ds_read_b128 a[124:127], v30 offset:31744
  v_sub_u32 v33, v24, v1
  v_mfma_f32_16x16x32_bf16 v[148:151], a[128:131], a[100:103], v[148:151]
  v_sub_u32 v34, v25, v1
  v_lshl_add_u32 v1, v5, 3, v3
  v_mfma_f32_16x16x32_bf16 v[152:155], a[132:135], a[96:99], v[152:155]
  v_lshl_add_u32 v31, v1, 7, v4
  v_and_b32 v1, 2, v3
  v_mfma_f32_16x16x32_bf16 v[156:159], a[132:135], a[100:103], v[156:159]
  v_lshl_add_u32 v31, v1, 5, v31
  v_add_u32 v31, s63, v31
  v_mfma_f32_16x16x32_bf16 v[160:163], a[136:139], a[96:99], v[160:163]
  s_mul_i32 s63, s92, 896
  v_xor_b32 v32, 64, v31
  v_and_b32 v1, 48, v0
  v_mfma_f32_16x16x32_bf16 v[164:167], a[136:139], a[100:103], v[164:167]
  v_lshl_add_u32 v1, v1, 4, v28
  v_add_u32 v18, s62, v1
  v_mfma_f32_16x16x32_bf16 v[168:171], a[140:143], a[96:99], v[168:171]
  s_lshl_b32 s62, s48, 11
  s_add_u32 s63, s63, s62
  s_waitcnt vmcnt(7) lgkmcnt(0)
  s_barrier
  v_mfma_f32_16x16x32_bf16 v[172:175], a[140:143], a[100:103], v[172:175]
  s_add_u32 s93, s63, 65536
  buffer_load_dwordx4 v8, s[16:19], s10 offen offset:3072 sc1 lds
  v_mfma_f32_16x16x32_bf16 v[144:147], a[112:115], a[104:107], v[144:147]
  s_add_u32 m0, s60, 81920
  ds_read_b128 a[128:131], v30 offset:32768
  ds_read_b128 a[132:135], v30 offset:33792
  v_mfma_f32_16x16x32_bf16 v[148:151], a[112:115], a[108:111], v[148:151]
  s_lshl_b32 s63, s92, 10
  ds_read_b128 a[136:139], v30 offset:34816
  s_add_u32 s62, s62, s63
  v_mfma_f32_16x16x32_bf16 v[152:155], a[116:119], a[104:107], v[152:155]
  s_add_u32 s62, s62, 131072
  v_cvt_pk_bf16_f32 v176, v144, v145
  v_cvt_pk_bf16_f32 v177, v146, v147
  v_mfma_f32_16x16x32_bf16 v[156:159], a[116:119], a[108:111], v[156:159]
  s_mov_b32 s3, s62
  v_cvt_pk_bf16_f32 v178, v148, v149
  buffer_store_dwordx4 v[176:179], v28, s[16:19], s42 offen offset:0 sc1
  v_mfma_f32_16x16x32_bf16 v[160:163], a[120:123], a[104:107], v[160:163]
  s_add_u32 s100, s16, s62
  s_addc_u32 s101, s17, 0
  v_cvt_pk_bf16_f32 v180, v150, v151
  v_mfma_f32_16x16x32_bf16 v[164:167], a[120:123], a[108:111], v[164:167]
  s_and_b32 s62, s51, 1
  v_cvt_pk_bf16_f32 v181, v152, v153
  v_cvt_pk_bf16_f32 v182, v154, v155
  v_mfma_f32_16x16x32_bf16 v[168:171], a[124:127], a[104:107], v[168:171]
  s_lshl1_add_u32 s62, s49, s62
  ds_read_b128 a[140:143], v30 offset:35840
  ds_read_b128 a[112:115], v30 offset:36864
  v_mfma_f32_16x16x32_bf16 v[172:175], a[124:127], a[108:111], v[172:175]
  s_lshl2_add_u32 s62, s48, s62
  v_cvt_pk_bf16_f32 v184, v156, v157
  v_cvt_pk_bf16_f32 v185, v158, v159
  s_waitcnt lgkmcnt(2)
  v_mfma_f32_16x16x32_bf16 v[112:115], a[128:131], a[144:147], v[136:139]
  s_lshl1_add_u32 s62, s62, s92
  v_cvt_pk_bf16_f32 v186, v160, v161
  ds_read_b128 a[116:119], v30 offset:37888
  v_mfma_f32_16x16x32_bf16 v[116:119], a[128:131], a[148:151], v[140:143]
  s_lshl_b32 s98, s62, 14
  ds_read_b128 a[120:123], v30 offset:38912
  ds_read_b128 a[124:127], v30 offset:39936
  v_mfma_f32_16x16x32_bf16 v[120:123], a[132:135], a[144:147], v[136:139]
  s_add_u32 s98, s98, 8388608
  ds_read_b128 a[128:131], v30 offset:40960
  v_cvt_pk_bf16_f32 v188, v162, v163
  v_mfma_f32_16x16x32_bf16 v[124:127], a[132:135], a[148:151], v[140:143]
  s_mul_i32 s99, s62, 28672
  ds_read_b128 a[132:135], v30 offset:41984
  v_cvt_pk_bf16_f32 v189, v164, v165
  v_mfma_f32_16x16x32_bf16 v[128:131], a[136:139], a[144:147], v[136:139]
  s_add_u32 s99, s99, 10485760
  v_cvt_pk_bf16_f32 v190, v166, v167
  v_cvt_pk_bf16_f32 v192, v168, v169
  v_mfma_f32_16x16x32_bf16 v[132:135], a[136:139], a[148:151], v[140:143]
  buffer_store_dwordx4 v[180:183], v28, s[16:19], s42 offen offset:1024 sc1
  s_waitcnt lgkmcnt(4)
  v_mfma_f32_16x16x32_bf16 v[136:139], a[140:143], a[144:147], v[136:139]
  ds_read_b128 a[136:139], v30 offset:43008
  v_cvt_pk_bf16_f32 v193, v170, v171
  v_mfma_f32_16x16x32_bf16 v[140:143], a[140:143], a[148:151], v[140:143]
  ds_read_b128 a[140:143], v30 offset:44032
  v_cvt_pk_bf16_f32 v194, v172, v173
  v_mfma_f32_16x16x32_bf16 v[112:115], a[112:115], a[152:155], v[112:115]
  v_cvt_pk_bf16_f32 v196, v174, v175
  v_mul_f32 v64, v104, v104
  v_mfma_f32_16x16x32_bf16 v[116:119], a[112:115], a[156:159], v[116:119]
  buffer_store_dwordx4 v[184:187], v28, s[16:19], s42 offen offset:2048 sc1
  v_mfma_f32_16x16x32_bf16 v[120:123], a[116:119], a[152:155], v[120:123]
  ds_read_b128 a[112:115], v30 offset:45056
  v_fma_f32 v64, v64, v61, v60
  v_mfma_f32_16x16x32_bf16 v[124:127], a[116:119], a[156:159], v[124:127]
  ds_read_b128 a[116:119], v30 offset:46080
  v_mul_f32 v64, v64, v104
  s_waitcnt lgkmcnt(3)
  v_mfma_f32_16x16x32_bf16 v[128:131], a[120:123], a[152:155], v[128:131]
  v_rcp_f32 v47, v58
  v_mfma_f32_16x16x32_bf16 v[132:135], a[120:123], a[156:159], v[132:135]
  buffer_load_dwordx4 v8, s[16:19], s11 offen offset:0 sc1 lds
  v_mfma_f32_16x16x32_bf16 v[136:139], a[124:127], a[152:155], v[136:139]
  ds_read_b128 a[120:123], v30 offset:47104
  v_mul_f32 v80, v80, v47
  v_mfma_f32_16x16x32_bf16 v[140:143], a[124:127], a[156:159], v[140:143]
  ds_read_b128 a[124:127], v30 offset:48128
  v_mul_f32 v81, v81, v47
  v_mfma_f32_16x16x32_bf16 v[112:115], a[128:131], a[192:195], v[112:115]
  v_mul_f32 v82, v82, v47
  v_mul_f32 v83, v83, v47
  v_mfma_f32_16x16x32_bf16 v[116:119], a[128:131], a[196:199], v[116:119]
  v_mul_f32 v84, v84, v47
  v_mul_f32 v85, v85, v47
  v_mfma_f32_16x16x32_bf16 v[120:123], a[132:135], a[192:195], v[120:123]
  v_mul_f32 v86, v86, v47
  v_mul_f32 v87, v87, v47
  v_mfma_f32_16x16x32_bf16 v[124:127], a[132:135], a[196:199], v[124:127]
  buffer_load_dwordx4 v8, s[16:19], s11 offen offset:1024 sc1 lds
  v_mfma_f32_16x16x32_bf16 v[128:131], a[136:139], a[192:195], v[128:131]
  v_mul_f32 v88, v88, v47
  v_mul_f32 v89, v89, v47
  v_mfma_f32_16x16x32_bf16 v[132:135], a[136:139], a[196:199], v[132:135]
  s_waitcnt vmcnt(9) lgkmcnt(0)
  s_barrier
  ds_read_b128 a[128:131], v30 offset:49152
  v_mfma_f32_16x16x32_bf16 v[136:139], a[140:143], a[192:195], v[136:139]
  ds_read_b128 a[132:135], v30 offset:50176
  ds_read_b128 a[136:139], v30 offset:51200
  v_mfma_f32_16x16x32_bf16 v[140:143], a[140:143], a[196:199], v[140:143]
  buffer_load_dwordx4 v8, s[16:19], s11 offen offset:2048 sc1 lds
  v_mfma_f32_16x16x32_bf16 v[112:115], a[112:115], a[200:203], v[112:115]
  ds_read_b128 a[140:143], v30 offset:52224
  v_mul_f32 v90, v90, v47
  v_mfma_f32_16x16x32_bf16 v[116:119], a[112:115], a[204:207], v[116:119]
  ds_read_b128 a[112:115], v30 offset:53248
  v_mul_f32 v91, v91, v47
  v_mfma_f32_16x16x32_bf16 v[120:123], a[116:119], a[200:203], v[120:123]
  v_mul_f32 v92, v92, v47
  v_mul_f32 v93, v93, v47
  v_mfma_f32_16x16x32_bf16 v[124:127], a[116:119], a[204:207], v[124:127]
  buffer_load_dwordx4 v8, s[16:19], s11 offen offset:3072 sc1 lds
  v_mfma_f32_16x16x32_bf16 v[128:131], a[120:123], a[200:203], v[128:131]
  s_add_u32 m0, s60, 98304
  ds_read_b128 a[116:119], v30 offset:54272
  buffer_load_dwordx4 v8, s[16:19], s12 offen offset:0 sc1 lds
  v_mfma_f32_16x16x32_bf16 v[132:135], a[120:123], a[204:207], v[132:135]
  ds_read_b128 a[120:123], v30 offset:55296
  v_mul_f32 v94, v94, v47
  v_mfma_f32_16x16x32_bf16 v[136:139], a[124:127], a[200:203], v[136:139]
  v_mul_f32 v95, v95, v47
  v_mul_f32 v96, v96, v47
  v_mfma_f32_16x16x32_bf16 v[140:143], a[124:127], a[204:207], v[140:143]
  ds_read_b128 a[124:127], v30 offset:56320
  v_mul_f32 v97, v97, v47
  s_waitcnt lgkmcnt(3)
  v_mfma_f32_16x16x32_bf16 v[112:115], a[128:131], a[160:163], v[112:115]
  v_mul_f32 v98, v98, v47
  v_mul_f32 v99, v99, v47
  v_mfma_f32_16x16x32_bf16 v[116:119], a[128:131], a[164:167], v[116:119]
  ds_read_b128 a[128:131], v30 offset:57344
  v_mul_f32 v100, v100, v47
  v_mfma_f32_16x16x32_bf16 v[120:123], a[132:135], a[160:163], v[120:123]
  v_mul_f32 v101, v101, v47
  v_mul_f32 v102, v102, v47
  v_mfma_f32_16x16x32_bf16 v[124:127], a[132:135], a[164:167], v[124:127]
  ds_read_b128 a[132:135], v30 offset:58368
  v_mul_f32 v103, v103, v47
  v_mfma_f32_16x16x32_bf16 v[128:131], a[136:139], a[160:163], v[128:131]
  v_exp_f32 v64, v64
  v_mfma_f32_16x16x32_bf16 v[132:135], a[136:139], a[164:167], v[132:135]
  buffer_load_dwordx4 v8, s[16:19], s12 offen offset:1024 sc1 lds
  v_mfma_f32_16x16x32_bf16 v[136:139], a[140:143], a[160:163], v[136:139]
  ds_read_b128 a[136:139], v30 offset:59392
  v_fma_f32 v64, v64, v58, v58
  v_mfma_f32_16x16x32_bf16 v[140:143], a[140:143], a[164:167], v[140:143]
  ds_read_b128 a[140:143], v30 offset:60416
  v_mul_f32 v65, v105, v105
  v_mfma_f32_16x16x32_bf16 v[112:115], a[112:115], a[168:171], v[112:115]
  v_rcp_f32 v64, v64
  v_mfma_f32_16x16x32_bf16 v[116:119], a[112:115], a[172:175], v[116:119]
  ds_read_b128 a[112:115], v30 offset:61440
  v_mul_f32 v104, v104, v64
  s_waitcnt lgkmcnt(4)
  v_mfma_f32_16x16x32_bf16 v[120:123], a[116:119], a[168:171], v[120:123]
  v_fma_f32 v65, v65, v61, v60
  v_mul_f32 v65, v65, v105
  v_mfma_f32_16x16x32_bf16 v[124:127], a[116:119], a[172:175], v[124:127]
  buffer_load_dwordx4 v8, s[16:19], s12 offen offset:2048 sc1 lds
  v_mfma_f32_16x16x32_bf16 v[128:131], a[120:123], a[168:171], v[128:131]
  ds_read_b128 a[116:119], v30 offset:62464
  v_mul_f32 v66, v106, v106
  v_mfma_f32_16x16x32_bf16 v[132:135], a[120:123], a[172:175], v[132:135]
  ds_read_b128 a[120:123], v30 offset:63488
  v_fma_f32 v66, v66, v61, v60
  v_mfma_f32_16x16x32_bf16 v[136:139], a[124:127], a[168:171], v[136:139]
  v_exp_f32 v65, v65
  v_mfma_f32_16x16x32_bf16 v[140:143], a[124:127], a[172:175], v[140:143]
  buffer_load_dwordx4 v8, s[16:19], s12 offen offset:3072 sc1 lds
  v_mfma_f32_16x16x32_bf16 v[112:115], a[128:131], a[208:211], v[112:115]
  s_add_u32 m0, s59, 131072
  ds_read_b128 a[124:127], v30 offset:64512
  v_fma_f32 v65, v65, v58, v58
  v_mfma_f32_16x16x32_bf16 v[116:119], a[128:131], a[212:215], v[116:119]
  v_rcp_f32 v65, v65
  s_waitcnt lgkmcnt(3)
  v_mfma_f32_16x16x32_bf16 v[120:123], a[132:135], a[208:211], v[120:123]
  v_mul_f32 v105, v105, v65
  v_mul_f32 v66, v66, v106
  v_mfma_f32_16x16x32_bf16 v[124:127], a[132:135], a[212:215], v[124:127]
  v_exp_f32 v66, v66
  v_mfma_f32_16x16x32_bf16 v[128:131], a[136:139], a[208:211], v[128:131]
  v_fma_f32 v66, v66, v58, v58
  v_mul_f32 v67, v107, v107
  v_mfma_f32_16x16x32_bf16 v[132:135], a[136:139], a[212:215], v[132:135]
  buffer_load_dwordx4 v16, s[24:27], s65 offen offset:0 lds
  v_mfma_f32_16x16x32_bf16 v[136:139], a[140:143], a[208:211], v[136:139]
  s_waitcnt vmcnt(12) lgkmcnt(0)
  s_barrier
  ds_read_b128 a[128:131], v30 offset:0
  v_mfma_f32_16x16x32_bf16 v[140:143], a[140:143], a[212:215], v[140:143]
  ds_read_b128 a[132:135], v30 offset:1024
  ds_read_b128 a[136:139], v30 offset:2048
  v_mfma_f32_16x16x32_bf16 v[112:115], a[112:115], a[216:219], v[112:115]
  ds_read_b128 a[140:143], v30 offset:3072
  v_fma_f32 v67, v67, v61, v60
  v_mfma_f32_16x16x32_bf16 v[116:119], a[112:115], a[220:223], v[116:119]
  ds_read_b128 a[112:115], v30 offset:4096
  v_mul_f32 v67, v67, v107
  v_mfma_f32_16x16x32_bf16 v[120:123], a[116:119], a[216:219], v[120:123]
  v_rcp_f32 v66, v66
  v_mfma_f32_16x16x32_bf16 v[124:127], a[116:119], a[220:223], v[124:127]
  buffer_load_dwordx4 v17, s[24:27], s65 offen offset:1024 lds
  v_mfma_f32_16x16x32_bf16 v[128:131], a[120:123], a[216:219], v[128:131]
  s_add_u32 m0, s59, 155648
  ds_read_b128 a[116:119], v30 offset:5120
  buffer_store_dwordx4 v[188:191], v28, s[16:19], s42 offen offset:3072 sc1
  v_mfma_f32_16x16x32_bf16 v[132:135], a[120:123], a[220:223], v[132:135]
  s_mov_b32 s65, 344064
  ds_read_b128 a[120:123], v30 offset:6144
  v_mul_f32 v106, v106, v66
  v_mfma_f32_16x16x32_bf16 v[136:139], a[124:127], a[216:219], v[136:139]
  v_exp_f32 v67, v67
  v_mfma_f32_16x16x32_bf16 v[140:143], a[124:127], a[220:223], v[140:143]
  ds_read_b128 a[124:127], v30 offset:7168
  v_fma_f32 v67, v67, v58, v58
  s_waitcnt lgkmcnt(3)
  v_mfma_f32_16x16x32_bf16 v[112:115], a[128:131], a[176:179], v[112:115]
  v_rcp_f32 v67, v67
  v_mfma_f32_16x16x32_bf16 v[116:119], a[128:131], a[180:183], v[116:119]
  ds_read_b128 a[128:131], v30 offset:8192
  v_mul_f32 v107, v107, v67
  v_mfma_f32_16x16x32_bf16 v[120:123], a[132:135], a[176:179], v[120:123]
  v_mul_f32 v68, v108, v108
  v_fma_f32 v68, v68, v61, v60
  v_mfma_f32_16x16x32_bf16 v[124:127], a[132:135], a[180:183], v[124:127]
  ds_read_b128 a[132:135], v30 offset:9216
  v_mul_f32 v68, v68, v108
  v_mfma_f32_16x16x32_bf16 v[128:131], a[136:139], a[176:179], v[128:131]
  v_exp_f32 v68, v68
  v_mfma_f32_16x16x32_bf16 v[132:135], a[136:139], a[180:183], v[132:135]
  ds_read_b128 a[136:139], v30 offset:10240
  v_fma_f32 v68, v68, v58, v58
  v_mfma_f32_16x16x32_bf16 v[136:139], a[140:143], a[176:179], v[136:139]
  v_rcp_f32 v68, v68
  v_mfma_f32_16x16x32_bf16 v[140:143], a[140:143], a[180:183], v[140:143]
  buffer_store_dwordx4 v[192:195], v28, s[16:19], s43 offen offset:0 sc1
  v_mfma_f32_16x16x32_bf16 v[112:115], a[112:115], a[184:187], v[112:115]
  ds_read_b128 a[140:143], v30 offset:11264
  v_mul_f32 v108, v108, v68
  v_mfma_f32_16x16x32_bf16 v[116:119], a[112:115], a[188:191], v[116:119]
  ds_read_b128 a[112:115], v30 offset:12288
  v_mul_f32 v69, v109, v109
  s_waitcnt lgkmcnt(3)
  v_mfma_f32_16x16x32_bf16 v[120:123], a[116:119], a[184:187], v[120:123]
  v_fma_f32 v69, v69, v61, v60
  v_mul_f32 v69, v69, v109
  v_mfma_f32_16x16x32_bf16 v[124:127], a[116:119], a[188:191], v[124:127]
  ds_read_b128 a[116:119], v30 offset:13312
  v_mul_f32 v70, v110, v110
  v_mfma_f32_16x16x32_bf16 v[128:131], a[120:123], a[184:187], v[128:131]
  v_exp_f32 v69, v69
  v_mfma_f32_16x16x32_bf16 v[132:135], a[120:123], a[188:191], v[132:135]
  buffer_store_dwordx2 v[196:197], v50, s[16:19], s43 offen offset:1024 sc1
  v_mfma_f32_16x16x32_bf16 v[136:139], a[124:127], a[184:187], v[136:139]
  ds_read_b128 a[120:123], v30 offset:14336
  v_fma_f32 v69, v69, v58, v58
  v_mfma_f32_16x16x32_bf16 v[140:143], a[124:127], a[188:191], v[140:143]
  ds_read_b128 a[124:127], v30 offset:15360
  v_fma_f32 v70, v70, v61, v60
  v_mfma_f32_16x16x32_bf16 v[112:115], a[128:131], a[224:227], v[112:115]
  v_rcp_f32 v69, v69
  v_mfma_f32_16x16x32_bf16 v[116:119], a[128:131], a[228:231], v[116:119]
  v_mul_f32 v109, v109, v69
  v_mul_f32 v70, v70, v110
  v_mfma_f32_16x16x32_bf16 v[120:123], a[132:135], a[224:227], v[120:123]
  v_exp_f32 v70, v70
  v_mfma_f32_16x16x32_bf16 v[124:127], a[132:135], a[228:231], v[124:127]
  buffer_load_dwordx4 v28, s[16:19], s36 offen offset:0 sc1 lds
  s_waitcnt lgkmcnt(2)
  v_mfma_f32_16x16x32_bf16 v[128:131], a[136:139], a[224:227], v[128:131]
  v_fma_f32 v70, v70, v58, v58
  v_mul_f32 v71, v111, v111
  v_mfma_f32_16x16x32_bf16 v[132:135], a[136:139], a[228:231], v[132:135]
  s_waitcnt vmcnt(10) lgkmcnt(0)
  s_barrier
  ds_read_b128 a[128:131], v30 offset:16384
  v_mfma_f32_16x16x32_bf16 v[136:139], a[140:143], a[224:227], v[136:139]
  ds_read_b128 a[132:135], v30 offset:17408
  ds_read_b128 a[136:139], v30 offset:18432
  v_mfma_f32_16x16x32_bf16 v[140:143], a[140:143], a[228:231], v[140:143]
  ds_read_b128 a[140:143], v30 offset:19456
  v_fma_f32 v71, v71, v61, v60
  v_mfma_f32_16x16x32_bf16 v[112:115], a[112:115], a[232:235], v[112:115]
  v_rcp_f32 v70, v70
  v_mfma_f32_16x16x32_bf16 v[116:119], a[112:115], a[236:239], v[116:119]
  buffer_load_dwordx4 v28, s[16:19], s36 offen offset:1024 sc1 lds
  v_mfma_f32_16x16x32_bf16 v[120:123], a[116:119], a[232:235], v[120:123]
  s_add_u32 m0, s60, 114688
  ds_read_b128 a[112:115], v30 offset:20480
  buffer_load_dwordx4 v8, s[16:19], s13 offen offset:0 sc1 lds
  v_mfma_f32_16x16x32_bf16 v[124:127], a[116:119], a[236:239], v[124:127]
  ds_read_b128 a[116:119], v30 offset:21504
  v_mul_f32 v110, v110, v70
  v_mfma_f32_16x16x32_bf16 v[128:131], a[120:123], a[232:235], v[128:131]
  v_mul_f32 v71, v71, v111
  v_mfma_f32_16x16x32_bf16 v[132:135], a[120:123], a[236:239], v[132:135]
  ds_read_b128 a[120:123], v30 offset:22528
  v_mfma_f32_16x16x32_bf16 v[136:139], a[124:127], a[232:235], v[136:139]
  v_exp_f32 v71, v71
  v_mfma_f32_16x16x32_bf16 v[140:143], a[124:127], a[236:239], v[140:143]
  ds_read_b128 a[124:127], v30 offset:23552
  v_fma_f32 v71, v71, v58, v58
  s_waitcnt lgkmcnt(4)
  v_mfma_f32_16x16x32_bf16 v[112:115], a[128:131], a[240:243], v[112:115]
  v_rcp_f32 v71, v71
  v_mfma_f32_16x16x32_bf16 v[116:119], a[128:131], a[244:247], v[116:119]
  ds_read_b128 a[128:131], v30 offset:24576
  v_mul_f32 v111, v111, v71
  v_mfma_f32_16x16x32_bf16 v[120:123], a[132:135], a[240:243], v[120:123]
  v_permlane16_swap_b32 v80, v84
  v_mfma_f32_16x16x32_bf16 v[124:127], a[132:135], a[244:247], v[124:127]
  buffer_load_dwordx4 v8, s[16:19], s13 offen offset:1024 sc1 lds
  v_mfma_f32_16x16x32_bf16 v[128:131], a[136:139], a[240:243], v[128:131]
  ds_read_b128 a[132:135], v30 offset:25600
  v_mfma_f32_16x16x32_bf16 v[132:135], a[136:139], a[244:247], v[132:135]
  ds_read_b128 a[136:139], v30 offset:26624
  v_mfma_f32_16x16x32_bf16 v[136:139], a[140:143], a[240:243], v[136:139]
  v_permlane16_swap_b32 v81, v85
  v_mfma_f32_16x16x32_bf16 v[140:143], a[140:143], a[244:247], v[140:143]
  buffer_load_dwordx4 v8, s[16:19], s13 offen offset:2048 sc1 lds
  s_waitcnt lgkmcnt(2)
  v_mfma_f32_16x16x32_bf16 v[112:115], a[112:115], a[248:251], v[112:115]
  ds_read_b128 a[140:143], v30 offset:27648
  v_mfma_f32_16x16x32_bf16 v[116:119], a[112:115], a[252:255], v[116:119]
  ds_read_b128 a[112:115], v30 offset:28672
  v_mfma_f32_16x16x32_bf16 v[120:123], a[116:119], a[248:251], v[120:123]
  v_permlane16_swap_b32 v82, v86
  v_mfma_f32_16x16x32_bf16 v[124:127], a[116:119], a[252:255], v[124:127]
  buffer_load_dwordx4 v8, s[16:19], s13 offen offset:3072 sc1 lds
  v_mfma_f32_16x16x32_bf16 v[128:131], a[120:123], a[248:251], v[128:131]
  s_add_u32 m0, s60, 65536
  ds_read_b128 a[116:119], v30 offset:29696
  v_mfma_f32_16x16x32_bf16 v[132:135], a[120:123], a[252:255], v[132:135]
  ds_read_b128 a[120:123], v30 offset:30720
  v_mfma_f32_16x16x32_bf16 v[136:139], a[124:127], a[248:251], v[136:139]
  v_permlane16_swap_b32 v83, v87
  v_mfma_f32_16x16x32_bf16 v[140:143], a[124:127], a[252:255], v[140:143]
  buffer_load_dwordx4 v8, s[16:19], s14 offen offset:0 sc1 lds
  v_mfma_f32_16x16x32_bf16 v[112:115], a[128:131], v[224:227], v[112:115]
  ds_read_b128 a[124:127], v30 offset:31744
  v_mfma_f32_16x16x32_bf16 v[116:119], a[128:131], v[228:231], v[116:119]
  v_permlane16_swap_b32 v88, v92
  s_waitcnt lgkmcnt(3)
  v_mfma_f32_16x16x32_bf16 v[120:123], a[132:135], v[224:227], v[120:123]
  v_permlane16_swap_b32 v89, v93
  v_mfma_f32_16x16x32_bf16 v[124:127], a[132:135], v[228:231], v[124:127]
  buffer_load_dwordx4 v8, s[16:19], s14 offen offset:1024 sc1 lds
  v_mfma_f32_16x16x32_bf16 v[128:131], a[136:139], v[224:227], v[128:131]
  v_permlane16_swap_b32 v90, v94
  v_mfma_f32_16x16x32_bf16 v[132:135], a[136:139], v[228:231], v[132:135]
  v_permlane16_swap_b32 v91, v95
  v_mfma_f32_16x16x32_bf16 v[136:139], a[140:143], v[224:227], v[136:139]
  s_waitcnt vmcnt(13) lgkmcnt(0)
  s_barrier
  ds_read_b128 a[128:131], v30 offset:32768
  v_mfma_f32_16x16x32_bf16 v[140:143], a[140:143], v[228:231], v[140:143]
  buffer_load_dwordx4 v8, s[16:19], s14 offen offset:2048 sc1 lds
  v_mfma_f32_16x16x32_bf16 v[112:115], a[112:115], v[232:235], v[112:115]
  ds_read_b128 a[132:135], v30 offset:33792
  ds_read_b128 a[136:139], v30 offset:34816
  v_mfma_f32_16x16x32_bf16 v[116:119], a[112:115], v[236:239], v[116:119]
  ds_read_b128 a[140:143], v30 offset:35840
  v_mfma_f32_16x16x32_bf16 v[120:123], a[116:119], v[232:235], v[120:123]
  ds_read_b128 a[112:115], v30 offset:36864
  v_mfma_f32_16x16x32_bf16 v[124:127], a[116:119], v[236:239], v[124:127]
  buffer_load_dwordx4 v8, s[16:19], s14 offen offset:3072 sc1 lds
  v_mfma_f32_16x16x32_bf16 v[128:131], a[120:123], v[232:235], v[128:131]
  s_add_u32 m0, s60, 81920
  ds_read_b128 a[116:119], v30 offset:37888
  buffer_load_dwordx4 v8, s[16:19], s15 offen offset:0 sc1 lds
  v_mfma_f32_16x16x32_bf16 v[132:135], a[120:123], v[236:239], v[132:135]
  ds_read_b128 a[120:123], v30 offset:38912
  v_mfma_f32_16x16x32_bf16 v[136:139], a[124:127], v[232:235], v[136:139]
  v_permlane16_swap_b32 v96, v100
  v_mfma_f32_16x16x32_bf16 v[140:143], a[124:127], v[236:239], v[140:143]
  ds_read_b128 a[124:127], v30 offset:39936
  s_waitcnt lgkmcnt(4)
  v_mfma_f32_16x16x32_bf16 v[112:115], a[128:131], v[240:243], v[112:115]
  v_permlane16_swap_b32 v97, v101
  v_mfma_f32_16x16x32_bf16 v[116:119], a[128:131], v[244:247], v[116:119]
  ds_read_b128 a[128:131], v30 offset:40960
  v_mfma_f32_16x16x32_bf16 v[120:123], a[132:135], v[240:243], v[120:123]
  v_permlane16_swap_b32 v98, v102
  v_mfma_f32_16x16x32_bf16 v[124:127], a[132:135], v[244:247], v[124:127]
  ds_read_b128 a[132:135], v30 offset:41984
  s_waitcnt vmcnt(9)
  ds_read_b32 v52, v46 offset:8
  v_mfma_f32_16x16x32_bf16 v[128:131], a[136:139], v[240:243], v[128:131]
  ds_read_b32 v56, v46 offset:1032
  v_mfma_f32_16x16x32_bf16 v[132:135], a[136:139], v[244:247], v[132:135]
  ds_read_b128 a[136:139], v30 offset:43008
  v_mfma_f32_16x16x32_bf16 v[136:139], a[140:143], v[240:243], v[136:139]
  v_permlane16_swap_b32 v99, v103
  v_mfma_f32_16x16x32_bf16 v[140:143], a[140:143], v[244:247], v[140:143]
  buffer_load_dwordx4 v8, s[16:19], s15 offen offset:1024 sc1 lds
  s_waitcnt lgkmcnt(4)
  v_mfma_f32_16x16x32_bf16 v[112:115], a[112:115], v[248:251], v[112:115]
  ds_read_b128 a[140:143], v30 offset:44032
  v_mfma_f32_16x16x32_bf16 v[116:119], a[112:115], v[252:255], v[116:119]
  ds_read_b128 a[112:115], v30 offset:45056
  s_waitcnt lgkmcnt(4)
  v_xor_b32 v52, s54, v52
  v_mfma_f32_16x16x32_bf16 v[120:123], a[116:119], v[248:251], v[120:123]
  s_waitcnt lgkmcnt(3)
  v_bitop3_b32 v52, v56, s54, v52 bitop3:0xbe
  v_cmp_ne_u32 vcc, 0, v52
  v_mfma_f32_16x16x32_bf16 v[124:127], a[116:119], v[252:255], v[124:127]
  ds_read_b128 a[116:119], v30 offset:46080
  s_cbranch_vccnz Lslow_kvf_5
Lback_kvf_5:
  v_mfma_f32_16x16x32_bf16 v[128:131], a[120:123], v[248:251], v[128:131]
  v_permlane16_swap_b32 v104, v108
  v_mfma_f32_16x16x32_bf16 v[132:135], a[120:123], v[252:255], v[132:135]
  ds_read_b128 a[120:123], v30 offset:47104
  v_mfma_f32_16x16x32_bf16 v[136:139], a[124:127], v[248:251], v[136:139]
  v_permlane16_swap_b32 v105, v109
  v_mfma_f32_16x16x32_bf16 v[140:143], a[124:127], v[252:255], v[140:143]
  buffer_load_dwordx4 v8, s[16:19], s15 offen offset:2048 sc1 lds
  v_mfma_f32_16x16x32_bf16 v[112:115], a[128:131], a[0:3], v[112:115]
  ds_read_b128 a[124:127], v30 offset:48128
  v_mfma_f32_16x16x32_bf16 v[116:119], a[128:131], a[4:7], v[116:119]
  v_permlane16_swap_b32 v106, v110
  v_mfma_f32_16x16x32_bf16 v[120:123], a[132:135], a[0:3], v[120:123]
  v_permlane16_swap_b32 v107, v111
  v_mfma_f32_16x16x32_bf16 v[124:127], a[132:135], a[4:7], v[124:127]
  s_waitcnt lgkmcnt(2)
  v_mfma_f32_16x16x32_bf16 v[128:131], a[136:139], a[0:3], v[128:131]
  v_mfma_f32_16x16x32_bf16 v[132:135], a[136:139], a[4:7], v[132:135]
  v_mfma_f32_16x16x32_bf16 v[136:139], a[140:143], a[0:3], v[136:139]
  s_waitcnt vmcnt(7) lgkmcnt(0)
  s_barrier
  v_mfma_f32_16x16x32_bf16 v[140:143], a[140:143], a[4:7], v[140:143]
  buffer_load_dwordx4 v8, s[16:19], s15 offen offset:3072 sc1 lds
  v_mfma_f32_16x16x32_bf16 v[112:115], a[112:115], a[8:11], v[112:115]
  s_add_u32 m0, s59, 155648
  ds_read_b64 a[128:129], v45 offset:0
  ds_read_b64 a[130:131], v45 offset:1024
  v_mfma_f32_16x16x32_bf16 v[116:119], a[112:115], a[12:15], v[116:119]
  ds_read_b64 a[132:133], v45 offset:2048
  ds_read_b64 a[134:135], v45 offset:3072
  v_mfma_f32_16x16x32_bf16 v[120:123], a[116:119], a[8:11], v[120:123]
  ds_read_b64 a[136:137], v45 offset:4096
  ds_read_b64 a[138:139], v45 offset:5120
  v_mfma_f32_16x16x32_bf16 v[124:127], a[116:119], a[12:15], v[124:127]
  ds_read_b64 a[140:141], v45 offset:6144
  ds_read_b64 a[142:143], v45 offset:7168
  v_mfma_f32_16x16x32_bf16 v[128:131], a[120:123], a[8:11], v[128:131]
  buffer_load_dwordx4 v[176:179], v28, s[16:19], s40 offen offset:0 sc1
  v_mfma_f32_16x16x32_bf16 v[132:135], a[120:123], a[12:15], v[132:135]
  ds_read_b128 a[112:115], v30 offset:49152
  ds_read_b128 a[116:119], v30 offset:50176
  v_mfma_f32_16x16x32_bf16 v[136:139], a[124:127], a[8:11], v[136:139]
  ds_read_b128 a[120:123], v30 offset:51200
  v_mfma_f32_16x16x32_bf16 v[140:143], a[124:127], a[12:15], v[140:143]
  ds_read_b128 a[124:127], v30 offset:52224
  s_waitcnt lgkmcnt(10)
  v_mfma_f32_32x32x16_bf16 v[144:159], a[128:131], v[208:211], 0
  ds_read_b128 a[128:131], v30 offset:53248
  s_waitcnt lgkmcnt(9)
  v_mfma_f32_32x32x16_bf16 v[144:159], a[132:135], v[212:215], v[144:159]
  ds_read_b128 a[132:135], v30 offset:54272
  s_waitcnt lgkmcnt(6)
  v_mfma_f32_32x32x16_bf16 v[144:159], a[136:139], v[216:219], v[144:159]
  ds_read_b128 a[136:139], v30 offset:55296
  v_mfma_f32_32x32x16_bf16 v[144:159], a[140:143], v[220:223], v[144:159]
  ds_read_b128 a[140:143], v30 offset:56320
  s_waitcnt lgkmcnt(4)
  v_mfma_f32_16x16x32_bf16 v[112:115], a[112:115], a[16:19], v[112:115]
  v_mfma_f32_16x16x32_bf16 v[116:119], a[112:115], a[20:23], v[116:119]
  ds_read_b128 a[112:115], v30 offset:57344
  v_mfma_f32_16x16x32_bf16 v[120:123], a[116:119], a[16:19], v[120:123]
  v_mfma_f32_16x16x32_bf16 v[124:127], a[116:119], a[20:23], v[124:127]
  ds_read_b128 a[116:119], v30 offset:58368
  v_mfma_f32_16x16x32_bf16 v[128:131], a[120:123], a[16:19], v[128:131]
  v_mfma_f32_16x16x32_bf16 v[132:135], a[120:123], a[20:23], v[132:135]
  buffer_load_dwordx4 v[180:183], v28, s[16:19], s40 offen offset:1024 sc1
  v_mfma_f32_16x16x32_bf16 v[136:139], a[124:127], a[16:19], v[136:139]
  ds_read_b128 a[120:123], v30 offset:59392
  v_mov_b32 v54, v156
  v_mfma_f32_16x16x32_bf16 v[140:143], a[124:127], a[20:23], v[140:143]
  ds_read_b128 a[124:127], v30 offset:60416
  v_mov_b32 v55, v156
  s_waitcnt lgkmcnt(4)
  v_mfma_f32_16x16x32_bf16 v[112:115], a[128:131], a[24:27], v[112:115]
  v_permlane32_swap_b32 v55, v54
  v_mfma_f32_16x16x32_bf16 v[116:119], a[128:131], a[28:31], v[116:119]
  ds_read_b128 a[128:131], v30 offset:61440
  v_fmac_f32 v54, 0x358637bd, v59
  v_mfma_f32_16x16x32_bf16 v[120:123], a[132:135], a[24:27], v[120:123]
  v_rcp_f32 v54, v54
  v_mfma_f32_16x16x32_bf16 v[124:127], a[132:135], a[28:31], v[124:127]
  buffer_load_dwordx4 v[184:187], v28, s[16:19], s40 offen offset:2048 sc1
  v_mfma_f32_16x16x32_bf16 v[128:131], a[136:139], a[24:27], v[128:131]
  ds_read_b128 a[132:135], v30 offset:62464
  v_mul_f32 v54, v54, v57
  v_mfma_f32_16x16x32_bf16 v[132:135], a[136:139], a[28:31], v[132:135]
  ds_read_b128 a[136:139], v30 offset:63488
  v_cndmask_b32 v55, 0, v54, s[72:73]
  v_mfma_f32_16x16x32_bf16 v[136:139], a[140:143], a[24:27], v[136:139]
  v_mul_f32 v144, v144, v54
  v_mul_f32 v145, v145, v54
  v_mfma_f32_16x16x32_bf16 v[140:143], a[140:143], a[28:31], v[140:143]
  buffer_load_dwordx4 v[188:191], v28, s[16:19], s40 offen offset:3072 sc1
  s_waitcnt lgkmcnt(2)
  v_mfma_f32_16x16x32_bf16 v[112:115], a[112:115], a[32:35], v[112:115]
  ds_read_b128 a[140:143], v30 offset:64512
  v_mul_f32 v146, v146, v54
  v_mfma_f32_16x16x32_bf16 v[116:119], a[112:115], a[36:39], v[116:119]
  v_mul_f32 v147, v147, v54
  v_mul_f32 v148, v148, v54
  v_mfma_f32_16x16x32_bf16 v[120:123], a[116:119], a[32:35], v[120:123]
  v_mul_f32 v149, v149, v54
  v_mul_f32 v150, v150, v54
  v_mfma_f32_16x16x32_bf16 v[124:127], a[116:119], a[36:39], v[124:127]
  v_mul_f32 v151, v151, v54
  v_mul_f32 v152, v152, v54
  v_mfma_f32_16x16x32_bf16 v[128:131], a[120:123], a[32:35], v[128:131]
  v_mul_f32 v153, v153, v54
  v_mul_f32 v154, v154, v54
  v_mfma_f32_16x16x32_bf16 v[132:135], a[120:123], a[36:39], v[132:135]
  buffer_load_dwordx4 v[192:195], v28, s[16:19], s41 offen offset:0 sc1
  v_mfma_f32_16x16x32_bf16 v[136:139], a[124:127], a[32:35], v[136:139]
  s_waitcnt vmcnt(9) lgkmcnt(0)
  s_barrier
  ds_read_b128 a[112:115], v30 offset:0
  v_mfma_f32_16x16x32_bf16 v[140:143], a[124:127], a[36:39], v[140:143]
  ds_read_b128 a[116:119], v30 offset:1024
  ds_read_b128 a[120:123], v30 offset:2048
  v_mfma_f32_16x16x32_bf16 v[112:115], a[128:131], a[40:43], v[112:115]
  ds_read_b128 a[124:127], v30 offset:3072
  v_mul_f32 v155, v155, v54
  v_mfma_f32_16x16x32_bf16 v[116:119], a[128:131], a[44:47], v[116:119]
  ds_read_b128 a[128:131], v30 offset:4096
  v_mul_f32 v156, v156, v55
  v_mfma_f32_16x16x32_bf16 v[120:123], a[132:135], a[40:43], v[120:123]
  v_mul_f32 v157, v157, v55
  v_mul_f32 v158, v158, v55
  v_mfma_f32_16x16x32_bf16 v[124:127], a[132:135], a[44:47], v[124:127]
  buffer_load_dwordx2 v[196:197], v50, s[16:19], s41 offen offset:1024 sc1
  v_mfma_f32_16x16x32_bf16 v[128:131], a[136:139], a[40:43], v[128:131]
  ds_read_b128 a[132:135], v30 offset:5120
  buffer_load_dwordx4 v16, s[24:27], s65 offen offset:0 lds
  v_mfma_f32_16x16x32_bf16 v[132:135], a[136:139], a[44:47], v[132:135]
  ds_read_b128 a[136:139], v30 offset:6144
  v_mul_f32 v159, v159, v55
  v_mfma_f32_16x16x32_bf16 v[136:139], a[140:143], a[40:43], v[136:139]
  v_cvt_pk_bf16_f32 v198, v144, v145
  v_cvt_pk_bf16_f32 v199, v146, v147
  v_mfma_f32_16x16x32_bf16 v[140:143], a[140:143], a[44:47], v[140:143]
  ds_read_b128 a[140:143], v30 offset:7168
  v_cvt_pk_bf16_f32 v200, v148, v149
  s_waitcnt lgkmcnt(3)
  v_mfma_f32_16x16x32_bf16 v[112:115], a[112:115], a[48:51], v[112:115]
  v_cvt_pk_bf16_f32 v201, v150, v151
  v_cvt_pk_bf16_f32 v202, v152, v153
  v_mfma_f32_16x16x32_bf16 v[116:119], a[112:115], a[52:55], v[116:119]
  ds_read_b128 a[112:115], v30 offset:8192
  v_cvt_pk_bf16_f32 v203, v154, v155
  v_mfma_f32_16x16x32_bf16 v[120:123], a[116:119], a[48:51], v[120:123]
  v_cvt_pk_bf16_f32 v204, v156, v157
  v_cvt_pk_bf16_f32 v205, v158, v159
  v_mfma_f32_16x16x32_bf16 v[124:127], a[116:119], a[52:55], v[124:127]
  ds_read_b128 a[116:119], v30 offset:9216
  v_mfma_f32_16x16x32_bf16 v[128:131], a[120:123], a[48:51], v[128:131]
  v_mfma_f32_16x16x32_bf16 v[132:135], a[120:123], a[52:55], v[132:135]
  buffer_load_dwordx4 v17, s[24:27], s65 offen offset:1024 lds
  v_mfma_f32_16x16x32_bf16 v[136:139], a[124:127], a[48:51], v[136:139]
  s_add_u32 m0, s59, 106496
  s_mov_b32 s65, 0
  ds_read_b128 a[120:123], v30 offset:10240
  v_mfma_f32_16x16x32_bf16 v[140:143], a[124:127], a[52:55], v[140:143]
  ds_read_b128 a[124:127], v30 offset:11264
  v_mfma_f32_16x16x32_bf16 v[112:115], a[128:131], a[56:59], v[112:115]
  v_mfma_f32_16x16x32_bf16 v[116:119], a[128:131], a[60:63], v[116:119]
  ds_read_b128 a[128:131], v30 offset:12288
  s_waitcnt lgkmcnt(4)
  v_mfma_f32_16x16x32_bf16 v[120:123], a[132:135], a[56:59], v[120:123]
  v_mfma_f32_16x16x32_bf16 v[124:127], a[132:135], a[60:63], v[124:127]
  buffer_load_dwordx4 v16, s[24:27], s65 offen offset:0 lds
  v_mfma_f32_16x16x32_bf16 v[128:131], a[136:139], a[56:59], v[128:131]
  ds_read_b128 a[132:135], v30 offset:13312
  v_mfma_f32_16x16x32_bf16 v[132:135], a[136:139], a[60:63], v[132:135]
  ds_read_b128 a[136:139], v30 offset:14336
  v_mfma_f32_16x16x32_bf16 v[136:139], a[140:143], a[56:59], v[136:139]
  v_mfma_f32_16x16x32_bf16 v[140:143], a[140:143], a[60:63], v[140:143]
  buffer_load_dwordx4 v17, s[24:27], s65 offen offset:1024 lds
  v_mfma_f32_16x16x32_bf16 v[112:115], a[112:115], a[64:67], v[112:115]
  s_add_u32 m0, s59, 114688
  s_mov_b32 s65, 57344
  ds_read_b128 a[140:143], v30 offset:15360
  v_mfma_f32_16x16x32_bf16 v[116:119], a[112:115], a[68:71], v[116:119]
  s_waitcnt lgkmcnt(3)
  v_mfma_f32_16x16x32_bf16 v[120:123], a[116:119], a[64:67], v[120:123]
  v_mfma_f32_16x16x32_bf16 v[124:127], a[116:119], a[68:71], v[124:127]
  v_mfma_f32_16x16x32_bf16 v[128:131], a[120:123], a[64:67], v[128:131]
  v_mfma_f32_16x16x32_bf16 v[132:135], a[120:123], a[68:71], v[132:135]
  buffer_load_dwordx4 v16, s[24:27], s65 offen offset:0 lds
  v_mfma_f32_16x16x32_bf16 v[136:139], a[124:127], a[64:67], v[136:139]
  s_waitcnt vmcnt(11) lgkmcnt(0)
  s_barrier
  ds_read_b128 a[112:115], v30 offset:16384
  v_mfma_f32_16x16x32_bf16 v[140:143], a[124:127], a[68:71], v[140:143]
  ds_read_b128 a[116:119], v30 offset:17408
  ds_read_b128 a[120:123], v30 offset:18432
  v_mfma_f32_16x16x32_bf16 v[112:115], a[128:131], a[72:75], v[112:115]
  ds_read_b128 a[124:127], v30 offset:19456
  v_mfma_f32_16x16x32_bf16 v[116:119], a[128:131], a[76:79], v[116:119]
  ds_read_b128 a[128:131], v30 offset:20480
  v_mfma_f32_16x16x32_bf16 v[120:123], a[132:135], a[72:75], v[120:123]
  v_mfma_f32_16x16x32_bf16 v[124:127], a[132:135], a[76:79], v[124:127]
  buffer_load_dwordx4 v17, s[24:27], s65 offen offset:1024 lds
  v_mfma_f32_16x16x32_bf16 v[128:131], a[136:139], a[72:75], v[128:131]
  s_add_u32 m0, s59, 122880
  s_mov_b32 s65, 114688
  buffer_load_dwordx4 v16, s[24:27], s65 offen offset:0 lds
  v_mfma_f32_16x16x32_bf16 v[132:135], a[136:139], a[76:79], v[132:135]
  ds_read_b128 a[132:135], v30 offset:21504
  ds_read_b128 a[136:139], v30 offset:22528
  v_mfma_f32_16x16x32_bf16 v[136:139], a[140:143], a[72:75], v[136:139]
  v_mfma_f32_16x16x32_bf16 v[140:143], a[140:143], a[76:79], v[140:143]
  ds_read_b128 a[140:143], v30 offset:23552
  s_waitcnt lgkmcnt(3)
  v_mfma_f32_16x16x32_bf16 v[112:115], a[112:115], a[80:83], v[112:115]
  v_mfma_f32_16x16x32_bf16 v[116:119], a[112:115], a[84:87], v[116:119]
  ds_read_b128 a[112:115], v30 offset:24576
  v_mfma_f32_16x16x32_bf16 v[120:123], a[116:119], a[80:83], v[120:123]
  v_mfma_f32_16x16x32_bf16 v[124:127], a[116:119], a[84:87], v[124:127]
  ds_read_b128 a[116:119], v30 offset:25600
  v_mfma_f32_16x16x32_bf16 v[128:131], a[120:123], a[80:83], v[128:131]
  v_mfma_f32_16x16x32_bf16 v[132:135], a[120:123], a[84:87], v[132:135]
  buffer_load_dwordx4 v17, s[24:27], s65 offen offset:1024 lds
  v_mfma_f32_16x16x32_bf16 v[136:139], a[124:127], a[80:83], v[136:139]
  s_add_u32 m0, s59, 139264
  s_mov_b32 s65, 229376
  ds_read_b128 a[120:123], v30 offset:26624
  v_mfma_f32_16x16x32_bf16 v[140:143], a[124:127], a[84:87], v[140:143]
  ds_read_b128 a[124:127], v30 offset:27648
  v_mfma_f32_16x16x32_bf16 v[112:115], a[128:131], a[88:91], v[112:115]
  v_mfma_f32_16x16x32_bf16 v[116:119], a[128:131], a[92:95], v[116:119]
  ds_read_b128 a[128:131], v30 offset:28672
  s_waitcnt lgkmcnt(4)
  v_mfma_f32_16x16x32_bf16 v[120:123], a[132:135], a[88:91], v[120:123]
  v_mfma_f32_16x16x32_bf16 v[124:127], a[132:135], a[92:95], v[124:127]
  buffer_load_dwordx4 v16, s[24:27], s65 offen offset:0 lds
  v_mfma_f32_16x16x32_bf16 v[128:131], a[136:139], a[88:91], v[128:131]
  ds_read_b128 a[132:135], v30 offset:29696
  v_mfma_f32_16x16x32_bf16 v[132:135], a[136:139], a[92:95], v[132:135]
  ds_read_b128 a[136:139], v30 offset:30720
  v_mfma_f32_16x16x32_bf16 v[136:139], a[140:143], a[88:91], v[136:139]
  v_mfma_f32_16x16x32_bf16 v[140:143], a[140:143], a[92:95], v[140:143]
  buffer_load_dwordx4 v17, s[24:27], s65 offen offset:1024 lds
  v_mfma_f32_16x16x32_bf16 v[112:115], a[112:115], a[96:99], v[112:115]
  s_add_u32 m0, s59, 147456
  s_mov_b32 s65, 286720
  ds_read_b128 a[140:143], v30 offset:31744
  v_mfma_f32_16x16x32_bf16 v[116:119], a[112:115], a[100:103], v[116:119]
  s_waitcnt lgkmcnt(3)
  v_mfma_f32_16x16x32_bf16 v[120:123], a[116:119], a[96:99], v[120:123]
  v_mfma_f32_16x16x32_bf16 v[124:127], a[116:119], a[100:103], v[124:127]
  s_waitcnt vmcnt(10)
  v_xor_b32 v52, s54, v197
  v_bitop3_b32 v52, v179, s54, v52 bitop3:0xbe
  v_mfma_f32_16x16x32_bf16 v[128:131], a[120:123], a[96:99], v[128:131]
  v_bitop3_b32 v52, v183, s54, v52 bitop3:0xbe
  v_bitop3_b32 v52, v187, s54, v52 bitop3:0xbe
  v_mfma_f32_16x16x32_bf16 v[132:135], a[120:123], a[100:103], v[132:135]
  buffer_load_dwordx4 v16, s[24:27], s65 offen offset:0 lds
  v_mfma_f32_16x16x32_bf16 v[136:139], a[124:127], a[96:99], v[136:139]
  v_bitop3_b32 v52, v191, s54, v52 bitop3:0xbe
  v_bitop3_b32 v52, v195, s54, v52 bitop3:0xbe
  v_mfma_f32_16x16x32_bf16 v[140:143], a[124:127], a[100:103], v[140:143]
  v_lshlrev_b32 v144, 16, v176
  v_and_b32 v145, 0xffff0000, v176
  v_mfma_f32_16x16x32_bf16 v[112:115], a[128:131], a[104:107], v[112:115]
  v_lshlrev_b32 v146, 16, v177
  v_and_b32 v147, 0xffff0000, v177
  v_mfma_f32_16x16x32_bf16 v[116:119], a[128:131], a[108:111], v[116:119]
  v_lshlrev_b32 v148, 16, v178
  v_and_b32 v149, 0xffff0000, v178
  s_waitcnt lgkmcnt(0)
  v_mfma_f32_16x16x32_bf16 v[120:123], a[132:135], a[104:107], v[120:123]
  v_lshlrev_b32 v150, 16, v180
  v_and_b32 v151, 0xffff0000, v180
  v_mfma_f32_16x16x32_bf16 v[124:127], a[132:135], a[108:111], v[124:127]
  buffer_load_dwordx4 v17, s[24:27], s65 offen offset:1024 lds
  v_mfma_f32_16x16x32_bf16 v[128:131], a[136:139], a[104:107], v[128:131]
  v_lshlrev_b32 v152, 16, v181
  v_and_b32 v153, 0xffff0000, v181
  v_mfma_f32_16x16x32_bf16 v[132:135], a[136:139], a[108:111], v[132:135]
  v_lshlrev_b32 v154, 16, v182
  v_and_b32 v155, 0xffff0000, v182
  v_mfma_f32_16x16x32_bf16 v[136:139], a[140:143], a[104:107], v[136:139]
  v_lshlrev_b32 v156, 16, v184
  v_and_b32 v157, 0xffff0000, v184
  v_mfma_f32_16x16x32_bf16 v[140:143], a[140:143], a[108:111], v[140:143]
  v_lshlrev_b32 v158, 16, v185
  v_and_b32 v159, 0xffff0000, v185
  v_lshlrev_b32 v160, 16, v186
  v_and_b32 v161, 0xffff0000, v186
  v_lshlrev_b32 v162, 16, v188
  v_and_b32 v163, 0xffff0000, v188
  v_lshlrev_b32 v164, 16, v189
  v_and_b32 v165, 0xffff0000, v189
  v_lshlrev_b32 v166, 16, v190
  v_and_b32 v167, 0xffff0000, v190
  v_lshlrev_b32 v168, 16, v192
  v_and_b32 v169, 0xffff0000, v192
  v_lshlrev_b32 v170, 16, v193
  v_and_b32 v171, 0xffff0000, v193
  v_lshlrev_b32 v172, 16, v194
  v_and_b32 v173, 0xffff0000, v194
  v_lshlrev_b32 v174, 16, v196
  v_and_b32 v175, 0xffff0000, v196
  v_cmp_ne_u32 vcc, 0, v52
  s_nop 0
  s_cbranch_vccnz Lslow_gp_6
Lback_gp_6:
  buffer_store_dwordx4 v[198:201], v28, s[16:19], s37 offen offset:0 sc1
  buffer_store_dwordx4 v[202:205], v28, s[16:19], s37 offen offset:1024 sc1
  v_pk_add_f32 v[112:113], v[112:113], v[144:145]
  v_pk_mul_f32 v[112:113], v[112:113], v[80:81]
  v_pk_add_f32 v[114:115], v[114:115], v[146:147]
  v_pk_mul_f32 v[114:115], v[114:115], v[82:83]
  v_pk_add_f32 v[120:121], v[120:121], v[152:153]
  v_pk_mul_f32 v[120:121], v[120:121], v[88:89]
  v_pk_add_f32 v[122:123], v[122:123], v[154:155]
  v_pk_mul_f32 v[122:123], v[122:123], v[90:91]
  v_cvt_pk_bf16_f32 v208, v112, v113
  v_cvt_pk_bf16_f32 v209, v114, v115
  v_cvt_pk_bf16_f32 v210, v120, v121
  v_cvt_pk_bf16_f32 v211, v122, v123
  buffer_store_dwordx4 v[208:211], v18, s[16:19], 0 offen offset:0 sc1
  v_pk_add_f32 v[116:117], v[116:117], v[148:149]
  v_pk_mul_f32 v[116:117], v[116:117], v[84:85]
  v_pk_add_f32 v[118:119], v[118:119], v[150:151]
  v_pk_mul_f32 v[118:119], v[118:119], v[86:87]
  v_pk_add_f32 v[124:125], v[124:125], v[156:157]
  v_pk_mul_f32 v[124:125], v[124:125], v[92:93]
  v_pk_add_f32 v[126:127], v[126:127], v[158:159]
  v_pk_mul_f32 v[126:127], v[126:127], v[94:95]
  v_cvt_pk_bf16_f32 v212, v116, v117
  v_cvt_pk_bf16_f32 v213, v118, v119
  v_cvt_pk_bf16_f32 v214, v124, v125
  v_cvt_pk_bf16_f32 v215, v126, v127
  buffer_store_dwordx4 v[212:215], v18, s[16:19], 0 offen offset:256 sc1
  v_pk_add_f32 v[128:129], v[128:129], v[160:161]
  v_pk_mul_f32 v[128:129], v[128:129], v[96:97]
  v_pk_add_f32 v[130:131], v[130:131], v[162:163]
  v_pk_mul_f32 v[130:131], v[130:131], v[98:99]
  v_pk_add_f32 v[136:137], v[136:137], v[168:169]
  v_pk_mul_f32 v[136:137], v[136:137], v[104:105]
  v_pk_add_f32 v[138:139], v[138:139], v[170:171]
  v_pk_mul_f32 v[138:139], v[138:139], v[106:107]
  v_cvt_pk_bf16_f32 v216, v128, v129
  v_cvt_pk_bf16_f32 v217, v130, v131
  v_cvt_pk_bf16_f32 v218, v136, v137
  v_cvt_pk_bf16_f32 v219, v138, v139
  buffer_store_dwordx4 v[216:219], v18, s[16:19], 0 offen offset:2048 sc1
  v_pk_add_f32 v[132:133], v[132:133], v[164:165]
  v_pk_mul_f32 v[132:133], v[132:133], v[100:101]
  v_pk_add_f32 v[134:135], v[134:135], v[166:167]
  v_pk_mul_f32 v[134:135], v[134:135], v[102:103]
  v_pk_add_f32 v[140:141], v[140:141], v[172:173]
  v_pk_mul_f32 v[140:141], v[140:141], v[108:109]
  v_pk_add_f32 v[142:143], v[142:143], v[174:175]
  v_pk_mul_f32 v[142:143], v[142:143], v[110:111]
  v_cvt_pk_bf16_f32 v220, v132, v133
  v_cvt_pk_bf16_f32 v221, v134, v135
  v_cvt_pk_bf16_f32 v222, v140, v141
  v_cvt_pk_bf16_f32 v223, v142, v143
  buffer_store_dwordx4 v[220:223], v18, s[16:19], 0 offen offset:2304 sc1
  s_barrier
  s_add_u32 m0, s59, 0
  s_mov_b32 s65, 0
  buffer_load_dwordx4 v16, s[28:31], s65 offen offset:0 lds
  buffer_load_dwordx4 v17, s[28:31], s65 offen offset:1024 lds
  s_add_u32 m0, s59, 8192
  s_mov_b32 s65, 57344
  buffer_load_dwordx4 v16, s[28:31], s65 offen offset:0 lds
  buffer_load_dwordx4 v17, s[28:31], s65 offen offset:1024 lds
  v_and_b32 v1, 31, v0
  v_and_b32 v2, 15, v0
  v_xor_b32 v2, v2, v5
  v_lshlrev_b32 v2, 4, v2
  v_lshl_add_u32 v1, v1, 8, v2
  s_lshl_b32 s62, s51, 13
  s_add_u32 s62, s62, 131072
  v_add_u32 v20, s62, v1
  v_lshrrev_b32 v1, 3, v0
  v_and_b32 v2, 7, v0
  v_lshlrev_b32 v3, 1, v2
  v_xor_b32 v3, v3, v1
  v_lshlrev_b32 v3, 4, v3
  v_lshl_add_u32 v3, v1, 8, v3
  s_add_u32 s62, s60, 131072
  v_add_u32 v21, s62, v3
  s_lshl1_add_u32 s62, s48, s49
  s_lshl2_add_u32 s62, s62, s51
  s_mul_i32 s62, s62, 14336
  s_lshl_b32 s63, s50, 7
  s_add_u32 s90, s62, s63
  s_add_u32 s91, s90, 7168
  v_mul_u32_u24 v1, 896, v1
  v_lshl_add_u32 v23, v2, 4, v1
  v_xor_b32 v144, 0, v20
  v_xor_b32 v145, 32, v20
  v_xor_b32 v146, 64, v20
  v_xor_b32 v147, 96, v20
  v_xor_b32 v148, 128, v20
  v_xor_b32 v149, 160, v20
  v_xor_b32 v150, 192, v20
  v_xor_b32 v151, 224, v20
  v_xor_b32 v152, 0, v21
  v_xor_b32 v153, 16, v21
  v_xor_b32 v154, 128, v21
  v_xor_b32 v155, 144, v21
  s_add_u32 s82, s98, 0
  s_add_u32 s83, s98, 4096
  s_add_u32 s84, s98, 8192
  s_add_u32 s85, s98, 12288
  s_add_u32 s8, s99, 0
  s_add_u32 s9, s99, 4096
  s_add_u32 s10, s99, 8192
  s_add_u32 s11, s99, 12288
  s_add_u32 s12, s99, 16384
  s_add_u32 s13, s99, 20480
  s_add_u32 s14, s99, 24576
  s_lshl2_add_u32 s62, s48, s51
  s_lshl_b32 s62, s62, 9
  s_add_u32 s62, s62, 65536
  s_mov_b32 s3, s62
  s_add_u32 s100, s16, s62
  s_addc_u32 s101, s17, 0
  s_waitcnt vmcnt(4)
  s_barrier
  s_cmp_lg_u32 s51, 0
  s_cbranch_scc1 Lsf2
  s_atomic_swap s54, s[16:17], s47
Lsf2:
  s_add_u32 m0, s59, 16384
  s_mov_b32 s65, 114688
  buffer_load_dwordx4 v16, s[28:31], s65 offen offset:0 lds
  buffer_load_dwordx4 v17, s[28:31], s65 offen offset:1024 lds
  s_add_u32 m0, s59, 24576
  s_mov_b32 s65, 172032
  buffer_load_dwordx4 v16, s[28:31], s65 offen offset:0 lds
  buffer_load_dwordx4 v17, s[28:31], s65 offen offset:1024 lds
  s_add_u32 m0, s59, 32768
  s_mov_b32 s65, 229376
  buffer_load_dwordx4 v16, s[28:31], s65 offen offset:0 lds
  buffer_load_dwordx4 v17, s[28:31], s65 offen offset:1024 lds
  s_add_u32 m0, s59, 40960
  s_mov_b32 s65, 286720
  buffer_load_dwordx4 v16, s[28:31], s65 offen offset:0 lds
  buffer_load_dwordx4 v17, s[28:31], s65 offen offset:1024 lds
  s_add_u32 m0, s59, 49152
  s_mov_b32 s65, 344064
  buffer_load_dwordx4 v16, s[28:31], s65 offen offset:0 lds
  buffer_load_dwordx4 v17, s[28:31], s65 offen offset:1024 lds
  s_barrier
  ds_read_b64_tr_b16 v[160:161], v24 offset:0
  ds_read_b64_tr_b16 v[162:163], v24 offset:1024
  ds_read_b64_tr_b16 v[164:165], v25 offset:0
  ds_read_b64_tr_b16 v[166:167], v25 offset:1024
  ds_read_b64_tr_b16 v[168:169], v24 offset:2048
  ds_read_b64_tr_b16 v[170:171], v33 offset:3072
  ds_read_b64_tr_b16 v[172:173], v25 offset:2048
  ds_read_b64_tr_b16 v[174:175], v34 offset:3072
  ds_read_b64_tr_b16 v[176:177], v24 offset:3584
  ds_read_b64_tr_b16 v[178:179], v24 offset:4608
  ds_read_b64_tr_b16 v[180:181], v25 offset:3584
  ds_read_b64_tr_b16 v[182:183], v25 offset:4608
  ds_read_b64_tr_b16 v[184:185], v24 offset:5632
  ds_read_b64_tr_b16 v[186:187], v33 offset:6656
  ds_read_b64_tr_b16 v[188:189], v25 offset:5632
  ds_read_b64_tr_b16 v[190:191], v34 offset:6656
  ds_read_b64_tr_b16 v[192:193], v24 offset:7168
  ds_read_b64_tr_b16 v[194:195], v24 offset:8192
  ds_read_b64_tr_b16 v[196:197], v25 offset:7168
  ds_read_b64_tr_b16 v[198:199], v25 offset:8192
  ds_read_b64_tr_b16 v[200:201], v24 offset:9216
  ds_read_b64_tr_b16 v[202:203], v33 offset:10240
  ds_read_b64_tr_b16 v[204:205], v25 offset:9216
  ds_read_b64_tr_b16 v[206:207], v34 offset:10240
  s_add_u32 m0, s59, 57344
  s_mov_b32 s65, 401408
  buffer_load_dwordx4 v16, s[28:31], s65 offen offset:0 lds
  buffer_load_dwordx4 v17, s[28:31], s65 offen offset:1024 lds
  s_load_dword s74, s[100:101], 0 glc
  s_load_dword s75, s[100:101], 128 glc
  s_load_dword s76, s[100:101], 256 glc
  s_load_dword s77, s[100:101], 384 glc
  s_add_u32 m0, s59, 98304
  s_mov_b32 s65, 688128
  buffer_load_dwordx4 v16, s[28:31], s65 offen offset:0 lds
  buffer_load_dwordx4 v17, s[28:31], s65 offen offset:1024 lds
  s_add_u32 m0, s59, 65536
  s_mov_b32 s65, 458752
  buffer_load_dwordx4 v16, s[28:31], s65 offen offset:0 lds
  buffer_load_dwordx4 v17, s[28:31], s65 offen offset:1024 lds
  s_add_u32 m0, s59, 73728
  s_mov_b32 s65, 516096
  buffer_load_dwordx4 v16, s[28:31], s65 offen offset:0 lds
  buffer_load_dwordx4 v17, s[28:31], s65 offen offset:1024 lds
  s_add_u32 m0, s59, 81920
  s_mov_b32 s65, 573440
  buffer_load_dwordx4 v16, s[28:31], s65 offen offset:0 lds
  buffer_load_dwordx4 v17, s[28:31], s65 offen offset:1024 lds
  s_add_u32 m0, s59, 90112
  s_mov_b32 s65, 630784
  buffer_load_dwordx4 v16, s[28:31], s65 offen offset:0 lds
  buffer_load_dwordx4 v17, s[28:31], s65 offen offset:1024 lds
  s_waitcnt lgkmcnt(0)
  s_xor_b32 s74, s74, s54
  s_xor_b32 s75, s75, s54
  s_xor_b32 s76, s76, s54
  s_xor_b32 s77, s77, s54
  s_or_b32 s74, s74, s75
  s_or_b32 s74, s74, s76
  s_or_b32 s74, s74, s77
  s_cbranch_scc1 Lslow_fh_7
Lback_fh_7:
  s_barrier
  s_add_u32 m0, s59, 106496
  s_mov_b32 s65, 745472
  ds_read_b64_tr_b16 a[112:113], v24 offset:10752
  ds_read_b64_tr_b16 a[114:115], v24 offset:11776
  ds_read_b64_tr_b16 a[116:117], v25 offset:10752
  ds_read_b64_tr_b16 a[118:119], v25 offset:11776
  ds_read_b64_tr_b16 a[120:121], v24 offset:12800
  ds_read_b64_tr_b16 a[122:123], v33 offset:13824
  ds_read_b64_tr_b16 a[124:125], v25 offset:12800
  ds_read_b64_tr_b16 a[126:127], v34 offset:13824
  ds_read_b64_tr_b16 a[128:129], v24 offset:14336
  ds_read_b64_tr_b16 a[130:131], v24 offset:15360
  ds_read_b64_tr_b16 a[132:133], v25 offset:14336
  ds_read_b64_tr_b16 a[134:135], v25 offset:15360
  buffer_load_dwordx4 a[144:147], v28, s[16:19], s82 offen offset:0 sc1
  ds_read_b64_tr_b16 a[136:137], v24 offset:16384
  ds_read_b64_tr_b16 a[138:139], v33 offset:17408
  ds_read_b64_tr_b16 a[140:141], v25 offset:16384
  ds_read_b64_tr_b16 a[142:143], v34 offset:17408
  buffer_load_dwordx4 a[148:151], v28, s[16:19], s82 offen offset:1024 sc1
  buffer_load_dwordx4 a[152:155], v28, s[16:19], s82 offen offset:2048 sc1
  buffer_load_dwordx4 a[156:159], v28, s[16:19], s82 offen offset:3072 sc1
  buffer_load_dwordx4 a[160:163], v28, s[16:19], s83 offen offset:0 sc1
  buffer_load_dwordx4 a[164:167], v28, s[16:19], s83 offen offset:1024 sc1
  buffer_load_dwordx4 v16, s[28:31], s65 offen offset:0 lds
  buffer_load_dwordx4 v17, s[28:31], s65 offen offset:1024 lds
  buffer_load_dwordx4 a[168:171], v28, s[16:19], s83 offen offset:2048 sc1
  buffer_load_dwordx4 a[172:175], v28, s[16:19], s83 offen offset:3072 sc1
  s_waitcnt vmcnt(9)
  v_mfma_f32_32x32x16_bf16 v[80:95], v[160:163], a[144:147], 0
  buffer_load_dwordx4 a[176:179], v28, s[16:19], s84 offen offset:0 sc1
  v_mfma_f32_32x32x16_bf16 v[96:111], v[164:167], a[144:147], 0
  buffer_load_dwordx4 a[180:183], v28, s[16:19], s84 offen offset:1024 sc1
  s_waitcnt vmcnt(10)
  v_mfma_f32_32x32x16_bf16 v[80:95], v[168:171], a[148:151], v[80:95]
  v_mfma_f32_32x32x16_bf16 v[96:111], v[172:175], a[148:151], v[96:111]
  buffer_load_dwordx4 a[184:187], v28, s[16:19], s84 offen offset:2048 sc1
  s_waitcnt vmcnt(10)
  v_mfma_f32_32x32x16_bf16 v[80:95], v[176:179], a[152:155], v[80:95]
  v_mfma_f32_32x32x16_bf16 v[96:111], v[180:183], a[152:155], v[96:111]
  s_waitcnt vmcnt(9)
  v_mfma_f32_32x32x16_bf16 v[80:95], v[184:187], a[156:159], v[80:95]
  buffer_load_dwordx4 a[188:191], v28, s[16:19], s84 offen offset:3072 sc1
  v_mfma_f32_32x32x16_bf16 v[96:111], v[188:191], a[156:159], v[96:111]
  s_waitcnt vmcnt(9)
  v_mfma_f32_32x32x16_bf16 v[80:95], v[192:195], a[160:163], v[80:95]
  buffer_load_dwordx4 a[192:195], v28, s[16:19], s85 offen offset:0 sc1
  v_mfma_f32_32x32x16_bf16 v[96:111], v[196:199], a[160:163], v[96:111]
  s_waitcnt vmcnt(9)
  v_mfma_f32_32x32x16_bf16 v[80:95], v[200:203], a[164:167], v[80:95]
  buffer_load_dwordx4 a[196:199], v28, s[16:19], s85 offen offset:1024 sc1
  v_mfma_f32_32x32x16_bf16 v[96:111], v[204:207], a[164:167], v[96:111]
  buffer_load_dwordx4 a[200:203], v28, s[16:19], s85 offen offset:2048 sc1
  buffer_load_dwordx4 a[204:207], v28, s[16:19], s85 offen offset:3072 sc1
  s_waitcnt vmcnt(9) lgkmcnt(0)
  v_mfma_f32_32x32x16_bf16 v[80:95], a[112:115], a[168:171], v[80:95]
  buffer_load_dwordx4 a[0:3], v28, s[16:19], s8 offen offset:0 sc1
  ds_read_b64_tr_b16 a[112:113], v24 offset:17920
  ds_read_b64_tr_b16 a[114:115], v24 offset:18944
  v_mfma_f32_32x32x16_bf16 v[96:111], a[116:119], a[168:171], v[96:111]
  ds_read_b64_tr_b16 a[116:117], v25 offset:17920
  ds_read_b64_tr_b16 a[118:119], v25 offset:18944
  buffer_load_dwordx4 a[4:7], v28, s[16:19], s8 offen offset:1024 sc1
  s_waitcnt vmcnt(10)
  v_mfma_f32_32x32x16_bf16 v[80:95], a[120:123], a[172:175], v[80:95]
  ds_read_b64_tr_b16 a[120:121], v24 offset:19968
  ds_read_b64_tr_b16 a[122:123], v33 offset:20992
  v_mfma_f32_32x32x16_bf16 v[96:111], a[124:127], a[172:175], v[96:111]
  ds_read_b64_tr_b16 a[124:125], v25 offset:19968
  ds_read_b64_tr_b16 a[126:127], v34 offset:20992
  s_waitcnt vmcnt(9)
  v_mfma_f32_32x32x16_bf16 v[80:95], a[128:131], a[176:179], v[80:95]
  buffer_load_dwordx4 a[8:11], v28, s[16:19], s8 offen offset:2048 sc1
  ds_read_b64_tr_b16 a[128:129], v24 offset:21504
  ds_read_b64_tr_b16 a[130:131], v24 offset:22528
  v_mfma_f32_32x32x16_bf16 v[96:111], a[132:135], a[176:179], v[96:111]
  ds_read_b64_tr_b16 a[132:133], v25 offset:21504
  ds_read_b64_tr_b16 a[134:135], v25 offset:22528
  buffer_load_dwordx4 a[12:15], v28, s[16:19], s8 offen offset:3072 sc1
  s_waitcnt vmcnt(10)
  v_mfma_f32_32x32x16_bf16 v[80:95], a[136:139], a[180:183], v[80:95]
  ds_read_b64_tr_b16 a[136:137], v24 offset:23552
  ds_read_b64_tr_b16 a[138:139], v33 offset:24576
  v_mfma_f32_32x32x16_bf16 v[96:111], a[140:143], a[180:183], v[96:111]
  ds_read_b64_tr_b16 a[140:141], v25 offset:23552
  ds_read_b64_tr_b16 a[142:143], v34 offset:24576
  buffer_load_dwordx4 a[16:19], v28, s[16:19], s9 offen offset:0 sc1
  s_waitcnt vmcnt(10) lgkmcnt(8)
  v_mfma_f32_32x32x16_bf16 v[80:95], a[112:115], a[184:187], v[80:95]
  ds_read_b64_tr_b16 a[112:113], v24 offset:25088
  ds_read_b64_tr_b16 a[114:115], v24 offset:26112
  v_mfma_f32_32x32x16_bf16 v[96:111], a[116:119], a[184:187], v[96:111]
  ds_read_b64_tr_b16 a[116:117], v25 offset:25088
  ds_read_b64_tr_b16 a[118:119], v25 offset:26112
  s_waitcnt vmcnt(9)
  v_mfma_f32_32x32x16_bf16 v[80:95], a[120:123], a[188:191], v[80:95]
  buffer_load_dwordx4 a[20:23], v28, s[16:19], s9 offen offset:1024 sc1
  ds_read_b64_tr_b16 a[120:121], v24 offset:27136
  ds_read_b64_tr_b16 a[122:123], v33 offset:28160
  v_mfma_f32_32x32x16_bf16 v[96:111], a[124:127], a[188:191], v[96:111]
  ds_read_b64_tr_b16 a[124:125], v25 offset:27136
  ds_read_b64_tr_b16 a[126:127], v34 offset:28160
  buffer_load_dwordx4 a[24:27], v28, s[16:19], s9 offen offset:2048 sc1
  s_waitcnt vmcnt(10) lgkmcnt(5)
  v_mfma_f32_32x32x16_bf16 v[80:95], a[128:131], a[192:195], v[80:95]
  v_mfma_f32_32x32x16_bf16 v[96:111], a[132:135], a[192:195], v[96:111]
  s_waitcnt lgkmcnt(0)
  s_barrier
  ds_read_b64_tr_b16 a[128:129], v31 offset:0
  ds_read_b64_tr_b16 a[130:131], v31 offset:2048
  ds_read_b64_tr_b16 a[132:133], v32 offset:0
  ds_read_b64_tr_b16 a[134:135], v32 offset:2048
  s_waitcnt vmcnt(9)
  v_mfma_f32_32x32x16_bf16 v[80:95], a[136:139], a[196:199], v[80:95]
  buffer_load_dwordx4 a[28:31], v28, s[16:19], s9 offen offset:3072 sc1
  ds_read_b64_tr_b16 a[136:137], v31 offset:512
  ds_read_b64_tr_b16 a[138:139], v31 offset:2560
  v_mfma_f32_32x32x16_bf16 v[96:111], a[140:143], a[196:199], v[96:111]
  ds_read_b64_tr_b16 a[140:141], v32 offset:512
  ds_read_b64_tr_b16 a[142:143], v32 offset:2560
  buffer_load_dwordx4 a[32:35], v28, s[16:19], s10 offen offset:0 sc1
  s_waitcnt vmcnt(10)
  v_mfma_f32_32x32x16_bf16 v[80:95], a[112:115], a[200:203], v[80:95]
  ds_read_b64_tr_b16 a[112:113], v31 offset:4096
  ds_read_b64_tr_b16 a[114:115], v31 offset:6144
  v_mfma_f32_32x32x16_bf16 v[96:111], a[116:119], a[200:203], v[96:111]
  ds_read_b64_tr_b16 a[116:117], v32 offset:4096
  ds_read_b64_tr_b16 a[118:119], v32 offset:6144
  buffer_load_dwordx4 a[36:39], v28, s[16:19], s10 offen offset:1024 sc1
  s_waitcnt vmcnt(10)
  v_mfma_f32_32x32x16_bf16 v[80:95], a[120:123], a[204:207], v[80:95]
  ds_read_b64_tr_b16 a[120:121], v31 offset:4608
  ds_read_b64_tr_b16 a[122:123], v31 offset:6656
  v_mfma_f32_32x32x16_bf16 v[96:111], a[124:127], a[204:207], v[96:111]
  ds_read_b64_tr_b16 a[124:125], v32 offset:4608
  ds_read_b64_tr_b16 a[126:127], v32 offset:6656
  s_waitcnt vmcnt(9) lgkmcnt(5)
  v_mfma_f32_32x32x16_bf16 v[80:95], a[128:131], a[0:3], v[80:95]
  buffer_load_dwordx4 a[40:43], v28, s[16:19], s10 offen offset:2048 sc1
  ds_read_b64_tr_b16 a[128:129], v31 offset:8192
  ds_read_b64_tr_b16 a[130:131], v31 offset:10240
  v_mfma_f32_32x32x16_bf16 v[96:111], a[132:135], a[0:3], v[96:111]
  ds_read_b64_tr_b16 a[132:133], v32 offset:8192
  ds_read_b64_tr_b16 a[134:135], v32 offset:10240
  buffer_load_dwordx4 a[44:47], v28, s[16:19], s10 offen offset:3072 sc1
  s_waitcnt vmcnt(10)
  v_mfma_f32_32x32x16_bf16 v[80:95], a[136:139], a[4:7], v[80:95]
  ds_read_b64_tr_b16 a[136:137], v31 offset:8704
  ds_read_b64_tr_b16 a[138:139], v31 offset:10752
  v_mfma_f32_32x32x16_bf16 v[96:111], a[140:143], a[4:7], v[96:111]
  ds_read_b64_tr_b16 a[140:141], v32 offset:8704
  ds_read_b64_tr_b16 a[142:143], v32 offset:10752
  s_waitcnt vmcnt(9)
  v_mfma_f32_32x32x16_bf16 v[80:95], a[112:115], a[8:11], v[80:95]
  buffer_load_dwordx4 a[48:51], v28, s[16:19], s11 offen offset:0 sc1
  ds_read_b64_tr_b16 a[112:113], v31 offset:12288
  ds_read_b64_tr_b16 a[114:115], v31 offset:14336
  s_waitcnt lgkmcnt(2)
  v_mfma_f32_32x32x16_bf16 v[96:111], a[116:119], a[8:11], v[96:111]
  ds_read_b64_tr_b16 a[116:117], v32 offset:12288
  ds_read_b64_tr_b16 a[118:119], v32 offset:14336
  buffer_load_dwordx4 a[52:55], v28, s[16:19], s11 offen offset:1024 sc1
  s_waitcnt vmcnt(10)
  v_mfma_f32_32x32x16_bf16 v[80:95], a[120:123], a[12:15], v[80:95]
  ds_read_b64_tr_b16 a[120:121], v31 offset:12800
  ds_read_b64_tr_b16 a[122:123], v31 offset:14848
  v_mfma_f32_32x32x16_bf16 v[96:111], a[124:127], a[12:15], v[96:111]
  ds_read_b64_tr_b16 a[124:125], v32 offset:12800
  ds_read_b64_tr_b16 a[126:127], v32 offset:14848
  buffer_load_dwordx4 a[56:59], v28, s[16:19], s11 offen offset:2048 sc1
  s_waitcnt vmcnt(10)
  v_mfma_f32_32x32x16_bf16 v[80:95], a[128:131], a[16:19], v[80:95]
  ds_read_b64_tr_b16 a[128:129], v31 offset:16384
  ds_read_b64_tr_b16 a[130:131], v31 offset:18432
  v_mfma_f32_32x32x16_bf16 v[96:111], a[132:135], a[16:19], v[96:111]
  ds_read_b64_tr_b16 a[132:133], v32 offset:16384
  ds_read_b64_tr_b16 a[134:135], v32 offset:18432
  s_waitcnt vmcnt(9)
  v_mfma_f32_32x32x16_bf16 v[80:95], a[136:139], a[20:23], v[80:95]
  buffer_load_dwordx4 a[60:63], v28, s[16:19], s11 offen offset:3072 sc1
  ds_read_b64_tr_b16 a[136:137], v31 offset:16896
  ds_read_b64_tr_b16 a[138:139], v31 offset:18944
  v_mfma_f32_32x32x16_bf16 v[96:111], a[140:143], a[20:23], v[96:111]
  ds_read_b64_tr_b16 a[140:141], v32 offset:16896
  ds_read_b64_tr_b16 a[142:143], v32 offset:18944
  buffer_load_dwordx4 a[64:67], v28, s[16:19], s12 offen offset:0 sc1
  s_waitcnt vmcnt(10) lgkmcnt(6)
  v_mfma_f32_32x32x16_bf16 v[80:95], a[112:115], a[24:27], v[80:95]
  ds_read_b64_tr_b16 a[112:113], v31 offset:20480
  ds_read_b64_tr_b16 a[114:115], v31 offset:22528
  v_mfma_f32_32x32x16_bf16 v[96:111], a[116:119], a[24:27], v[96:111]
  ds_read_b64_tr_b16 a[116:117], v32 offset:20480
  ds_read_b64_tr_b16 a[118:119], v32 offset:22528
  s_waitcnt vmcnt(9)
  v_mfma_f32_32x32x16_bf16 v[80:95], a[120:123], a[28:31], v[80:95]
  buffer_load_dwordx4 a[68:71], v28, s[16:19], s12 offen offset:1024 sc1
  ds_read_b64_tr_b16 a[120:121], v31 offset:20992
  ds_read_b64_tr_b16 a[122:123], v31 offset:23040
  v_mfma_f32_32x32x16_bf16 v[96:111], a[124:127], a[28:31], v[96:111]
  ds_read_b64_tr_b16 a[124:125], v32 offset:20992
  ds_read_b64_tr_b16 a[126:127], v32 offset:23040
  buffer_load_dwordx4 a[72:75], v28, s[16:19], s12 offen offset:2048 sc1
  s_waitcnt vmcnt(10)
  v_mfma_f32_32x32x16_bf16 v[80:95], a[128:131], a[32:35], v[80:95]
  ds_read_b64_tr_b16 a[128:129], v31 offset:24576
  ds_read_b64_tr_b16 a[130:131], v31 offset:26624
  s_waitcnt lgkmcnt(6)
  v_mfma_f32_32x32x16_bf16 v[96:111], a[132:135], a[32:35], v[96:111]
  ds_read_b64_tr_b16 a[132:133], v32 offset:24576
  ds_read_b64_tr_b16 a[134:135], v32 offset:26624
  buffer_load_dwordx4 a[76:79], v28, s[16:19], s12 offen offset:3072 sc1
  s_waitcnt vmcnt(10)
  v_mfma_f32_32x32x16_bf16 v[80:95], a[136:139], a[36:39], v[80:95]
  ds_read_b64_tr_b16 a[136:137], v31 offset:25088
  ds_read_b64_tr_b16 a[138:139], v31 offset:27136
  v_mfma_f32_32x32x16_bf16 v[96:111], a[140:143], a[36:39], v[96:111]
  ds_read_b64_tr_b16 a[140:141], v32 offset:25088
  ds_read_b64_tr_b16 a[142:143], v32 offset:27136
  s_waitcnt vmcnt(9)
  v_mfma_f32_32x32x16_bf16 v[80:95], a[112:115], a[40:43], v[80:95]
  buffer_load_dwordx4 a[80:83], v28, s[16:19], s13 offen offset:0 sc1
  ds_read_b64_tr_b16 a[112:113], v31 offset:28672
  ds_read_b64_tr_b16 a[114:115], v31 offset:30720
  v_mfma_f32_32x32x16_bf16 v[96:111], a[116:119], a[40:43], v[96:111]
  ds_read_b64_tr_b16 a[116:117], v32 offset:28672
  ds_read_b64_tr_b16 a[118:119], v32 offset:30720
  buffer_load_dwordx4 a[84:87], v28, s[16:19], s13 offen offset:1024 sc1
  s_waitcnt vmcnt(10) lgkmcnt(5)
  v_mfma_f32_32x32x16_bf16 v[80:95], a[120:123], a[44:47], v[80:95]
  ds_read_b64_tr_b16 a[120:121], v31 offset:29184
  ds_read_b64_tr_b16 a[122:123], v31 offset:31232
  v_mfma_f32_32x32x16_bf16 v[96:111], a[124:127], a[44:47], v[96:111]
  ds_read_b64_tr_b16 a[124:125], v32 offset:29184
  ds_read_b64_tr_b16 a[126:127], v32 offset:31232
  s_waitcnt vmcnt(9)
  v_mfma_f32_32x32x16_bf16 v[80:95], a[128:131], a[48:51], v[80:95]
  buffer_load_dwordx4 a[88:91], v28, s[16:19], s13 offen offset:2048 sc1
  ds_read_b64_tr_b16 a[128:129], v31 offset:32768
  ds_read_b64_tr_b16 a[130:131], v31 offset:34816
  v_mfma_f32_32x32x16_bf16 v[96:111], a[132:135], a[48:51], v[96:111]
  ds_read_b64_tr_b16 a[132:133], v32 offset:32768
  ds_read_b64_tr_b16 a[134:135], v32 offset:34816
  buffer_load_dwordx4 a[92:95], v28, s[16:19], s13 offen offset:3072 sc1
  s_waitcnt vmcnt(10)
  v_mfma_f32_32x32x16_bf16 v[80:95], a[136:139], a[52:55], v[80:95]
  ds_read_b64_tr_b16 a[136:137], v31 offset:33280
  ds_read_b64_tr_b16 a[138:139], v31 offset:35328
  s_waitcnt lgkmcnt(6)
  v_mfma_f32_32x32x16_bf16 v[96:111], a[140:143], a[52:55], v[96:111]
  ds_read_b64_tr_b16 a[140:141], v32 offset:33280
  ds_read_b64_tr_b16 a[142:143], v32 offset:35328
  buffer_load_dwordx4 a[96:99], v28, s[16:19], s14 offen offset:0 sc1
  s_waitcnt vmcnt(10)
  v_mfma_f32_32x32x16_bf16 v[80:95], a[112:115], a[56:59], v[80:95]
  ds_read_b64_tr_b16 a[112:113], v31 offset:36864
  ds_read_b64_tr_b16 a[114:115], v31 offset:38912
  v_mfma_f32_32x32x16_bf16 v[96:111], a[116:119], a[56:59], v[96:111]
  ds_read_b64_tr_b16 a[116:117], v32 offset:36864
  ds_read_b64_tr_b16 a[118:119], v32 offset:38912
  s_waitcnt vmcnt(9)
  v_mfma_f32_32x32x16_bf16 v[80:95], a[120:123], a[60:63], v[80:95]
  buffer_load_dwordx4 a[100:103], v28, s[16:19], s14 offen offset:1024 sc1
  ds_read_b64_tr_b16 a[120:121], v31 offset:37376
  ds_read_b64_tr_b16 a[122:123], v31 offset:39424
  v_mfma_f32_32x32x16_bf16 v[96:111], a[124:127], a[60:63], v[96:111]
  ds_read_b64_tr_b16 a[124:125], v32 offset:37376
  ds_read_b64_tr_b16 a[126:127], v32 offset:39424
  buffer_load_dwordx4 a[104:107], v28, s[16:19], s14 offen offset:2048 sc1
  s_waitcnt vmcnt(10) lgkmcnt(5)
  v_mfma_f32_32x32x16_bf16 v[80:95], a[128:131], a[64:67], v[80:95]
  ds_read_b64_tr_b16 a[128:129], v31 offset:40960
  ds_read_b64_tr_b16 a[130:131], v31 offset:43008
  v_mfma_f32_32x32x16_bf16 v[96:111], a[132:135], a[64:67], v[96:111]
  ds_read_b64_tr_b16 a[132:133], v32 offset:40960
  ds_read_b64_tr_b16 a[134:135], v32 offset:43008
  s_waitcnt vmcnt(9)
  v_mfma_f32_32x32x16_bf16 v[80:95], a[136:139], a[68:71], v[80:95]
  buffer_load_dwordx4 a[108:111], v28, s[16:19], s14 offen offset:3072 sc1
  ds_read_b64_tr_b16 a[136:137], v31 offset:41472
  ds_read_b64_tr_b16 a[138:139], v31 offset:43520
  v_mfma_f32_32x32x16_bf16 v[96:111], a[140:143], a[68:71], v[96:111]
  ds_read_b64_tr_b16 a[140:141], v32 offset:41472
  ds_read_b64_tr_b16 a[142:143], v32 offset:43520
  s_waitcnt vmcnt(9)
  v_mfma_f32_32x32x16_bf16 v[80:95], a[112:115], a[72:75], v[80:95]
  ds_read_b64_tr_b16 a[112:113], v31 offset:45056
  ds_read_b64_tr_b16 a[114:115], v31 offset:47104
  s_waitcnt lgkmcnt(6)
  v_mfma_f32_32x32x16_bf16 v[96:111], a[116:119], a[72:75], v[96:111]
  ds_read_b64_tr_b16 a[116:117], v32 offset:45056
  ds_read_b64_tr_b16 a[118:119], v32 offset:47104
  s_waitcnt vmcnt(8)
  v_mfma_f32_32x32x16_bf16 v[80:95], a[120:123], a[76:79], v[80:95]
  ds_read_b64_tr_b16 a[120:121], v31 offset:45568
  ds_read_b64_tr_b16 a[122:123], v31 offset:47616
  v_mfma_f32_32x32x16_bf16 v[96:111], a[124:127], a[76:79], v[96:111]
  ds_read_b64_tr_b16 a[124:125], v32 offset:45568
  ds_read_b64_tr_b16 a[126:127], v32 offset:47616
  s_waitcnt vmcnt(7)
  v_mfma_f32_32x32x16_bf16 v[80:95], a[128:131], a[80:83], v[80:95]
  ds_read_b64_tr_b16 a[128:129], v31 offset:49152
  ds_read_b64_tr_b16 a[130:131], v31 offset:51200
  v_mfma_f32_32x32x16_bf16 v[96:111], a[132:135], a[80:83], v[96:111]
  ds_read_b64_tr_b16 a[132:133], v32 offset:49152
  ds_read_b64_tr_b16 a[134:135], v32 offset:51200
  s_waitcnt vmcnt(6) lgkmcnt(5)
  v_mfma_f32_32x32x16_bf16 v[80:95], a[136:139], a[84:87], v[80:95]
  ds_read_b64_tr_b16 a[136:137], v31 offset:49664
  ds_read_b64_tr_b16 a[138:139], v31 offset:51712
  v_mfma_f32_32x32x16_bf16 v[96:111], a[140:143], a[84:87], v[96:111]
  ds_read_b64_tr_b16 a[140:141], v32 offset:49664
  ds_read_b64_tr_b16 a[142:143], v32 offset:51712
  s_waitcnt vmcnt(5)
  v_mfma_f32_32x32x16_bf16 v[80:95], a[112:115], a[88:91], v[80:95]
  ds_read_b64_tr_b16 a[112:113], v31 offset:53248
  ds_read_b64_tr_b16 a[114:115], v31 offset:55296
  v_mfma_f32_32x32x16_bf16 v[96:111], a[116:119], a[88:91], v[96:111]
  ds_read_b64_tr_b16 a[116:117], v32 offset:53248
  ds_read_b64_tr_b16 a[118:119], v32 offset:55296
  s_waitcnt vmcnt(4)
  v_mfma_f32_32x32x16_bf16 v[80:95], a[120:123], a[92:95], v[80:95]
  ds_read_b64_tr_b16 a[120:121], v31 offset:53760
  ds_read_b64_tr_b16 a[122:123], v31 offset:55808
  s_waitcnt lgkmcnt(6)
  v_mfma_f32_32x32x16_bf16 v[96:111], a[124:127], a[92:95], v[96:111]
  ds_read_b64_tr_b16 a[124:125], v32 offset:53760
  ds_read_b64_tr_b16 a[126:127], v32 offset:55808
  s_waitcnt vmcnt(3)
  v_mfma_f32_32x32x16_bf16 v[80:95], a[128:131], a[96:99], v[80:95]
  v_mfma_f32_32x32x16_bf16 v[96:111], a[132:135], a[96:99], v[96:111]
  s_waitcnt vmcnt(2)
  v_mfma_f32_32x32x16_bf16 v[80:95], a[136:139], a[100:103], v[80:95]
  v_mfma_f32_32x32x16_bf16 v[96:111], a[140:143], a[100:103], v[96:111]
  s_waitcnt vmcnt(1) lgkmcnt(0)
  v_mfma_f32_32x32x16_bf16 v[80:95], a[112:115], a[104:107], v[80:95]
  v_mfma_f32_32x32x16_bf16 v[96:111], a[116:119], a[104:107], v[96:111]
  s_waitcnt vmcnt(0)
  v_mfma_f32_32x32x16_bf16 v[80:95], a[120:123], a[108:111], v[80:95]
  v_mfma_f32_32x32x16_bf16 v[96:111], a[124:127], a[108:111], v[96:111]
  s_nop 10
  ds_write_b128 v144, v[80:83]
  ds_write_b128 v145, v[84:87]
  ds_write_b128 v146, v[88:91]
  ds_write_b128 v147, v[92:95]
  ds_write_b128 v148, v[96:99]
  ds_write_b128 v149, v[100:103]
  ds_write_b128 v150, v[104:107]
  ds_write_b128 v151, v[108:111]
  s_waitcnt lgkmcnt(0)
  s_barrier
  ds_read_b128 v[160:163], v152 offset:0
  ds_read_b128 v[164:167], v153 offset:0
  ds_read_b128 v[168:171], v152 offset:16384
  ds_read_b128 v[172:175], v153 offset:16384
  ds_read_b128 v[176:179], v154 offset:2048
  ds_read_b128 v[180:183], v155 offset:2048
  ds_read_b128 v[184:187], v154 offset:18432
  ds_read_b128 v[188:191], v155 offset:18432
  s_waitcnt lgkmcnt(5)
  v_pk_add_f32 v[160:161], v[160:161], v[168:169]
  v_pk_add_f32 v[162:163], v[162:163], v[170:171]
  s_waitcnt lgkmcnt(4)
  v_pk_add_f32 v[164:165], v[164:165], v[172:173]
  v_pk_add_f32 v[166:167], v[166:167], v[174:175]
  v_cvt_pk_bf16_f32 v168, v160, v161
  v_cvt_pk_bf16_f32 v169, v162, v163
  v_cvt_pk_bf16_f32 v170, v164, v165
  v_cvt_pk_bf16_f32 v171, v166, v167
  buffer_store_dwordx4 v[168:171], v23, s[32:35], s90 offen sc1
  s_waitcnt lgkmcnt(1)
  v_pk_add_f32 v[176:177], v[176:177], v[184:185]
  v_pk_add_f32 v[178:179], v[178:179], v[186:187]
  s_waitcnt lgkmcnt(0)
  v_pk_add_f32 v[180:181], v[180:181], v[188:189]
  v_pk_add_f32 v[182:183], v[182:183], v[190:191]
  v_cvt_pk_bf16_f32 v184, v176, v177
  v_cvt_pk_bf16_f32 v185, v178, v179
  v_cvt_pk_bf16_f32 v186, v180, v181
  v_cvt_pk_bf16_f32 v187, v182, v183
  buffer_store_dwordx4 v[184:187], v23, s[32:35], s91 offen sc1
  s_endpgm
.p2align 6
Lhelper:
  s_mov_b32 s10, 1204224
  s_mov_b32 s11, s7
  s_lshl1_add_u32 s69, s48, s49
  s_lshl2_add_u32 s62, s69, s51
  s_mul_i32 s62, s62, 10752
  v_lshlrev_b32 v28, 4, v0
  v_add_u32 v12, s62, v28
  v_min_u32 v1, 640, v28
  v_add_u32 v13, s62, v1
  s_mul_i32 s64, s51, 12544
  s_waitcnt lgkmcnt(0)
  s_load_dwordx2 s[20:21], s[0:1], 48
  s_load_dwordx2 s[36:37], s[0:1], 16
  s_load_dwordx2 s[44:45], s[0:1], 72
  s_load_dwordx2 s[40:41], s[0:1], 56
  s_load_dwordx2 s[24:25], s[0:1], 24
  s_load_dwordx2 s[28:29], s[0:1], 64
  s_load_dwordx2 s[32:33], s[0:1], 80
  s_add_u32 m0, s64, 65536
  s_movk_i32 s65, 0
  buffer_load_dwordx4 v12, s[8:11], s65 offen offset:0 lds
  buffer_load_dwordx4 v12, s[8:11], s65 offen offset:1024 lds
  buffer_load_dwordx4 v13, s[8:11], s65 offen offset:2048 lds
  s_add_u32 m0, s64, 68672
  s_movk_i32 s65, 2688
  buffer_load_dwordx4 v12, s[8:11], s65 offen offset:0 lds
  buffer_load_dwordx4 v12, s[8:11], s65 offen offset:1024 lds
  buffer_load_dwordx4 v13, s[8:11], s65 offen offset:2048 lds
  s_add_u32 m0, s64, 71808
  s_movk_i32 s65, 5376
  buffer_load_dwordx4 v12, s[8:11], s65 offen offset:0 lds
  buffer_load_dwordx4 v12, s[8:11], s65 offen offset:1024 lds
  buffer_load_dwordx4 v13, s[8:11], s65 offen offset:2048 lds
  s_mov_b32 s18, 27262976
  s_mov_b32 s19, s7
  s_mov_b32 s22, 8388608
  s_mov_b32 s23, s7
  s_mov_b32 s38, 25088
  s_mov_b32 s39, s7
  s_mov_b32 s46, 896
  s_mov_b32 s47, s7
  s_mov_b32 s42, 4096
  s_mov_b32 s43, s7
  s_mov_b32 s26, 401408
  s_mov_b32 s27, s7
  s_mov_b32 s30, 802816
  s_mov_b32 s31, s7
  s_mov_b32 s34, 1835008
  s_mov_b32 s35, s7
  s_lshl3_add_u32 s53, s49, s50
  s_lshl_b32 s60, s51, 12
  s_mov_b32 s70, 0x3fb8aa3b
  v_lshrrev_b32 v1, 2, v0
  s_lshl_b32 s62, s69, 5
  v_lshl_add_u32 v14, v1, 1, s62
  v_mov_b32 v47, 0
  s_waitcnt lgkmcnt(0)
  buffer_load_dword v47, v47, s[16:19], 0 offen sc1
  buffer_load_ushort v14, v14, s[44:47], 0 offen
  v_and_b32 v3, 3, v0
  v_mul_u32_u24 v1, 3136, v1
  v_lshl_add_u32 v1, v3, 4, v1
  s_mul_i32 s62, s51, 224
  s_add_u32 s62, s62, 65536
  v_add_u32 v29, s62, v1
  v_cmp_eq_u32 vcc, 3, v3
  v_mov_b32 v2, 0xffff
  s_nop 0
  v_cndmask_b32 v15, 0, v2, vcc
  s_add_u32 m0, s64, 74944
  s_movk_i32 s65, 8064
  buffer_load_dwordx4 v12, s[8:11], s65 offen offset:0 lds
  buffer_load_dwordx4 v12, s[8:11], s65 offen offset:1024 lds
  buffer_load_dwordx4 v13, s[8:11], s65 offen offset:2048 lds
  s_cmp_lt_u32 s69, 28
  s_cselect_b32 s64, 0, 1073741824
  s_mul_i32 s62, s51, 344064
  s_lshl_b32 s63, s69, 10
  s_add_u32 s62, s62, s63
  s_add_u32 s62, s62, s64
  v_add_u32 v13, s62, v28
  s_add_u32 s63, s63, 27648
  v_add_u32 v12, s63, v13
  s_lshl2_add_u32 s62, s48, s51
  s_mul_i32 s62, s62, 28672
  v_lshrrev_b32 v1, 3, v0
  v_mul_u32_u24 v1, 896, v1
  v_add_u32 v1, s62, v1
  v_lshrrev_b32 v2, 4, v0
  v_xor_b32 v2, v0, v2
  v_and_b32 v2, 7, v2
  v_lshl_add_u32 v8, v2, 4, v1
  v_xor_b32 v2, 64, v8
  v_add_u32 v9, 6144, v2
  v_add_u32 v10, 12288, v8
  v_add_u32 v11, 18432, v2
  s_add_u32 s61, s61, 1
  s_sub_u32 s63, s61, 7
  s_min_u32 s61, s61, s63
  s_lshl_b32 s75, s61, 7
  s_add_u32 s61, s61, 1
  s_sub_u32 s63, s61, 7
  s_min_u32 s61, s61, s63
  s_lshl_b32 s76, s61, 7
  s_add_u32 s61, s61, 1
  s_sub_u32 s63, s61, 7
  s_min_u32 s61, s61, s63
  s_lshl_b32 s77, s61, 7
  s_add_u32 s61, s61, 1
  s_sub_u32 s63, s61, 7
  s_min_u32 s61, s61, s63
  s_lshl_b32 s78, s61, 7
  s_add_u32 s61, s61, 1
  s_sub_u32 s63, s61, 7
  s_min_u32 s61, s61, s63
  s_lshl_b32 s79, s61, 7
  s_add_u32 s61, s61, 1
  s_sub_u32 s63, s61, 7
  s_min_u32 s61, s61, s63
  s_lshl_b32 s80, s61, 7
  s_bitcmp1_b32 s48, 0
  s_mov_b32 s62, 1985160208
  s_mov_b32 s63, 1967534338
  s_cselect_b32 s62, 1984123393, s62
  s_cselect_b32 s63, 1702109488, s63
  s_bitcmp1_b32 s48, 1
  s_cselect_b32 s62, s63, s62
  s_mul_i32 s63, s50, 0x11111111
  s_add_u32 s62, s62, s63
  s_and_b32 s66, s62, 0x77777777
  s_lshl2_add_u32 s62, s48, s51
  s_lshl_b32 s62, s62, 17
  s_lshl_b32 s63, s49, 11
  s_add_u32 s62, s62, s63
  v_and_b32 v1, 31, v0
  v_lshlrev_b32 v1, 12, v1
  v_lshrrev_b32 v2, 5, v0
  v_lshl_add_u32 v1, v2, 7, v1
  v_add_u32 v50, s62, v1
  s_waitcnt vmcnt(0)
  s_barrier
  ds_read_b64 v[80:81], v29 offset:896
  ds_read_b64 v[82:83], v29 offset:904
  ds_read_b64 v[84:85], v29 offset:1792
  ds_read_b64 v[86:87], v29 offset:1800
  ds_read_b64 v[88:89], v29 offset:0
  ds_read_b64 v[90:91], v29 offset:8
  ds_read_b64 v[92:93], v29 offset:952
  ds_read_b64 v[94:95], v29 offset:960
  ds_read_b64 v[96:97], v29 offset:1848
  ds_read_b64 v[98:99], v29 offset:1856
  ds_read_b64 v[100:101], v29 offset:56
  ds_read_b64 v[102:103], v29 offset:64
  ds_read_b64 v[104:105], v29 offset:1008
  ds_read_b64 v[106:107], v29 offset:1016
  ds_read_b64 v[108:109], v29 offset:1904
  ds_read_b64 v[110:111], v29 offset:1912
  ds_read_b64 v[112:113], v29 offset:112
  ds_read_b64 v[114:115], v29 offset:120
  ds_read_b64 v[116:117], v29 offset:1064
  ds_read_b64 v[118:119], v29 offset:1072
  ds_read_b64 v[120:121], v29 offset:1960
  ds_read_b64 v[122:123], v29 offset:1968
  ds_read_b64 v[124:125], v29 offset:168
  ds_read_b64 v[126:127], v29 offset:176
  v_readfirstlane_b32 s54, v47
  s_nop 0
  s_add_u32 s54, s54, 2654435769
  s_lshr_b32 s55, s54, 8
  s_lshr_b32 s56, s54, 16
  s_lshr_b32 s57, s54, 24
  v_mov_b32 v53, s54
  s_waitcnt lgkmcnt(15)
  v_bfi_b32 v82, v15, v14, v82
  s_mov_b32 s65, 25165824
  buffer_store_dwordx4 v[80:83], v13, s[16:19], s65 offen offset:0 sc1
  buffer_store_dwordx4 v[84:87], v12, s[16:19], s65 offen offset:1024 sc1
  buffer_store_dwordx4 v[88:91], v12, s[16:19], s65 offen offset:2048 sc1
  v_bfi_b32 v94, v15, v14, v94
  s_mov_b32 s65, 25251840
  buffer_store_dwordx4 v[92:95], v13, s[16:19], s65 offen offset:0 sc1
  s_waitcnt lgkmcnt(0)
  buffer_store_dwordx4 v[96:99], v12, s[16:19], s65 offen offset:1024 sc1
  buffer_store_dwordx4 v[100:103], v12, s[16:19], s65 offen offset:2048 sc1
  v_bfi_b32 v106, v15, v14, v106
  s_mov_b32 s65, 25337856
  buffer_store_dwordx4 v[104:107], v13, s[16:19], s65 offen offset:0 sc1
  buffer_store_dwordx4 v[108:111], v12, s[16:19], s65 offen offset:1024 sc1
  buffer_store_dwordx4 v[112:115], v12, s[16:19], s65 offen offset:2048 sc1
  v_bfi_b32 v118, v15, v14, v118
  s_mov_b32 s65, 25423872
  buffer_store_dwordx4 v[116:119], v13, s[16:19], s65 offen offset:0 sc1
  buffer_store_dwordx4 v[120:123], v12, s[16:19], s65 offen offset:1024 sc1
  buffer_store_dwordx4 v[124:127], v12, s[16:19], s65 offen offset:2048 sc1
  v_and_b32 v1, 31, v0
  v_lshlrev_b32 v1, 7, v1
  v_add_u32 v1, s58, v1
  v_bfe_u32 v2, v0, 1, 3
  v_lshrrev_b32 v20, 5, v0
  v_xor_b32 v2, v2, v20
  v_lshl_add_u32 v20, v2, 4, v1
  v_xor_b32 v21, 32, v20
  v_xor_b32 v22, 64, v20
  v_xor_b32 v23, 96, v20
  v_bfe_u32 v3, v0, 2, 2
  v_and_b32 v4, 3, v0
  v_lshlrev_b32 v4, 3, v4
  v_and_b32 v5, 16, v0
  v_lshl_add_u32 v4, v5, 1, v4
  v_lshrrev_b32 v5, 5, v0
  s_mul_i32 s62, s53, 86016
  s_add_u32 s62, s62, 25165824
  s_lshl_b32 s67, s51, 10
  s_add_u32 s62, s62, s67
  v_add_u32 v18, s62, v28
  s_add_u32 s62, s67, 28672
  v_add_u32 v19, s62, v18
  s_lshl_b32 s88, s74, 6
  s_lshl_b32 s89, s75, 6
  s_lshl_b32 s90, s76, 6
  s_lshl_b32 s91, s77, 6
  s_lshl_b32 s92, s78, 6
  s_lshl_b32 s93, s79, 6
  s_lshl_b32 s94, s80, 6
  v_lshl_add_u32 v1, v5, 3, v3
  v_lshl_add_u32 v26, v1, 6, v4
  v_add_u32 v26, 65536, v26
  v_lshl_add_u32 v1, v5, 2, v3
  v_lshl_add_u32 v27, v1, 6, v4
  v_add_u32 v27, 155648, v27
  v_lshrrev_b32 v1, 3, v0
  v_and_b32 v1, 4, v1
  v_xor_b32 v1, v0, v1
  v_lshlrev_b32 v1, 4, v1
  s_add_u32 s62, s60, 131072
  v_add_u32 v31, s62, v1
  v_xor_b32 v32, 1152, v31
  s_lshr_b32 s63, s51, 1
  s_lshl_b32 s64, s63, 11
  s_add_u32 s64, s64, 131072
  v_bfe_u32 v1, v0, 4, 1
  v_and_b32 v2, 1, v0
  v_lshl_add_u32 v1, v1, 1, v2
  v_lshrrev_b32 v2, 5, v0
  v_lshlrev_b32 v2, 0, v2
  v_xor_b32 v2, v2, v1
  v_lshlrev_b32 v33, 9, v1
  v_lshl_add_u32 v33, v2, 6, v33
  v_and_b32 v1, 14, v0
  v_lshl_add_u32 v33, v1, 2, v33
  v_add_u32 v33, s64, v33
  v_xor_b32 v34, 128, v33
  v_add_u32 v41, 147456, v28
  v_add_u32 v42, s59, v41
  v_mov_b32 v43, 0x3f803f80
  v_mov_b32 v44, 0xff
  v_and_b32 v1, 31, v0
  v_cmp_eq_u32 s[72:73], 28, v1
  s_lshl1_add_u32 s63, s53, s63
  s_lshl_b32 s63, s63, 6
  s_add_u32 s63, s63, s48
  s_lshl_b32 s63, s63, 10
  s_add_u32 s95, s63, 1048576
  s_and_b32 s63, s51, 1
  s_sub_u32 s44, 0, s63
  s_mov_b32 s45, s44
  s_lshl_b32 s63, s63, 15
  s_add_u32 s95, s95, s63
  v_add_u32 v49, 0x4000, v28
  v_bfe_u32 v1, v0, 2, 2
  v_and_b32 v2, 1, v0
  v_lshl_add_u32 v1, v1, 1, v2
  v_cmp_eq_u32 vcc, 7, v1
  v_bfe_u32 v2, v0, 1, 1
  v_mad_u32_u24 v1, v2, 7, v1
  v_lshrrev_b32 v2, 4, v0
  v_mad_u32_u24 v1, v2, 14, v1
  v_lshlrev_b32 v1, 2, v1
  v_mov_b32 v2, 1073741824
  v_cndmask_b32 v45, v1, v2, vcc
  s_cmp_eq_u32 s51, 3
  s_cselect_b32 s64, 1073741824, 0
  v_or_b32 v46, s64, v45
  s_lshl_b32 s62, s69, 7
  s_add_u32 s46, s62, 98304
  v_lshrrev_b32 v1, 5, v0
  v_or_b32 v1, s51, v1
  v_min_u32 v1, 1, v1
  v_lshlrev_b32 v1, 30, v1
  v_lshl_add_u32 v1, v0, 2, v1
  v_add_u32 v51, s46, v1
  s_mul_i32 s62, s51, 896
  s_add_u32 s62, s62, 98304
  s_mov_b32 s3, s62
  s_add_u32 s100, s16, s62
  s_addc_u32 s101, s17, 0
  s_waitcnt vmcnt(0)
  s_barrier
  s_cmp_lg_u32 s51, 0
  s_cbranch_scc1 Lsf3
  s_atomic_swap s54, s[16:17], s46
Lsf3:
  s_add_u32 m0, s58, 0
  s_nop 0
  buffer_load_dwordx4 v8, s[4:7], s74 offen offset:0 lds
  buffer_load_dwordx4 v9, s[4:7], s74 offen offset:1024 lds
  buffer_load_dwordx4 v10, s[4:7], s74 offen offset:2048 lds
  buffer_load_dwordx4 v11, s[4:7], s74 offen offset:3072 lds
  s_add_u32 m0, s58, 4096
  s_nop 0
  buffer_load_dwordx4 v8, s[4:7], s75 offen offset:0 lds
  buffer_load_dwordx4 v9, s[4:7], s75 offen offset:1024 lds
  buffer_load_dwordx4 v10, s[4:7], s75 offen offset:2048 lds
  buffer_load_dwordx4 v11, s[4:7], s75 offen offset:3072 lds
  s_add_u32 m0, s58, 8192
  s_nop 0
  buffer_load_dwordx4 v8, s[4:7], s76 offen offset:0 lds
  buffer_load_dwordx4 v9, s[4:7], s76 offen offset:1024 lds
  buffer_load_dwordx4 v10, s[4:7], s76 offen offset:2048 lds
  buffer_load_dwordx4 v11, s[4:7], s76 offen offset:3072 lds
  s_add_u32 m0, s58, 12288
  s_nop 0
  buffer_load_dwordx4 v8, s[4:7], s77 offen offset:0 lds
  buffer_load_dwordx4 v9, s[4:7], s77 offen offset:1024 lds
  buffer_load_dwordx4 v10, s[4:7], s77 offen offset:2048 lds
  buffer_load_dwordx4 v11, s[4:7], s77 offen offset:3072 lds
  s_waitcnt vmcnt(12)
  ds_read_b128 a[0:3], v20 offset:0
  ds_read_b128 a[4:7], v21 offset:0
  ds_read_b128 a[8:11], v22 offset:0
  ds_read_b128 a[12:15], v23 offset:0
  s_add_u32 m0, s58, 0
  s_waitcnt lgkmcnt(0)
  buffer_load_dwordx4 v8, s[4:7], s78 offen offset:0 lds
  buffer_load_dwordx4 v9, s[4:7], s78 offen offset:1024 lds
  buffer_load_dwordx4 v10, s[4:7], s78 offen offset:2048 lds
  buffer_load_dwordx4 v11, s[4:7], s78 offen offset:3072 lds
  s_waitcnt vmcnt(12)
  ds_read_b128 a[16:19], v20 offset:4096
  ds_read_b128 a[20:23], v21 offset:4096
  ds_read_b128 a[24:27], v22 offset:4096
  ds_read_b128 a[28:31], v23 offset:4096
  s_add_u32 m0, s58, 4096
  s_waitcnt lgkmcnt(0)
  buffer_load_dwordx4 v8, s[4:7], s79 offen offset:0 lds
  buffer_load_dwordx4 v9, s[4:7], s79 offen offset:1024 lds
  buffer_load_dwordx4 v10, s[4:7], s79 offen offset:2048 lds
  buffer_load_dwordx4 v11, s[4:7], s79 offen offset:3072 lds
  s_waitcnt vmcnt(12)
  ds_read_b128 a[32:35], v20 offset:8192
  ds_read_b128 a[36:39], v21 offset:8192
  ds_read_b128 a[40:43], v22 offset:8192
  ds_read_b128 a[44:47], v23 offset:8192
  s_add_u32 m0, s58, 8192
  s_waitcnt lgkmcnt(0)
  buffer_load_dwordx4 v8, s[4:7], s80 offen offset:0 lds
  buffer_load_dwordx4 v9, s[4:7], s80 offen offset:1024 lds
  buffer_load_dwordx4 v10, s[4:7], s80 offen offset:2048 lds
  buffer_load_dwordx4 v11, s[4:7], s80 offen offset:3072 lds
  v_and_b32 v1, 7, v0
  s_add_u32 s62, s67, 98304
  v_lshl_add_u32 v12, v1, 7, s62
  buffer_load_dword v13, v12, s[16:19], 0 offen sc1
  s_waitcnt vmcnt(0)
  v_cmp_ne_u32 vcc, s54, v13
  s_nop 0
  s_cbranch_vccnz Lslow_fw_8
Lback_fw_8:
  s_barrier
  s_lshl2_add_u32 s62, s51, s49
  s_lshl4_add_u32 s63, s62, s48
  s_lshl_b32 s63, s63, 7
  s_add_u32 s63, s63, 4096
  s_load_dword s86, s[16:17], s63 glc
  s_add_u32 s64, s63, 4096
  s_load_dword s87, s[16:17], s64 glc
  s_lshl4_add_u32 s62, s48, s62
  s_lshl_b32 s62, s62, 7
  s_add_u32 s62, s62, 65536
  s_load_dword s98, s[16:17], s62 glc
  s_add_u32 s65, s62, 256
  s_load_dword s99, s[16:17], s65 glc
  s_mul_i32 s65, s53, 1568
  s_mul_i32 s63, s51, 448
  s_add_u32 s63, s63, s65
  s_lshl_b32 s64, s51, 9
  s_add_u32 m0, s64, 155648
  s_nop 0
  buffer_load_dword v45, s[36:39], s63 offen lds
  s_add_u32 m0, s64, 155680
  s_nop 0
  buffer_load_dword v46, s[36:39], s63 offen offset:224 lds
  s_add_u32 m0, s67, 98304
  s_lshr_b32 s65, s88, 1
  ds_read_b128 a[48:51], v20 offset:12288
  ds_read_b128 a[52:55], v21 offset:12288
  ds_read_b128 a[56:59], v22 offset:12288
  s_and_b32 s62, s48, 3
  buffer_load_dwordx4 v18, s[16:19], s65 offen sc1 lds
  s_add_u32 m0, s67, 102400
  s_lshr_b32 s65, s89, 1
  ds_read_b128 a[60:63], v23 offset:12288
  ds_read_b128 a[64:67], v20 offset:0
  buffer_load_dwordx4 v18, s[16:19], s65 offen sc1 lds
  s_add_u32 m0, s67, 106496
  s_lshr_b32 s65, s90, 1
  ds_read_b128 a[68:71], v21 offset:0
  ds_read_b128 a[72:75], v22 offset:0
  buffer_load_dwordx4 v18, s[16:19], s65 offen sc1 lds
  s_add_u32 m0, s67, 110592
  s_lshr_b32 s65, s91, 1
  ds_read_b128 a[76:79], v23 offset:0
  ds_read_b128 a[80:83], v20 offset:4096
  buffer_load_dwordx4 v18, s[16:19], s65 offen sc1 lds
  s_add_u32 m0, s67, 114688
  s_lshr_b32 s65, s92, 1
  ds_read_b128 a[84:87], v21 offset:4096
  ds_read_b128 a[88:91], v22 offset:4096
  buffer_load_dwordx4 v18, s[16:19], s65 offen sc1 lds
  s_add_u32 m0, s67, 118784
  s_lshr_b32 s65, s93, 1
  ds_read_b128 a[92:95], v23 offset:4096
  ds_read_b128 a[96:99], v20 offset:8192
  buffer_load_dwordx4 v18, s[16:19], s65 offen sc1 lds
  s_add_u32 m0, s67, 122880
  s_lshr_b32 s65, s94, 1
  ds_read_b128 a[100:103], v21 offset:8192
  ds_read_b128 a[104:107], v22 offset:8192
  buffer_load_dwordx4 v18, s[16:19], s65 offen sc1 lds
  s_add_u32 m0, s59, 65536
  ds_read_b128 a[108:111], v23 offset:8192
  s_lshl2_add_u32 s62, s62, s51
  s_lshl_b32 s62, s62, 13
  buffer_load_dwordx4 v19, s[16:19], s88 offen offset:0 sc1 lds
  v_lshlrev_b32 v16, 7, v0
  v_add_u32 v16, s62, v16
  s_lshl2_add_u32 s62, s69, s51
  s_mul_i32 s63, s62, 6272
  v_add_u32 v17, 15, v0
  v_lshrrev_b32 v17, 6, v17
  v_lshlrev_b32 v17, 30, v17
  v_lshl_add_u32 v17, v0, 7, v17
  s_mul_i32 s62, s62, 3200
  buffer_load_dwordx4 v19, s[16:19], s88 offen offset:1024 sc1 lds
  s_add_u32 m0, s59, 73728
  s_nop 0
  buffer_load_dwordx4 v19, s[16:19], s89 offen offset:0 sc1 lds
  buffer_load_dwordx4 v19, s[16:19], s89 offen offset:1024 sc1 lds
  s_add_u32 m0, s59, 81920
  s_nop 0
  buffer_load_dwordx4 v19, s[16:19], s90 offen offset:0 sc1 lds
  buffer_load_dwordx4 v19, s[16:19], s90 offen offset:1024 sc1 lds
  s_add_u32 m0, s59, 90112
  s_nop 0
  buffer_load_dwordx4 v19, s[16:19], s91 offen offset:0 sc1 lds
  buffer_load_dwordx4 v19, s[16:19], s91 offen offset:1024 sc1 lds
  s_add_u32 m0, s59, 65536
  s_waitcnt vmcnt(8)
  s_barrier
  ds_read_b64_tr_b16 a[112:113], v26 offset:32768
  ds_read_b64_tr_b16 a[114:115], v26 offset:33024
  ds_read_b64_tr_b16 a[116:117], v26 offset:33792
  ds_read_b64_tr_b16 a[118:119], v26 offset:34048
  ds_read_b64_tr_b16 a[120:121], v26 offset:34816
  ds_read_b64_tr_b16 a[122:123], v26 offset:35072
  ds_read_b64_tr_b16 a[124:125], v26 offset:35840
  ds_read_b64_tr_b16 a[126:127], v26 offset:36096
  ds_read_b64_tr_b16 a[128:129], v26 offset:36864
  ds_read_b64_tr_b16 a[130:131], v26 offset:37120
  ds_read_b64_tr_b16 a[132:133], v26 offset:37888
  ds_read_b64_tr_b16 a[134:135], v26 offset:38144
  ds_read_b64_tr_b16 a[136:137], v26 offset:38912
  ds_read_b64_tr_b16 a[138:139], v26 offset:39168
  ds_read_b64_tr_b16 a[140:141], v26 offset:39936
  ds_read_b64_tr_b16 a[142:143], v26 offset:40192
  s_waitcnt lgkmcnt(14)
  v_mfma_f32_32x32x16_bf16 v[112:127], a[112:115], a[0:3], 0
  ds_read_b64_tr_b16 a[112:113], v26 offset:40960
  ds_read_b64_tr_b16 a[114:115], v26 offset:41216
  ds_read_b64_tr_b16 v[64:65], v27 offset:0
  ds_read_b64_tr_b16 v[66:67], v27 offset:512
  ds_read_b64_tr_b16 v[68:69], v27 offset:1024
  s_waitcnt lgkmcnt(15)
  v_mfma_f32_32x32x16_bf16 v[112:127], a[116:119], a[4:7], v[112:127]
  ds_read_b64_tr_b16 a[116:117], v26 offset:41984
  ds_read_b64_tr_b16 a[118:119], v26 offset:42240
  ds_read_b64_tr_b16 v[70:71], v27 offset:1536
  v_mfma_f32_32x32x16_bf16 v[112:127], a[120:123], a[8:11], v[112:127]
  ds_read_b64_tr_b16 a[120:121], v26 offset:43008
  ds_read_b64_tr_b16 a[122:123], v26 offset:43264
  s_waitcnt lgkmcnt(11)
  v_mfma_f32_32x32x16_bf16 v[112:127], a[124:127], a[12:15], v[112:127]
  ds_read_b64_tr_b16 a[124:125], v26 offset:44032
  ds_read_b64_tr_b16 a[126:127], v26 offset:44288
  v_mfma_f32_32x32x16_bf16 v[112:127], a[128:131], a[16:19], v[112:127]
  ds_read_b64_tr_b16 a[128:129], v26 offset:45056
  ds_read_b64_tr_b16 a[130:131], v26 offset:45312
  v_mfma_f32_32x32x16_bf16 v[112:127], a[132:135], a[20:23], v[112:127]
  ds_read_b64_tr_b16 a[132:133], v26 offset:46080
  ds_read_b64_tr_b16 a[134:135], v26 offset:46336
  v_mfma_f32_32x32x16_bf16 v[112:127], a[136:139], a[24:27], v[112:127]
  ds_read_b64_tr_b16 a[136:137], v26 offset:47104
  ds_read_b64_tr_b16 a[138:139], v26 offset:47360
  s_waitcnt lgkmcnt(8)
  v_mfma_f32_32x32x16_bf16 v[112:127], a[140:143], a[28:31], v[112:127]
  ds_read_b64_tr_b16 a[140:141], v26 offset:48128
  ds_read_b64_tr_b16 a[142:143], v26 offset:48384
  v_mfma_f32_32x32x16_bf16 v[112:127], a[112:115], a[32:35], v[112:127]
  ds_read_b64_tr_b16 a[112:113], v26 offset:49152
  ds_read_b64_tr_b16 a[114:115], v26 offset:49408
  v_mfma_f32_32x32x16_bf16 v[112:127], a[116:119], a[36:39], v[112:127]
  ds_read_b64_tr_b16 a[116:117], v26 offset:50176
  ds_read_b64_tr_b16 a[118:119], v26 offset:50432
  v_mfma_f32_32x32x16_bf16 v[112:127], a[120:123], a[40:43], v[112:127]
  ds_read_b64_tr_b16 a[120:121], v26 offset:51200
  ds_read_b64_tr_b16 a[122:123], v26 offset:51456
  s_waitcnt lgkmcnt(8)
  v_mfma_f32_32x32x16_bf16 v[112:127], a[124:127], a[44:47], v[112:127]
  ds_read_b64_tr_b16 a[124:125], v26 offset:52224
  ds_read_b64_tr_b16 a[126:127], v26 offset:52480
  v_mfma_f32_32x32x16_bf16 v[112:127], a[128:131], a[48:51], v[112:127]
  ds_read_b64_tr_b16 a[128:129], v26 offset:53248
  ds_read_b64_tr_b16 a[130:131], v26 offset:53504
  v_mfma_f32_32x32x16_bf16 v[112:127], a[132:135], a[52:55], v[112:127]
  ds_read_b64_tr_b16 a[132:133], v26 offset:54272
  ds_read_b64_tr_b16 a[134:135], v26 offset:54528
  v_mfma_f32_32x32x16_bf16 v[112:127], a[136:139], a[56:59], v[112:127]
  ds_read_b64_tr_b16 a[136:137], v26 offset:55296
  ds_read_b64_tr_b16 a[138:139], v26 offset:55552
  s_waitcnt lgkmcnt(8)
  v_mfma_f32_32x32x16_bf16 v[112:127], a[140:143], a[60:63], v[112:127]
  ds_read_b64_tr_b16 a[140:141], v26 offset:56320
  ds_read_b64_tr_b16 a[142:143], v26 offset:56576
  v_mfma_f32_32x32x16_bf16 v[112:127], a[112:115], a[64:67], v[112:127]
  ds_read_b64_tr_b16 a[112:113], v26 offset:57344
  ds_read_b64_tr_b16 a[114:115], v26 offset:57600
  v_mfma_f32_32x32x16_bf16 v[112:127], a[116:119], a[68:71], v[112:127]
  ds_read_b64_tr_b16 a[116:117], v26 offset:58368
  ds_read_b64_tr_b16 a[118:119], v26 offset:58624
  v_mfma_f32_32x32x16_bf16 v[112:127], a[120:123], a[72:75], v[112:127]
  ds_read_b64_tr_b16 a[120:121], v26 offset:59392
  ds_read_b64_tr_b16 a[122:123], v26 offset:59648
  s_waitcnt lgkmcnt(8)
  v_mfma_f32_32x32x16_bf16 v[112:127], a[124:127], a[76:79], v[112:127]
  ds_read_b64_tr_b16 a[124:125], v26 offset:60416
  ds_read_b64_tr_b16 a[126:127], v26 offset:60672
  s_waitcnt vmcnt(6)
  s_barrier
  v_mfma_f32_32x32x16_bf16 v[112:127], a[128:131], a[80:83], v[112:127]
  ds_read_b64_tr_b16 a[128:129], v26 offset:0
  ds_read_b64_tr_b16 a[130:131], v26 offset:256
  v_mfma_f32_32x32x16_bf16 v[112:127], a[132:135], a[84:87], v[112:127]
  ds_read_b64_tr_b16 a[132:133], v26 offset:1024
  ds_read_b64_tr_b16 a[134:135], v26 offset:1280
  v_mfma_f32_32x32x16_bf16 v[112:127], a[136:139], a[88:91], v[112:127]
  ds_read_b64_tr_b16 a[136:137], v26 offset:2048
  ds_read_b64_tr_b16 a[138:139], v26 offset:2304
  s_waitcnt lgkmcnt(8)
  v_mfma_f32_32x32x16_bf16 v[112:127], a[140:143], a[92:95], v[112:127]
  ds_read_b64_tr_b16 a[140:141], v26 offset:3072
  ds_read_b64_tr_b16 a[142:143], v26 offset:3328
  v_mfma_f32_32x32x16_bf16 v[112:127], a[112:115], a[96:99], v[112:127]
  ds_read_b64_tr_b16 a[112:113], v26 offset:4096
  ds_read_b64_tr_b16 a[114:115], v26 offset:4352
  v_mfma_f32_32x32x16_bf16 v[112:127], a[116:119], a[100:103], v[112:127]
  ds_read_b64_tr_b16 a[116:117], v26 offset:5120
  ds_read_b64_tr_b16 a[118:119], v26 offset:5376
  v_mfma_f32_32x32x16_bf16 v[112:127], a[120:123], a[104:107], v[112:127]
  ds_read_b64_tr_b16 a[120:121], v26 offset:6144
  ds_read_b64_tr_b16 a[122:123], v26 offset:6400
  s_waitcnt lgkmcnt(8)
  v_mfma_f32_32x32x16_bf16 v[112:127], a[124:127], a[108:111], v[112:127]
  ds_read_b64_tr_b16 a[124:125], v26 offset:7168
  ds_read_b64_tr_b16 a[126:127], v26 offset:7424
  v_mfma_f32_32x32x16_bf16 v[128:143], a[0:3], a[128:131], 0
  v_mfma_f32_32x32x16_bf16 v[208:223], a[132:135], a[0:3], 0
  v_mfma_f32_32x32x16_bf16 v[128:143], a[4:7], a[136:139], v[128:143]
  s_waitcnt vmcnt(4) lgkmcnt(0)
  s_barrier
  buffer_load_dwordx4 v19, s[16:19], s92 offen offset:0 sc1 lds
  v_mfma_f32_32x32x16_bf16 v[208:223], a[140:143], a[4:7], v[208:223]
  ds_read_b64_tr_b16 a[128:129], v26 offset:8192
  ds_read_b64_tr_b16 a[130:131], v26 offset:8448
  buffer_load_dwordx4 v19, s[16:19], s92 offen offset:1024 sc1 lds
  v_mfma_f32_32x32x16_bf16 v[128:143], a[8:11], a[112:115], v[128:143]
  s_add_u32 m0, s59, 73728
  v_mov_b32 v57, v124
  v_mov_b32 v1, v124
  v_cvt_pk_bf16_f32 v144, v112, v113
  v_cvt_pk_bf16_f32 v145, v114, v115
  v_cvt_pk_bf16_f32 v146, v116, v117
  v_cvt_pk_bf16_f32 v147, v118, v119
  v_mfma_f32_32x32x16_bf16 v[208:223], a[116:119], a[8:11], v[208:223]
  v_cvt_pk_bf16_f32 v148, v120, v121
  v_cvt_pk_bf16_f32 v149, v122, v123
  v_cvt_pk_bf16_f32 v150, v124, v125
  v_cvt_pk_bf16_f32 v151, v126, v127
  ds_read_b64_tr_b16 a[132:133], v26 offset:9216
  ds_read_b64_tr_b16 a[134:135], v26 offset:9472
  v_mfma_f32_32x32x16_bf16 v[128:143], a[12:15], a[120:123], v[128:143]
  ds_read_b64_tr_b16 a[136:137], v26 offset:10240
  ds_read_b64_tr_b16 a[138:139], v26 offset:10496
  ds_read_b64_tr_b16 a[140:141], v26 offset:11264
  ds_read_b64_tr_b16 a[142:143], v26 offset:11520
  ds_read_b64_tr_b16 a[112:113], v26 offset:12288
  ds_read_b64_tr_b16 a[114:115], v26 offset:12544
  v_mfma_f32_32x32x16_bf16 v[208:223], a[124:127], a[12:15], v[208:223]
  ds_read_b64_tr_b16 a[116:117], v26 offset:13312
  ds_read_b64_tr_b16 a[118:119], v26 offset:13568
  ds_read_b64_tr_b16 a[120:121], v26 offset:14336
  v_permlane32_swap_b32 v1, v57
  ds_read_b64_tr_b16 a[122:123], v26 offset:14592
  v_mfma_f32_32x32x16_bf16 v[160:175], v[64:67], v[144:147], 0
  ds_read_b64_tr_b16 a[124:125], v26 offset:15360
  ds_read_b64_tr_b16 a[126:127], v26 offset:15616
  v_mfma_f32_32x32x16_bf16 v[160:175], v[68:71], v[148:151], v[160:175]
  s_waitcnt lgkmcnt(14)
  v_mfma_f32_32x32x16_bf16 v[128:143], a[16:19], a[128:131], v[128:143]
  s_waitcnt lgkmcnt(8)
  v_mfma_f32_32x32x16_bf16 v[208:223], a[132:135], a[16:19], v[208:223]
  s_waitcnt vmcnt(4) lgkmcnt(0)
  s_barrier
  buffer_load_dwordx4 v19, s[16:19], s93 offen offset:0 sc1 lds
  v_mfma_f32_32x32x16_bf16 v[128:143], a[20:23], a[136:139], v[128:143]
  ds_read_b64_tr_b16 a[128:129], v26 offset:16384
  ds_read_b64_tr_b16 a[130:131], v26 offset:16640
  buffer_load_dwordx4 v19, s[16:19], s93 offen offset:1024 sc1 lds
  v_mfma_f32_32x32x16_bf16 v[208:223], a[140:143], a[20:23], v[208:223]
  s_add_u32 m0, s59, 81920
  ds_read_b64_tr_b16 a[132:133], v26 offset:17408
  ds_read_b64_tr_b16 a[134:135], v26 offset:17664
  ds_read_b64_tr_b16 a[136:137], v26 offset:18432
  ds_read_b64_tr_b16 a[138:139], v26 offset:18688
  ds_read_b64_tr_b16 a[140:141], v26 offset:19456
  ds_read_b64_tr_b16 a[142:143], v26 offset:19712
  v_mfma_f32_32x32x16_bf16 v[128:143], a[24:27], a[112:115], v[128:143]
  ds_read_b64_tr_b16 a[112:113], v26 offset:20480
  ds_read_b64_tr_b16 a[114:115], v26 offset:20736
  v_max3_f32 v62, v160, v161, v162
  v_max3_f32 v63, -v160, -v161, -v162
  v_max3_f32 v62, v62, v163, v164
  v_mfma_f32_32x32x16_bf16 v[208:223], a[116:119], a[24:27], v[208:223]
  ds_read_b64_tr_b16 a[116:117], v26 offset:21504
  ds_read_b64_tr_b16 a[118:119], v26 offset:21760
  v_max3_f32 v63, v63, -v163, -v164
  v_max3_f32 v62, v62, v165, v166
  v_max3_f32 v63, v63, -v165, -v166
  v_mfma_f32_32x32x16_bf16 v[128:143], a[28:31], a[120:123], v[128:143]
  ds_read_b64_tr_b16 a[120:121], v26 offset:22528
  ds_read_b64_tr_b16 a[122:123], v26 offset:22784
  v_max3_f32 v62, v62, v167, v168
  v_max3_f32 v63, v63, -v167, -v168
  v_max3_f32 v62, v62, v169, v170
  v_mfma_f32_32x32x16_bf16 v[208:223], a[124:127], a[28:31], v[208:223]
  ds_read_b64_tr_b16 a[124:125], v26 offset:23552
  ds_read_b64_tr_b16 a[126:127], v26 offset:23808
  v_max3_f32 v63, v63, -v169, -v170
  v_max3_f32 v62, v62, v171, v172
  v_max3_f32 v63, v63, -v171, -v172
  s_waitcnt lgkmcnt(7)
  v_mfma_f32_32x32x16_bf16 v[128:143], a[32:35], a[128:131], v[128:143]
  v_max_f32 v62, v62, v173
  v_max_f32_e64 v63, v63, -v173
  v_mov_b32 v175, 0
  s_nop 0
  v_permlane32_swap_b32 v62, v63
  v_mfma_f32_32x32x16_bf16 v[208:223], a[132:135], a[32:35], v[208:223]
  v_max_f32 v62, v62, v63
  v_mul_f32 v62, 0xbfb8aa3b, v62
  v_mov_b32 v63, v62
  s_nop 1
  v_permlane32_swap_b32 v62, v63
  v_mfma_f32_32x32x16_bf16 v[128:143], a[36:39], a[136:139], v[128:143]
  v_fma_f32 v176, v160, s70, v62
  s_waitcnt vmcnt(4) lgkmcnt(0)
  s_barrier
  buffer_load_dwordx4 v19, s[16:19], s94 offen offset:0 sc1 lds
  v_mfma_f32_32x32x16_bf16 v[208:223], a[140:143], a[36:39], v[208:223]
  ds_read_b64_tr_b16 a[128:129], v26 offset:24576
  ds_read_b64_tr_b16 a[130:131], v26 offset:24832
  buffer_load_dwordx4 v19, s[16:19], s94 offen offset:1024 sc1 lds
  v_mfma_f32_32x32x16_bf16 v[128:143], a[40:43], a[112:115], v[128:143]
  ds_read_b64_tr_b16 a[132:133], v26 offset:25600
  ds_read_b64_tr_b16 a[134:135], v26 offset:25856
  buffer_load_dword a210, v17, s[28:31], s63 offen
  v_mfma_f32_32x32x16_bf16 v[208:223], a[116:119], a[40:43], v[208:223]
  v_add_u32 v17, 39, v0
  v_lshrrev_b32 v17, 6, v17
  v_lshlrev_b32 v17, 30, v17
  v_lshl_add_u32 v17, v0, 7, v17
  v_add_u32 v17, s62, v17
  buffer_load_dword a211, v17, s[24:27], 0 offen
  v_mfma_f32_32x32x16_bf16 v[128:143], a[44:47], a[120:123], v[128:143]
  ds_read_b64_tr_b16 a[136:137], v26 offset:26624
  ds_read_b64_tr_b16 a[138:139], v26 offset:26880
  ds_read_b64_tr_b16 a[140:141], v26 offset:27648
  ds_read_b64_tr_b16 a[142:143], v26 offset:27904
  ds_read_b64_tr_b16 a[112:113], v26 offset:28672
  ds_read_b64_tr_b16 a[114:115], v26 offset:28928
  v_mfma_f32_32x32x16_bf16 v[208:223], a[124:127], a[44:47], v[208:223]
  ds_read_b64_tr_b16 a[116:117], v26 offset:29696
  ds_read_b64_tr_b16 a[118:119], v26 offset:29952
  ds_read_b64_tr_b16 a[120:121], v26 offset:30720
  v_fma_f32 v190, -v160, s70, v63
  ds_read_b64_tr_b16 a[122:123], v26 offset:30976
  s_waitcnt lgkmcnt(10)
  v_mfma_f32_32x32x16_bf16 v[128:143], a[48:51], a[128:131], v[128:143]
  ds_read_b64_tr_b16 a[124:125], v26 offset:31744
  ds_read_b64_tr_b16 a[126:127], v26 offset:32000
  s_waitcnt vmcnt(6)
  s_barrier
  ds_read_b64_tr_b16 a[128:129], v26 offset:0
  ds_read_b64_tr_b16 a[130:131], v26 offset:256
  v_mfma_f32_32x32x16_bf16 v[208:223], a[132:135], a[48:51], v[208:223]
  ds_read_b64_tr_b16 a[132:133], v26 offset:1024
  ds_read_b64_tr_b16 a[134:135], v26 offset:1280
  v_fma_f32 v177, v161, s70, v62
  v_fma_f32 v191, -v161, s70, v63
  v_fma_f32 v178, v162, s70, v62
  s_waitcnt lgkmcnt(14)
  v_mfma_f32_32x32x16_bf16 v[128:143], a[52:55], a[136:139], v[128:143]
  ds_read_b64_tr_b16 a[136:137], v26 offset:2048
  ds_read_b64_tr_b16 a[138:139], v26 offset:2304
  v_fma_f32 v192, -v162, s70, v63
  v_fma_f32 v179, v163, s70, v62
  v_fma_f32 v193, -v163, s70, v63
  s_waitcnt lgkmcnt(11)
  v_mfma_f32_32x32x16_bf16 v[208:223], a[140:143], a[52:55], v[208:223]
  ds_read_b64_tr_b16 a[140:141], v26 offset:3072
  ds_read_b64_tr_b16 a[142:143], v26 offset:3328
  v_fma_f32 v180, v164, s70, v62
  v_fma_f32 v194, -v164, s70, v63
  v_fma_f32 v181, v165, s70, v62
  v_mfma_f32_32x32x16_bf16 v[128:143], a[56:59], a[112:115], v[128:143]
  ds_read_b64_tr_b16 a[112:113], v26 offset:4096
  ds_read_b64_tr_b16 a[114:115], v26 offset:4352
  v_fma_f32 v195, -v165, s70, v63
  v_fma_f32 v182, v166, s70, v62
  v_fma_f32 v196, -v166, s70, v63
  s_waitcnt lgkmcnt(7)
  v_mfma_f32_32x32x16_bf16 v[208:223], a[116:119], a[56:59], v[208:223]
  ds_read_b64_tr_b16 a[116:117], v26 offset:5120
  ds_read_b64_tr_b16 a[118:119], v26 offset:5376
  v_fma_f32 v183, v167, s70, v62
  v_fma_f32 v197, -v167, s70, v63
  v_fma_f32 v184, v168, s70, v62
  v_mfma_f32_32x32x16_bf16 v[128:143], a[60:63], a[120:123], v[128:143]
  ds_read_b64_tr_b16 a[120:121], v26 offset:6144
  ds_read_b64_tr_b16 a[122:123], v26 offset:6400
  v_fma_f32 v198, -v168, s70, v63
  v_fma_f32 v185, v169, s70, v62
  v_fma_f32 v199, -v169, s70, v63
  v_mfma_f32_32x32x16_bf16 v[208:223], a[124:127], a[60:63], v[208:223]
  ds_read_b64_tr_b16 a[124:125], v26 offset:7168
  ds_read_b64_tr_b16 a[126:127], v26 offset:7424
  s_waitcnt vmcnt(4)
  s_barrier
  v_fma_f32 v186, v170, s70, v62
  v_mfma_f32_32x32x16_bf16 v[128:143], a[64:67], a[128:131], v[128:143]
  ds_read_b64_tr_b16 a[128:129], v26 offset:8192
  ds_read_b64_tr_b16 a[130:131], v26 offset:8448
  v_fma_f32 v200, -v170, s70, v63
  v_fma_f32 v187, v171, s70, v62
  v_fma_f32 v201, -v171, s70, v63
  s_waitcnt lgkmcnt(7)
  v_mfma_f32_32x32x16_bf16 v[208:223], a[132:135], a[64:67], v[208:223]
  ds_read_b64_tr_b16 a[132:133], v26 offset:9216
  ds_read_b64_tr_b16 a[134:135], v26 offset:9472
  v_fma_f32 v188, v172, s70, v62
  v_fma_f32 v202, -v172, s70, v63
  v_fma_f32 v189, v173, s70, v62
  v_mfma_f32_32x32x16_bf16 v[128:143], a[68:71], a[136:139], v[128:143]
  ds_read_b64_tr_b16 a[136:137], v26 offset:10240
  ds_read_b64_tr_b16 a[138:139], v26 offset:10496
  v_fma_f32 v203, -v173, s70, v63
  v_exp_f32 v176, v176
  v_mfma_f32_32x32x16_bf16 v[208:223], a[140:143], a[68:71], v[208:223]
  ds_read_b64_tr_b16 a[140:141], v26 offset:11264
  ds_read_b64_tr_b16 a[142:143], v26 offset:11520
  v_exp_f32 v190, v190
  v_mov_b32 v167, 0
  v_mfma_f32_32x32x16_bf16 v[128:143], a[72:75], a[112:115], v[128:143]
  ds_read_b64_tr_b16 a[112:113], v26 offset:12288
  ds_read_b64_tr_b16 a[114:115], v26 offset:12544
  v_exp_f32 v177, v177
  s_nop 0
  v_add_f32 v62, v176, v177
  s_waitcnt lgkmcnt(6)
  v_mfma_f32_32x32x16_bf16 v[208:223], a[116:119], a[72:75], v[208:223]
  ds_read_b64_tr_b16 a[116:117], v26 offset:13312
  ds_read_b64_tr_b16 a[118:119], v26 offset:13568
  v_exp_f32 v191, v191
  s_nop 0
  v_add_f32 v63, v190, v191
  v_mfma_f32_32x32x16_bf16 v[128:143], a[76:79], a[120:123], v[128:143]
  ds_read_b64_tr_b16 a[120:121], v26 offset:14336
  ds_read_b64_tr_b16 a[122:123], v26 offset:14592
  v_exp_f32 v178, v178
  s_nop 0
  v_add_f32 v62, v62, v178
  v_mfma_f32_32x32x16_bf16 v[208:223], a[124:127], a[76:79], v[208:223]
  ds_read_b64_tr_b16 a[124:125], v26 offset:15360
  ds_read_b64_tr_b16 a[126:127], v26 offset:15616
  s_waitcnt vmcnt(2)
  s_barrier
  v_mfma_f32_32x32x16_bf16 v[128:143], a[80:83], a[128:131], v[128:143]
  ds_read_b64_tr_b16 a[128:129], v26 offset:16384
  ds_read_b64_tr_b16 a[130:131], v26 offset:16640
  v_exp_f32 v192, v192
  s_nop 0
  v_add_f32 v63, v63, v192
  v_mfma_f32_32x32x16_bf16 v[208:223], a[132:135], a[80:83], v[208:223]
  ds_read_b64_tr_b16 a[132:133], v26 offset:17408
  ds_read_b64_tr_b16 a[134:135], v26 offset:17664
  v_exp_f32 v179, v179
  s_nop 0
  v_add_f32 v62, v62, v179
  s_waitcnt lgkmcnt(6)
  v_mfma_f32_32x32x16_bf16 v[128:143], a[84:87], a[136:139], v[128:143]
  ds_read_b64_tr_b16 a[136:137], v26 offset:18432
  ds_read_b64_tr_b16 a[138:139], v26 offset:18688
  v_exp_f32 v193, v193
  s_nop 0
  v_add_f32 v63, v63, v193
  v_mfma_f32_32x32x16_bf16 v[208:223], a[140:143], a[84:87], v[208:223]
  ds_read_b64_tr_b16 a[140:141], v26 offset:19456
  ds_read_b64_tr_b16 a[142:143], v26 offset:19712
  v_exp_f32 v180, v180
  s_nop 0
  v_add_f32 v62, v62, v180
  v_mfma_f32_32x32x16_bf16 v[128:143], a[88:91], a[112:115], v[128:143]
  ds_read_b64_tr_b16 a[112:113], v26 offset:20480
  ds_read_b64_tr_b16 a[114:115], v26 offset:20736
  v_exp_f32 v194, v194
  s_nop 0
  v_add_f32 v63, v63, v194
  v_mfma_f32_32x32x16_bf16 v[208:223], a[116:119], a[88:91], v[208:223]
  ds_read_b64_tr_b16 a[116:117], v26 offset:21504
  ds_read_b64_tr_b16 a[118:119], v26 offset:21760
  v_exp_f32 v181, v181
  s_nop 0
  v_add_f32 v62, v62, v181
  v_mfma_f32_32x32x16_bf16 v[128:143], a[92:95], a[120:123], v[128:143]
  ds_read_b64_tr_b16 a[120:121], v26 offset:22528
  ds_read_b64_tr_b16 a[122:123], v26 offset:22784
  v_exp_f32 v195, v195
  s_nop 0
  v_add_f32 v63, v63, v195
  s_waitcnt lgkmcnt(6)
  v_mfma_f32_32x32x16_bf16 v[208:223], a[124:127], a[92:95], v[208:223]
  ds_read_b64_tr_b16 a[124:125], v26 offset:23552
  ds_read_b64_tr_b16 a[126:127], v26 offset:23808
  v_exp_f32 v182, v182
  s_nop 0
  v_add_f32 v62, v62, v182
  v_mfma_f32_32x32x16_bf16 v[128:143], a[96:99], a[128:131], v[128:143]
  v_exp_f32 v196, v196
  v_exp_f32 v183, v183
  v_add_f32 v63, v63, v196
  v_mfma_f32_32x32x16_bf16 v[208:223], a[132:135], a[96:99], v[208:223]
  v_exp_f32 v197, v197
  v_exp_f32 v184, v184
  v_add_f32 v62, v62, v183
  v_mfma_f32_32x32x16_bf16 v[128:143], a[100:103], a[136:139], v[128:143]
  v_exp_f32 v198, v198
  v_exp_f32 v185, v185
  v_add_f32 v63, v63, v197
  v_mfma_f32_32x32x16_bf16 v[208:223], a[140:143], a[100:103], v[208:223]
  v_exp_f32 v199, v199
  v_exp_f32 v186, v186
  v_add_f32 v62, v62, v184
  s_waitcnt lgkmcnt(0)
  v_mfma_f32_32x32x16_bf16 v[128:143], a[104:107], a[112:115], v[128:143]
  v_exp_f32 v200, v200
  v_exp_f32 v187, v187
  v_add_f32 v63, v63, v198
  v_mfma_f32_32x32x16_bf16 v[208:223], a[116:119], a[104:107], v[208:223]
  v_exp_f32 v201, v201
  v_exp_f32 v188, v188
  v_add_f32 v62, v62, v185
  v_mfma_f32_32x32x16_bf16 v[128:143], a[108:111], a[120:123], v[128:143]
  v_exp_f32 v202, v202
  v_exp_f32 v189, v189
  v_add_f32 v63, v63, v199
  v_mfma_f32_32x32x16_bf16 v[208:223], a[124:127], a[108:111], v[208:223]
  v_exp_f32 v203, v203
  v_add_f32 v62, v62, v186
  v_add_f32 v63, v63, v200
  v_add_f32 v62, v62, v187
  s_nop 3
  v_cvt_pk_bf16_f32 v152, v128, v129
  v_cvt_pk_bf16_f32 v153, v130, v131
  v_cvt_pk_bf16_f32 v154, v132, v133
  v_cvt_pk_bf16_f32 v155, v134, v135
  v_cndmask_b32 v152, v152, v43, s[72:73]
  v_cndmask_b32 v153, v153, v43, s[72:73]
  v_cndmask_b32 v154, v154, v43, s[72:73]
  v_cndmask_b32 v155, v155, v43, s[72:73]
  ds_write_b128 v42, v[152:155] offset:0
  v_cvt_pk_bf16_f32 v156, v136, v137
  v_cvt_pk_bf16_f32 v157, v138, v139
  v_cvt_pk_bf16_f32 v158, v140, v141
  v_cvt_pk_bf16_f32 v159, v142, v143
  v_cndmask_b32 v156, v156, v43, s[72:73]
  v_cndmask_b32 v157, v157, v43, s[72:73]
  v_cndmask_b32 v158, v158, v43, s[72:73]
  v_cndmask_b32 v159, v159, v43, s[72:73]
  ds_write_b128 v42, v[156:159] offset:1024
  v_cvt_pk_bf16_f32 v144, v208, v209
  v_cvt_pk_bf16_f32 v145, v210, v211
  v_cvt_pk_bf16_f32 v146, v212, v213
  v_cvt_pk_bf16_f32 v147, v214, v215
  v_cvt_pk_bf16_f32 v148, v216, v217
  v_cvt_pk_bf16_f32 v149, v218, v219
  v_cvt_pk_bf16_f32 v150, v220, v221
  v_cvt_pk_bf16_f32 v151, v222, v223
  v_mfma_f32_32x32x16_bf16 v[208:223], v[64:67], v[144:147], 0
  v_add_f32 v63, v63, v201
  v_add_f32 v62, v62, v188
  v_add_f32 v63, v63, v202
  v_add_f32 v62, v62, v189
  v_add_f32 v63, v63, v203
  v_mfma_f32_32x32x16_bf16 v[208:223], v[68:71], v[148:151], v[208:223]
  s_nop 0
  v_permlane32_swap_b32 v62, v63
  v_add_f32 v62, v62, v63
  v_rcp_f32 v62, v62
  s_nop 0
  v_mov_b32 v63, v62
  s_nop 1
  v_permlane32_swap_b32 v62, v63
  v_mul_f32 v176, v176, v62
  v_mul_f32 v177, v177, v62
  v_mul_f32 v178, v178, v62
  v_mul_f32 v179, v179, v62
  v_mul_f32 v180, v180, v62
  v_mul_f32 v181, v181, v62
  v_mul_f32 v182, v182, v62
  v_mul_f32 v183, v183, v62
  v_mul_f32 v184, v184, v62
  v_mul_f32 v185, v185, v62
  v_mul_f32 v186, v186, v62
  v_mul_f32 v187, v187, v62
  v_mul_f32 v188, v188, v62
  v_mul_f32 v189, v189, v62
  v_mul_f32 v190, v190, v63
  v_mul_f32 v191, v191, v63
  v_mul_f32 v192, v192, v63
  v_mul_f32 v193, v193, v63
  v_mul_f32 v194, v194, v63
  v_mul_f32 v195, v195, v63
  v_mul_f32 v196, v196, v63
  v_mul_f32 v197, v197, v63
  v_mul_f32 v198, v198, v63
  v_mul_f32 v199, v199, v63
  v_mul_f32 v200, v200, v63
  v_mul_f32 v201, v201, v63
  v_mul_f32 v202, v202, v63
  v_mul_f32 v203, v203, v63
  v_cvt_pk_bf16_f32 v160, v176, v177
  v_cvt_pk_bf16_f32 v161, v178, v179
  v_cvt_pk_bf16_f32 v162, v180, v181
  v_cvt_pk_bf16_f32 v163, v182, v183
  ds_write_b128 v31, v[160:163] offset:0
  v_cvt_pk_bf16_f32 v164, v184, v185
  v_cvt_pk_bf16_f32 v165, v186, v187
  v_cvt_pk_bf16_f32 v166, v188, v189
  ds_write_b128 v32, v[164:167] offset:0
  v_cvt_pk_bf16_f32 v168, v190, v191
  v_cvt_pk_bf16_f32 v169, v192, v193
  v_cvt_pk_bf16_f32 v170, v194, v195
  v_cvt_pk_bf16_f32 v171, v196, v197
  v_cvt_pk_bf16_f32 v172, v198, v199
  v_cvt_pk_bf16_f32 v173, v200, v201
  v_cvt_pk_bf16_f32 v174, v202, v203
  ds_write_b128 v31, v[168:171] offset:2048
  ds_write_b128 v32, v[172:175] offset:2048
  s_waitcnt lgkmcnt(0)
  s_barrier
  ds_read_b64_tr_b16 a[128:129], v33 offset:0
  ds_read_b64_tr_b16 a[130:131], v34 offset:0
  ds_read_b128 a[132:135], v41 offset:0
  ds_read_b64_tr_b16 a[136:137], v33 offset:256
  ds_read_b64_tr_b16 a[138:139], v34 offset:256
  ds_read_b128 a[140:143], v41 offset:1024
  ds_read_b64_tr_b16 a[112:113], v33 offset:4096
  ds_read_b64_tr_b16 a[114:115], v34 offset:4096
  ds_read_b128 a[116:119], v41 offset:2048
  ds_read_b64_tr_b16 a[120:121], v33 offset:4352
  ds_read_b64_tr_b16 a[122:123], v34 offset:4352
  ds_read_b128 a[124:127], v41 offset:3072
  s_waitcnt lgkmcnt(9)
  v_mfma_f32_32x32x16_bf16 v[176:191], a[128:131], a[132:135], 0
  ds_read_b64_tr_b16 a[128:129], v33 offset:8192
  ds_read_b64_tr_b16 a[130:131], v34 offset:8192
  ds_read_b128 a[132:135], v41 offset:4096
  s_waitcnt lgkmcnt(9)
  v_mfma_f32_32x32x16_bf16 v[176:191], a[136:139], a[140:143], v[176:191]
  ds_read_b64_tr_b16 a[136:137], v33 offset:8448
  ds_read_b64_tr_b16 a[138:139], v34 offset:8448
  ds_read_b128 a[140:143], v41 offset:5120
  s_waitcnt lgkmcnt(9)
  v_mfma_f32_32x32x16_bf16 v[176:191], a[112:115], a[116:119], v[176:191]
  ds_read_b64_tr_b16 a[112:113], v33 offset:12288
  ds_read_b64_tr_b16 a[114:115], v34 offset:12288
  ds_read_b128 a[116:119], v41 offset:6144
  s_waitcnt lgkmcnt(9)
  v_mfma_f32_32x32x16_bf16 v[176:191], a[120:123], a[124:127], v[176:191]
  ds_read_b64_tr_b16 a[120:121], v33 offset:12544
  ds_read_b64_tr_b16 a[122:123], v34 offset:12544
  ds_read_b128 a[124:127], v41 offset:7168
  s_waitcnt lgkmcnt(9)
  v_mfma_f32_32x32x16_bf16 v[176:191], a[128:131], a[132:135], v[176:191]
  s_waitcnt lgkmcnt(6)
  v_mfma_f32_32x32x16_bf16 v[176:191], a[136:139], a[140:143], v[176:191]
  s_waitcnt lgkmcnt(3)
  v_mfma_f32_32x32x16_bf16 v[176:191], a[112:115], a[116:119], v[176:191]
  s_waitcnt lgkmcnt(0)
  v_mfma_f32_32x32x16_bf16 v[176:191], a[120:123], a[124:127], v[176:191]
  s_nop 11
  v_cndmask_b32 v176, v176, v184, s[44:45]
  v_bfi_b32 v176, v44, s54, v176
  v_cndmask_b32 v177, v177, v185, s[44:45]
  v_bfi_b32 v177, v44, s55, v177
  v_cndmask_b32 v178, v178, v186, s[44:45]
  v_bfi_b32 v178, v44, s56, v178
  v_cndmask_b32 v179, v179, v187, s[44:45]
  v_bfi_b32 v179, v44, s57, v179
  buffer_store_dwordx4 v[176:179], v28, s[16:19], s95 offen sc1
  v_cndmask_b32 v180, v180, v188, s[44:45]
  v_bfi_b32 v180, v44, s54, v180
  v_cndmask_b32 v181, v181, v189, s[44:45]
  v_bfi_b32 v181, v44, s55, v181
  v_cndmask_b32 v182, v182, v190, s[44:45]
  v_bfi_b32 v182, v44, s56, v182
  v_cndmask_b32 v183, v183, v191, s[44:45]
  v_bfi_b32 v183, v44, s57, v183
  buffer_store_dwordx4 v[180:183], v49, s[16:19], s95 offen sc1
  s_mov_b32 s65, 0
  buffer_load_dword a152, v16, s[24:27], s65 offen
  v_mul_f32 v57, s70, v57
  v_exp_f32_e64 v57, -v57
  v_max3_f32 v62, v208, v209, v210
  v_add_f32 v57, 1.0, v57
  v_rcp_f32 v57, v57
  v_max3_f32 v63, -v208, -v209, -v210
  v_max3_f32 v62, v62, v211, v212
  v_max3_f32 v63, v63, -v211, -v212
  v_max3_f32 v62, v62, v213, v214
  v_max3_f32 v63, v63, -v213, -v214
  v_max3_f32 v62, v62, v215, v216
  v_max3_f32 v63, v63, -v215, -v216
  v_max3_f32 v62, v62, v217, v218
  v_max3_f32 v63, v63, -v217, -v218
  v_max3_f32 v62, v62, v219, v220
  v_max3_f32 v63, v63, -v219, -v220
  v_max_f32 v62, v62, v221
  v_max_f32_e64 v63, v63, -v221
  v_mov_b32 v223, 0
  s_lshl_b32 s62, s53, 13
  v_permlane32_swap_b32 v62, v63
  v_max_f32 v62, v62, v63
  v_mul_f32 v62, 0xbfb8aa3b, v62
  v_mov_b32 v63, v62
  s_add_u32 s62, s62, s59
  s_add_u32 s36, s62, 3145728
  v_permlane32_swap_b32 v62, v63
  v_pk_fma_f32 v[176:177], v[208:209], s[70:71], v[62:63] op_sel_hi:[1,0,0]
  v_pk_fma_f32 v[190:191], v[208:209], s[70:71], v[62:63] op_sel:[0,0,1] op_sel_hi:[1,0,1] neg_lo:[1,0,0] neg_hi:[1,0,0]
  v_pk_fma_f32 v[178:179], v[210:211], s[70:71], v[62:63] op_sel_hi:[1,0,0]
  v_pk_fma_f32 v[192:193], v[210:211], s[70:71], v[62:63] op_sel:[0,0,1] op_sel_hi:[1,0,1] neg_lo:[1,0,0] neg_hi:[1,0,0]
  v_pk_fma_f32 v[180:181], v[212:213], s[70:71], v[62:63] op_sel_hi:[1,0,0]
  v_pk_fma_f32 v[194:195], v[212:213], s[70:71], v[62:63] op_sel:[0,0,1] op_sel_hi:[1,0,1] neg_lo:[1,0,0] neg_hi:[1,0,0]
  v_pk_fma_f32 v[182:183], v[214:215], s[70:71], v[62:63] op_sel_hi:[1,0,0]
  v_pk_fma_f32 v[196:197], v[214:215], s[70:71], v[62:63] op_sel:[0,0,1] op_sel_hi:[1,0,1] neg_lo:[1,0,0] neg_hi:[1,0,0]
  v_pk_fma_f32 v[184:185], v[216:217], s[70:71], v[62:63] op_sel_hi:[1,0,0]
  v_pk_fma_f32 v[198:199], v[216:217], s[70:71], v[62:63] op_sel:[0,0,1] op_sel_hi:[1,0,1] neg_lo:[1,0,0] neg_hi:[1,0,0]
  v_pk_fma_f32 v[186:187], v[218:219], s[70:71], v[62:63] op_sel_hi:[1,0,0]
  v_pk_fma_f32 v[200:201], v[218:219], s[70:71], v[62:63] op_sel:[0,0,1] op_sel_hi:[1,0,1] neg_lo:[1,0,0] neg_hi:[1,0,0]
  v_pk_fma_f32 v[188:189], v[220:221], s[70:71], v[62:63] op_sel_hi:[1,0,0]
  v_pk_fma_f32 v[202:203], v[220:221], s[70:71], v[62:63] op_sel:[0,0,1] op_sel_hi:[1,0,1] neg_lo:[1,0,0] neg_hi:[1,0,0]
  v_exp_f32 v176, v176
  v_exp_f32 v190, v190
  v_exp_f32 v177, v177
  v_exp_f32 v191, v191
  v_exp_f32 v178, v178
  v_exp_f32 v192, v192
  v_exp_f32 v179, v179
  v_exp_f32 v193, v193
  v_exp_f32 v180, v180
  v_exp_f32 v194, v194
  v_exp_f32 v181, v181
  v_exp_f32 v195, v195
  v_exp_f32 v182, v182
  v_exp_f32 v196, v196
  v_exp_f32 v183, v183
  v_exp_f32 v197, v197
  v_exp_f32 v184, v184
  v_exp_f32 v198, v198
  v_exp_f32 v185, v185
  v_exp_f32 v199, v199
  v_exp_f32 v186, v186
  v_exp_f32 v200, v200
  v_exp_f32 v187, v187
  v_exp_f32 v201, v201
  v_exp_f32 v188, v188
  v_exp_f32 v202, v202
  v_exp_f32 v189, v189
  v_exp_f32 v203, v203
  v_pk_add_f32 v[208:209], v[176:177], v[178:179]
  v_pk_add_f32 v[210:211], v[190:191], v[192:193]
  v_pk_add_f32 v[208:209], v[208:209], v[180:181]
  v_pk_add_f32 v[210:211], v[210:211], v[194:195]
  v_pk_add_f32 v[208:209], v[208:209], v[182:183]
  v_pk_add_f32 v[210:211], v[210:211], v[196:197]
  v_pk_add_f32 v[208:209], v[208:209], v[184:185]
  v_pk_add_f32 v[210:211], v[210:211], v[198:199]
  v_pk_add_f32 v[208:209], v[208:209], v[186:187]
  v_pk_add_f32 v[210:211], v[210:211], v[200:201]
  v_pk_add_f32 v[208:209], v[208:209], v[188:189]
  v_pk_add_f32 v[210:211], v[210:211], v[202:203]
  v_add_f32 v62, v208, v209
  v_add_f32 v63, v210, v211
  v_cvt_pk_bf16_f32 v208, v176, v177
  v_cvt_pk_bf16_f32 v209, v178, v179
  v_permlane32_swap_b32 v62, v63
  v_add_f32 v62, v62, v63
  v_mov_b32 v63, v62
  v_cvt_pk_bf16_f32 v210, v180, v181
  v_cvt_pk_bf16_f32 v211, v182, v183
  v_permlane32_swap_b32 v62, v63
  v_rcp_f32 v63, v63
  v_mov_b32 v59, v62
  v_mul_f32 v63, v63, v62
  v_pk_mul_f32 v[190:191], v[190:191], v[62:63] op_sel:[0,1] op_sel_hi:[1,1]
  v_pk_mul_f32 v[192:193], v[192:193], v[62:63] op_sel:[0,1] op_sel_hi:[1,1]
  v_pk_mul_f32 v[194:195], v[194:195], v[62:63] op_sel:[0,1] op_sel_hi:[1,1]
  v_pk_mul_f32 v[196:197], v[196:197], v[62:63] op_sel:[0,1] op_sel_hi:[1,1]
  v_pk_mul_f32 v[198:199], v[198:199], v[62:63] op_sel:[0,1] op_sel_hi:[1,1]
  v_pk_mul_f32 v[200:201], v[200:201], v[62:63] op_sel:[0,1] op_sel_hi:[1,1]
  v_pk_mul_f32 v[202:203], v[202:203], v[62:63] op_sel:[0,1] op_sel_hi:[1,1]
  v_cvt_pk_bf16_f32 v212, v184, v185
  v_cvt_pk_bf16_f32 v213, v186, v187
  v_cvt_pk_bf16_f32 v214, v188, v189
  v_mov_b32 v215, 0
  v_cvt_pk_bf16_f32 v216, v190, v191
  v_cvt_pk_bf16_f32 v217, v192, v193
  v_cvt_pk_bf16_f32 v218, v194, v195
  v_cvt_pk_bf16_f32 v219, v196, v197
  v_cvt_pk_bf16_f32 v220, v198, v199
  v_cvt_pk_bf16_f32 v221, v200, v201
  v_cvt_pk_bf16_f32 v222, v202, v203
  s_lshl2_add_u32 s62, s48, s51
  s_lshl4_add_u32 s62, s62, s53
  s_lshl_b32 s62, s62, 11
  s_add_u32 s37, s62, 8388608
  s_lshl4_add_u32 s62, s48, s53
  s_lshl_b32 s62, s62, 7
  s_add_u32 s38, s62, 131072
  v_add_u32 v45, 155648, v28
  v_add_u32 v46, s59, v45
  v_cmp_eq_u32 s[72:73], 0, v5
  s_lshl2_add_u32 s62, s69, s51
  s_lshl_b32 s63, s62, 14
  s_add_u32 s82, s63, 1048576
  s_add_u32 s83, s63, 1052672
  s_add_u32 s84, s63, 1056768
  s_add_u32 s85, s63, 1060864
  s_lshl_b32 s62, s62, 10
  s_add_u32 s86, s62, 3145728
  v_and_b32 v8, 15, v0
  v_lshlrev_b32 v8, 10, v8
  buffer_load_dwordx4 v[80:83], v8, s[16:19], s82 offen offset:1008 sc1
  s_waitcnt vmcnt(0)
  v_xor_b32 v1, s54, v80
  v_bitop3_b32 v1, v81, s55, v1 bitop3:0xbe
  v_bitop3_b32 v1, v82, s56, v1 bitop3:0xbe
  v_bitop3_b32 v1, v83, s57, v1 bitop3:0xbe
  v_and_b32 v1, 0xff, v1
  v_cmp_ne_u32 vcc, 0, v1
  s_nop 0
  s_cbranch_vccnz Lslow_stats_9
Lback_stats_9:
  buffer_load_dwordx4 v[80:83], v28, s[16:19], s82 offen offset:0 sc1
  buffer_load_dwordx4 v[84:87], v28, s[16:19], s82 offen offset:1024 sc1
  buffer_load_dwordx4 v[88:91], v28, s[16:19], s82 offen offset:2048 sc1
  buffer_load_dwordx4 v[92:95], v28, s[16:19], s82 offen offset:3072 sc1
  buffer_load_dwordx4 v[96:99], v28, s[16:19], s83 offen offset:0 sc1
  buffer_load_dwordx4 v[100:103], v28, s[16:19], s83 offen offset:1024 sc1
  buffer_load_dwordx4 v[104:107], v28, s[16:19], s83 offen offset:2048 sc1
  buffer_load_dwordx4 v[108:111], v28, s[16:19], s83 offen offset:3072 sc1
  buffer_load_dwordx4 v[112:115], v28, s[16:19], s84 offen offset:0 sc1
  buffer_load_dwordx4 v[116:119], v28, s[16:19], s84 offen offset:1024 sc1
  buffer_load_dwordx4 v[120:123], v28, s[16:19], s84 offen offset:2048 sc1
  s_waitcnt vmcnt(10)
  v_xor_b32 v1, s54, v80
  v_bitop3_b32 v1, v81, s55, v1 bitop3:0xbe
  v_bitop3_b32 v1, v82, s56, v1 bitop3:0xbe
  v_bitop3_b32 v1, v83, s57, v1 bitop3:0xbe
  v_and_b32 v80, 0xffffff00, v80
  v_and_b32 v81, 0xffffff00, v81
  v_and_b32 v82, 0xffffff00, v82
  v_and_b32 v83, 0xffffff00, v83
  buffer_load_dwordx4 v[124:127], v28, s[16:19], s84 offen offset:3072 sc1
  s_waitcnt vmcnt(10)
  v_bitop3_b32 v1, v84, s54, v1 bitop3:0xbe
  v_bitop3_b32 v1, v85, s55, v1 bitop3:0xbe
  v_bitop3_b32 v1, v86, s56, v1 bitop3:0xbe
  v_bitop3_b32 v1, v87, s57, v1 bitop3:0xbe
  v_and_b32 v84, 0xffffff00, v84
  v_and_b32 v85, 0xffffff00, v85
  v_and_b32 v86, 0xffffff00, v86
  v_and_b32 v87, 0xffffff00, v87
  buffer_load_dwordx4 v[128:131], v28, s[16:19], s85 offen offset:0 sc1
  s_waitcnt vmcnt(10)
  v_bitop3_b32 v1, v88, s54, v1 bitop3:0xbe
  v_bitop3_b32 v1, v89, s55, v1 bitop3:0xbe
  v_bitop3_b32 v1, v90, s56, v1 bitop3:0xbe
  v_bitop3_b32 v1, v91, s57, v1 bitop3:0xbe
  v_and_b32 v88, 0xffffff00, v88
  v_and_b32 v89, 0xffffff00, v89
  v_and_b32 v90, 0xffffff00, v90
  v_and_b32 v91, 0xffffff00, v91
  buffer_load_dwordx4 v[132:135], v28, s[16:19], s85 offen offset:1024 sc1
  s_waitcnt vmcnt(10)
  v_bitop3_b32 v1, v92, s54, v1 bitop3:0xbe
  v_bitop3_b32 v1, v93, s55, v1 bitop3:0xbe
  v_bitop3_b32 v1, v94, s56, v1 bitop3:0xbe
  v_bitop3_b32 v1, v95, s57, v1 bitop3:0xbe
  v_and_b32 v92, 0xffffff00, v92
  v_and_b32 v93, 0xffffff00, v93
  v_and_b32 v94, 0xffffff00, v94
  v_and_b32 v95, 0xffffff00, v95
  buffer_load_dwordx4 v[136:139], v28, s[16:19], s85 offen offset:2048 sc1
  s_waitcnt vmcnt(10)
  v_bitop3_b32 v1, v96, s54, v1 bitop3:0xbe
  v_bitop3_b32 v1, v97, s55, v1 bitop3:0xbe
  v_bitop3_b32 v1, v98, s56, v1 bitop3:0xbe
  v_bitop3_b32 v1, v99, s57, v1 bitop3:0xbe
  v_and_b32 v96, 0xffffff00, v96
  v_and_b32 v97, 0xffffff00, v97
  v_and_b32 v98, 0xffffff00, v98
  v_and_b32 v99, 0xffffff00, v99
  buffer_load_dwordx4 v[140:143], v28, s[16:19], s85 offen offset:3072 sc1
  s_waitcnt vmcnt(10)
  v_bitop3_b32 v1, v100, s54, v1 bitop3:0xbe
  v_bitop3_b32 v1, v101, s55, v1 bitop3:0xbe
  v_bitop3_b32 v1, v102, s56, v1 bitop3:0xbe
  v_bitop3_b32 v1, v103, s57, v1 bitop3:0xbe
  v_and_b32 v100, 0xffffff00, v100
  v_and_b32 v101, 0xffffff00, v101
  v_and_b32 v102, 0xffffff00, v102
  v_and_b32 v103, 0xffffff00, v103
  s_waitcnt vmcnt(9)
  v_bitop3_b32 v1, v104, s54, v1 bitop3:0xbe
  v_bitop3_b32 v1, v105, s55, v1 bitop3:0xbe
  v_bitop3_b32 v1, v106, s56, v1 bitop3:0xbe
  v_bitop3_b32 v1, v107, s57, v1 bitop3:0xbe
  v_and_b32 v104, 0xffffff00, v104
  v_and_b32 v105, 0xffffff00, v105
  v_and_b32 v106, 0xffffff00, v106
  v_and_b32 v107, 0xffffff00, v107
  s_waitcnt vmcnt(8)
  v_bitop3_b32 v1, v108, s54, v1 bitop3:0xbe
  v_bitop3_b32 v1, v109, s55, v1 bitop3:0xbe
  v_bitop3_b32 v1, v110, s56, v1 bitop3:0xbe
  v_bitop3_b32 v1, v111, s57, v1 bitop3:0xbe
  v_and_b32 v108, 0xffffff00, v108
  v_and_b32 v109, 0xffffff00, v109
  v_and_b32 v110, 0xffffff00, v110
  v_and_b32 v111, 0xffffff00, v111
  s_waitcnt vmcnt(7)
  v_bitop3_b32 v1, v112, s54, v1 bitop3:0xbe
  v_bitop3_b32 v1, v113, s55, v1 bitop3:0xbe
  v_bitop3_b32 v1, v114, s56, v1 bitop3:0xbe
  v_bitop3_b32 v1, v115, s57, v1 bitop3:0xbe
  v_and_b32 v112, 0xffffff00, v112
  v_and_b32 v113, 0xffffff00, v113
  v_and_b32 v114, 0xffffff00, v114
  v_and_b32 v115, 0xffffff00, v115
  s_waitcnt vmcnt(6)
  v_bitop3_b32 v1, v116, s54, v1 bitop3:0xbe
  v_bitop3_b32 v1, v117, s55, v1 bitop3:0xbe
  v_bitop3_b32 v1, v118, s56, v1 bitop3:0xbe
  v_bitop3_b32 v1, v119, s57, v1 bitop3:0xbe
  v_and_b32 v116, 0xffffff00, v116
  v_and_b32 v117, 0xffffff00, v117
  v_and_b32 v118, 0xffffff00, v118
  v_and_b32 v119, 0xffffff00, v119
  s_waitcnt vmcnt(5)
  v_bitop3_b32 v1, v120, s54, v1 bitop3:0xbe
  v_bitop3_b32 v1, v121, s55, v1 bitop3:0xbe
  v_bitop3_b32 v1, v122, s56, v1 bitop3:0xbe
  v_bitop3_b32 v1, v123, s57, v1 bitop3:0xbe
  v_and_b32 v120, 0xffffff00, v120
  v_and_b32 v121, 0xffffff00, v121
  v_and_b32 v122, 0xffffff00, v122
  v_and_b32 v123, 0xffffff00, v123
  s_waitcnt vmcnt(4)
  v_bitop3_b32 v1, v124, s54, v1 bitop3:0xbe
  v_bitop3_b32 v1, v125, s55, v1 bitop3:0xbe
  v_bitop3_b32 v1, v126, s56, v1 bitop3:0xbe
  v_bitop3_b32 v1, v127, s57, v1 bitop3:0xbe
  v_and_b32 v124, 0xffffff00, v124
  v_and_b32 v125, 0xffffff00, v125
  v_and_b32 v126, 0xffffff00, v126
  v_and_b32 v127, 0xffffff00, v127
  s_waitcnt vmcnt(3)
  v_bitop3_b32 v1, v128, s54, v1 bitop3:0xbe
  v_bitop3_b32 v1, v129, s55, v1 bitop3:0xbe
  v_bitop3_b32 v1, v130, s56, v1 bitop3:0xbe
  v_bitop3_b32 v1, v131, s57, v1 bitop3:0xbe
  v_and_b32 v128, 0xffffff00, v128
  v_and_b32 v129, 0xffffff00, v129
  v_and_b32 v130, 0xffffff00, v130
  v_and_b32 v131, 0xffffff00, v131
  s_waitcnt vmcnt(2)
  v_bitop3_b32 v1, v132, s54, v1 bitop3:0xbe
  v_bitop3_b32 v1, v133, s55, v1 bitop3:0xbe
  v_bitop3_b32 v1, v134, s56, v1 bitop3:0xbe
  v_bitop3_b32 v1, v135, s57, v1 bitop3:0xbe
  v_and_b32 v132, 0xffffff00, v132
  v_and_b32 v133, 0xffffff00, v133
  v_and_b32 v134, 0xffffff00, v134
  v_and_b32 v135, 0xffffff00, v135
  s_waitcnt vmcnt(1)
  v_bitop3_b32 v1, v136, s54, v1 bitop3:0xbe
  v_bitop3_b32 v1, v137, s55, v1 bitop3:0xbe
  v_bitop3_b32 v1, v138, s56, v1 bitop3:0xbe
  v_bitop3_b32 v1, v139, s57, v1 bitop3:0xbe
  v_and_b32 v136, 0xffffff00, v136
  v_and_b32 v137, 0xffffff00, v137
  v_and_b32 v138, 0xffffff00, v138
  v_and_b32 v139, 0xffffff00, v139
  s_waitcnt vmcnt(0)
  v_bitop3_b32 v1, v140, s54, v1 bitop3:0xbe
  v_bitop3_b32 v1, v141, s55, v1 bitop3:0xbe
  v_bitop3_b32 v1, v142, s56, v1 bitop3:0xbe
  v_bitop3_b32 v1, v143, s57, v1 bitop3:0xbe
  v_and_b32 v140, 0xffffff00, v140
  v_and_b32 v141, 0xffffff00, v141
  v_and_b32 v142, 0xffffff00, v142
  v_and_b32 v143, 0xffffff00, v143
  v_and_b32 v1, 0xff, v1
  v_cmp_ne_u32 vcc, 0, v1
  s_nop 0
  s_cbranch_vccnz Lslow_kvp_10
Lback_kvp_10:
  v_pk_add_f32 v[80:81], v[80:81], v[84:85]
  v_pk_add_f32 v[82:83], v[82:83], v[86:87]
  v_pk_add_f32 v[80:81], v[80:81], v[88:89]
  v_pk_add_f32 v[82:83], v[82:83], v[90:91]
  v_pk_add_f32 v[80:81], v[80:81], v[92:93]
  v_pk_add_f32 v[82:83], v[82:83], v[94:95]
  v_pk_add_f32 v[80:81], v[80:81], v[96:97]
  v_pk_add_f32 v[82:83], v[82:83], v[98:99]
  v_pk_add_f32 v[80:81], v[80:81], v[100:101]
  v_pk_add_f32 v[82:83], v[82:83], v[102:103]
  v_pk_add_f32 v[80:81], v[80:81], v[104:105]
  v_pk_add_f32 v[82:83], v[82:83], v[106:107]
  v_pk_add_f32 v[80:81], v[80:81], v[108:109]
  v_pk_add_f32 v[82:83], v[82:83], v[110:111]
  v_pk_add_f32 v[80:81], v[80:81], v[112:113]
  v_pk_add_f32 v[82:83], v[82:83], v[114:115]
  v_pk_add_f32 v[80:81], v[80:81], v[116:117]
  v_pk_add_f32 v[82:83], v[82:83], v[118:119]
  v_pk_add_f32 v[80:81], v[80:81], v[120:121]
  v_pk_add_f32 v[82:83], v[82:83], v[122:123]
  v_pk_add_f32 v[80:81], v[80:81], v[124:125]
  v_pk_add_f32 v[82:83], v[82:83], v[126:127]
  v_pk_add_f32 v[80:81], v[80:81], v[128:129]
  v_pk_add_f32 v[82:83], v[82:83], v[130:131]
  v_pk_add_f32 v[80:81], v[80:81], v[132:133]
  v_pk_add_f32 v[82:83], v[82:83], v[134:135]
  v_pk_add_f32 v[80:81], v[80:81], v[136:137]
  v_pk_add_f32 v[82:83], v[82:83], v[138:139]
  v_pk_add_f32 v[80:81], v[80:81], v[140:141]
  v_pk_add_f32 v[82:83], v[82:83], v[142:143]
  v_cvt_pk_bf16_f32 v84, v80, v81
  v_cvt_pk_bf16_f32 v85, v82, v83
  v_mov_b32 v86, s54
  v_mov_b32 v87, s54
  buffer_store_dwordx4 v[84:87], v28, s[16:19], s86 offen sc1
  s_mov_b32 s65, 131072
  buffer_load_dword a153, v16, s[24:27], s65 offen
  s_add_u32 m0, s59, 155648
  s_nop 0
  buffer_load_dwordx4 v28, s[16:19], s36 offen offset:0 sc1 lds
  buffer_load_dwordx4 v28, s[16:19], s36 offen offset:1024 sc1 lds
  s_waitcnt vmcnt(0)
  ds_read_b32 v52, v46 offset:8
  ds_read_b32 v56, v46 offset:1032
  s_waitcnt lgkmcnt(1)
  v_xor_b32 v52, s54, v52
  s_waitcnt lgkmcnt(0)
  v_bitop3_b32 v52, v56, s54, v52 bitop3:0xbe
  v_cmp_ne_u32 vcc, 0, v52
  s_nop 0
  s_cbranch_vccnz Lslow_kvf_11
Lback_kvf_11:
  s_barrier
  ds_read_b64 a[128:129], v45 offset:0
  ds_read_b64 a[130:131], v45 offset:1024
  ds_read_b64 a[132:133], v45 offset:2048
  ds_read_b64 a[134:135], v45 offset:3072
  ds_read_b64 a[136:137], v45 offset:4096
  ds_read_b64 a[138:139], v45 offset:5120
  ds_read_b64 a[140:141], v45 offset:6144
  s_mov_b32 s65, 262144
  ds_read_b64 a[142:143], v45 offset:7168
  s_lshl4_add_u32 s62, s48, s52
  s_lshl_b32 s62, s62, 7
  s_add_u32 s38, s62, 65536
  s_or_b32 s64, s69, s51
  v_or_b32 v47, s64, v0
  v_min_u32 v47, 1, v47
  v_lshlrev_b32 v47, 30, v47
  s_waitcnt lgkmcnt(6)
  v_mfma_f32_32x32x16_bf16 v[144:159], a[128:131], v[208:211], 0
  s_waitcnt lgkmcnt(4)
  v_mfma_f32_32x32x16_bf16 v[144:159], a[132:135], v[212:215], v[144:159]
  s_waitcnt lgkmcnt(0)
  v_mfma_f32_32x32x16_bf16 v[144:159], a[136:139], v[216:219], v[144:159]
  v_mfma_f32_32x32x16_bf16 v[144:159], a[140:143], v[220:223], v[144:159]
  s_nop 11
  v_mov_b32 v54, v156
  v_mov_b32 v55, v156
  s_nop 1
  v_permlane32_swap_b32 v55, v54
  v_fmac_f32 v54, 0x358637bd, v59
  v_rcp_f32 v54, v54
  s_nop 0
  v_mul_f32 v54, v54, v57
  v_cndmask_b32 v55, 0, v54, s[72:73]
  v_mul_f32 v144, v144, v54
  v_mul_f32 v145, v145, v54
  v_mul_f32 v146, v146, v54
  v_mul_f32 v147, v147, v54
  v_mul_f32 v148, v148, v54
  v_mul_f32 v149, v149, v54
  v_mul_f32 v150, v150, v54
  v_mul_f32 v151, v151, v54
  v_mul_f32 v152, v152, v54
  v_mul_f32 v153, v153, v54
  v_mul_f32 v154, v154, v54
  v_mul_f32 v155, v155, v54
  v_mul_f32 v156, v156, v55
  v_mul_f32 v157, v157, v55
  v_mul_f32 v158, v158, v55
  v_mul_f32 v159, v159, v55
  v_cvt_pk_bf16_f32 v160, v144, v145
  v_cvt_pk_bf16_f32 v161, v146, v147
  v_cvt_pk_bf16_f32 v162, v148, v149
  v_cvt_pk_bf16_f32 v163, v150, v151
  v_cvt_pk_bf16_f32 v164, v152, v153
  v_cvt_pk_bf16_f32 v165, v154, v155
  v_cvt_pk_bf16_f32 v166, v156, v157
  v_cvt_pk_bf16_f32 v167, v158, v159
  buffer_store_dwordx4 v[160:163], v28, s[16:19], s37 offen offset:0 sc1
  buffer_store_dwordx4 v[164:167], v28, s[16:19], s37 offen offset:1024 sc1
  buffer_load_dword a154, v16, s[24:27], s65 offen
  s_mov_b32 s65, 393216
  s_waitcnt vmcnt(1)
  s_barrier
  s_cmp_lg_u32 s51, 0
  s_cbranch_scc1 Lsf4
  s_atomic_swap s54, s[16:17], s38
Lsf4:
  buffer_store_dword v53, v47, s[16:19], 0 offen sc1
  buffer_load_dword a155, v16, s[24:27], s65 offen
  s_mov_b32 s65, 0
  buffer_load_dword a144, v16, s[28:31], s65 offen
  s_mov_b32 s65, 131072
  buffer_load_dword a145, v16, s[28:31], s65 offen
  s_mov_b32 s65, 262144
  buffer_load_dword a146, v16, s[28:31], s65 offen
  s_mov_b32 s65, 393216
  buffer_load_dword a147, v16, s[28:31], s65 offen
  s_mov_b32 s65, 524288
  buffer_load_dword a148, v16, s[28:31], s65 offen
  s_mov_b32 s65, 655360
  buffer_load_dword a149, v16, s[28:31], s65 offen
  s_mov_b32 s65, 786432
  buffer_load_dword a150, v16, s[28:31], s65 offen
  s_endpgm
Lslow_fw_2:
  s_mov_b32 s68, 0
  v_min_u32 v56, 6, v0
  v_lshlrev_b32 v56, 7, v56
Lslow_fw_2_l:
  buffer_load_dword v54, v56, s[16:19], s3 offen sc1
  s_waitcnt vmcnt(0)
  v_cmp_ne_u32 vcc, s54, v54
  s_nop 1
  s_cbranch_vccz Lslow_fw_2_d
  s_add_u32 s68, s68, 1
  s_cmp_lt_u32 s68, 20000
  s_cbranch_scc1 Lslow_fw_2_l
Lslow_fw_2_d:
  s_branch Lback_fw_2
Lslow_stats_3:
  s_mov_b32 s68, 0
Lslow_stats_3_l:
  s_nop 7
  s_nop 7
  buffer_load_dwordx4 v[176:179], v28, s[16:19], s98 offen offset:0 sc1
  buffer_load_dwordx4 v[180:183], v28, s[16:19], s98 offen offset:1024 sc1
  buffer_load_dwordx4 v[184:187], v28, s[16:19], s98 offen offset:2048 sc1
  buffer_load_dwordx4 v[188:191], v28, s[16:19], s98 offen offset:3072 sc1
  buffer_load_dwordx4 v[192:195], v28, s[16:19], s99 offen offset:0 sc1
  buffer_load_dwordx4 v[196:199], v28, s[16:19], s99 offen offset:1024 sc1
  buffer_load_dwordx4 v[200:203], v28, s[16:19], s99 offen offset:2048 sc1
  s_waitcnt vmcnt(0)
  v_xor_b32 v52, s54, v178
  s_nop 1
  v_bitop3_b32 v52, v182, s54, v52 bitop3:0xbe
  s_nop 1
  v_bitop3_b32 v52, v186, s54, v52 bitop3:0xbe
  s_nop 1
  v_bitop3_b32 v52, v190, s54, v52 bitop3:0xbe
  s_nop 1
  v_bitop3_b32 v52, v194, s54, v52 bitop3:0xbe
  s_nop 1
  v_bitop3_b32 v52, v198, s54, v52 bitop3:0xbe
  s_nop 1
  v_bitop3_b32 v52, v202, s54, v52 bitop3:0xbe
  s_nop 1
  v_cmp_ne_u32 vcc, 0, v52
  s_nop 1
  s_cbranch_vccz Lslow_stats_3_d
  s_add_u32 s68, s68, 1
  s_cmp_lt_u32 s68, 20000
  s_cbranch_scc1 Lslow_stats_3_l
Lslow_stats_3_d:
  s_nop 4
  s_branch Lback_stats_3
Lslow_fz_4:
  s_mov_b32 s68, 0
  v_min_u32 v56, 3, v0
  v_lshlrev_b32 v56, 7, v56
Lslow_fz_4_l:
  buffer_load_dword v52, v56, s[16:19], s3 offen sc1
  s_waitcnt vmcnt(0)
  v_cmp_ne_u32 vcc, s54, v52
  s_nop 1
  s_cbranch_vccz Lslow_fz_4_d
  s_add_u32 s68, s68, 1
  s_cmp_lt_u32 s68, 20000
  s_cbranch_scc1 Lslow_fz_4_l
Lslow_fz_4_d:
  s_branch Lback_fz_4
Lslow_kvf_5:
  s_mov_b32 s68, 0
Lslow_kvf_5_l:
  s_nop 7
  s_nop 7
  s_mov_b32 s71, m0
  s_add_u32 m0, s59, 155648
  s_nop 0
  buffer_load_dwordx4 v28, s[16:19], s36 offen offset:0 sc1 lds
  buffer_load_dwordx4 v28, s[16:19], s36 offen offset:1024 sc1 lds
  s_mov_b32 m0, s71
  s_waitcnt vmcnt(0)
  ds_read_b32 v52, v46 offset:8
  ds_read_b32 v56, v46 offset:1032
  s_waitcnt lgkmcnt(0)
  s_waitcnt vmcnt(0)
  v_xor_b32 v52, s54, v52
  s_nop 1
  v_bitop3_b32 v52, v56, s54, v52 bitop3:0xbe
  s_nop 1
  v_cmp_ne_u32 vcc, 0, v52
  s_nop 1
  s_cbranch_vccz Lslow_kvf_5_d
  s_add_u32 s68, s68, 1
  s_cmp_lt_u32 s68, 20000
  s_cbranch_scc1 Lslow_kvf_5_l
Lslow_kvf_5_d:
  s_nop 4
  s_branch Lback_kvf_5
Lslow_gp_6:
  s_mov_b32 s68, 0
Lslow_gp_6_l:
  s_nop 7
  s_nop 7
  buffer_load_dwordx4 v[176:179], v28, s[16:19], s40 offen offset:0 sc1
  buffer_load_dwordx4 v[180:183], v28, s[16:19], s40 offen offset:1024 sc1
  buffer_load_dwordx4 v[184:187], v28, s[16:19], s40 offen offset:2048 sc1
  buffer_load_dwordx4 v[188:191], v28, s[16:19], s40 offen offset:3072 sc1
  buffer_load_dwordx4 v[192:195], v28, s[16:19], s41 offen offset:0 sc1
  buffer_load_dwordx2 v[196:197], v50, s[16:19], s41 offen offset:1024 sc1
  s_waitcnt vmcnt(0)
  v_xor_b32 v52, s54, v197
  s_nop 1
  v_bitop3_b32 v52, v179, s54, v52 bitop3:0xbe
  s_nop 1
  v_bitop3_b32 v52, v183, s54, v52 bitop3:0xbe
  s_nop 1
  v_bitop3_b32 v52, v187, s54, v52 bitop3:0xbe
  s_nop 1
  v_bitop3_b32 v52, v191, s54, v52 bitop3:0xbe
  s_nop 1
  v_bitop3_b32 v52, v195, s54, v52 bitop3:0xbe
  s_nop 1
  v_lshlrev_b32 v144, 16, v176
  s_nop 1
  v_and_b32 v145, 0xffff0000, v176
  s_nop 1
  v_lshlrev_b32 v146, 16, v177
  s_nop 1
  v_and_b32 v147, 0xffff0000, v177
  s_nop 1
  v_lshlrev_b32 v148, 16, v178
  s_nop 1
  v_and_b32 v149, 0xffff0000, v178
  s_nop 1
  v_lshlrev_b32 v150, 16, v180
  s_nop 1
  v_and_b32 v151, 0xffff0000, v180
  s_nop 1
  v_lshlrev_b32 v152, 16, v181
  s_nop 1
  v_and_b32 v153, 0xffff0000, v181
  s_nop 1
  v_lshlrev_b32 v154, 16, v182
  s_nop 1
  v_and_b32 v155, 0xffff0000, v182
  s_nop 1
  v_lshlrev_b32 v156, 16, v184
  s_nop 1
  v_and_b32 v157, 0xffff0000, v184
  s_nop 1
  v_lshlrev_b32 v158, 16, v185
  s_nop 1
  v_and_b32 v159, 0xffff0000, v185
  s_nop 1
  v_lshlrev_b32 v160, 16, v186
  s_nop 1
  v_and_b32 v161, 0xffff0000, v186
  s_nop 1
  v_lshlrev_b32 v162, 16, v188
  s_nop 1
  v_and_b32 v163, 0xffff0000, v188
  s_nop 1
  v_lshlrev_b32 v164, 16, v189
  s_nop 1
  v_and_b32 v165, 0xffff0000, v189
  s_nop 1
  v_lshlrev_b32 v166, 16, v190
  s_nop 1
  v_and_b32 v167, 0xffff0000, v190
  s_nop 1
  v_lshlrev_b32 v168, 16, v192
  s_nop 1
  v_and_b32 v169, 0xffff0000, v192
  s_nop 1
  v_lshlrev_b32 v170, 16, v193
  s_nop 1
  v_and_b32 v171, 0xffff0000, v193
  s_nop 1
  v_lshlrev_b32 v172, 16, v194
  s_nop 1
  v_and_b32 v173, 0xffff0000, v194
  s_nop 1
  v_lshlrev_b32 v174, 16, v196
  s_nop 1
  v_and_b32 v175, 0xffff0000, v196
  s_nop 1
  v_cmp_ne_u32 vcc, 0, v52
  s_nop 1
  s_cbranch_vccz Lslow_gp_6_d
  s_add_u32 s68, s68, 1
  s_cmp_lt_u32 s68, 20000
  s_cbranch_scc1 Lslow_gp_6_l
Lslow_gp_6_d:
  s_nop 4
  s_branch Lback_gp_6
Lslow_fh_7:
  s_mov_b32 s68, 0
Lslow_fh_7_l:
  s_load_dword s74, s[100:101], 0 glc
  s_load_dword s75, s[100:101], 128 glc
  s_load_dword s76, s[100:101], 256 glc
  s_load_dword s77, s[100:101], 384 glc
  s_waitcnt lgkmcnt(0)
  s_xor_b32 s74, s74, s54
  s_xor_b32 s75, s75, s54
  s_xor_b32 s76, s76, s54
  s_xor_b32 s77, s77, s54
  s_or_b32 s74, s74, s75
  s_or_b32 s74, s74, s76
  s_or_b32 s74, s74, s77
  s_cbranch_scc0 Lslow_fh_7_d
  s_add_u32 s68, s68, 1
  s_cmp_lt_u32 s68, 20000
  s_cbranch_scc1 Lslow_fh_7_l
Lslow_fh_7_d:
  s_branch Lback_fh_7
Lslow_fw_8:
  s_mov_b32 s68, 0
Lslow_fw_8_l:
  s_nop 7
  s_nop 7
  buffer_load_dword v13, v12, s[16:19], 0 offen sc1
  s_waitcnt vmcnt(0)
  v_cmp_ne_u32 vcc, s54, v13
  s_nop 1
  s_cbranch_vccz Lslow_fw_8_d
  s_add_u32 s68, s68, 1
  s_cmp_lt_u32 s68, 20000
  s_cbranch_scc1 Lslow_fw_8_l
Lslow_fw_8_d:
  s_nop 4
  s_branch Lback_fw_8
Lslow_stats_9:
  s_mov_b32 s68, 0
Lslow_stats_9_l:
  s_nop 7
  s_nop 7
  buffer_load_dwordx4 v[80:83], v8, s[16:19], s82 offen offset:1008 sc1
  s_waitcnt vmcnt(0)
  v_xor_b32 v1, s54, v80
  s_nop 1
  v_bitop3_b32 v1, v81, s55, v1 bitop3:0xbe
  s_nop 1
  v_bitop3_b32 v1, v82, s56, v1 bitop3:0xbe
  s_nop 1
  v_bitop3_b32 v1, v83, s57, v1 bitop3:0xbe
  s_nop 1
  v_and_b32 v1, 0xff, v1
  s_nop 1
  v_cmp_ne_u32 vcc, 0, v1
  s_nop 1
  s_cbranch_vccz Lslow_stats_9_d
  s_add_u32 s68, s68, 1
  s_cmp_lt_u32 s68, 20000
  s_cbranch_scc1 Lslow_stats_9_l
Lslow_stats_9_d:
  s_nop 4
  s_branch Lback_stats_9
Lslow_kvp_10:
  s_mov_b32 s68, 0
Lslow_kvp_10_l:
  s_nop 7
  s_nop 7
  buffer_load_dwordx4 v[80:83], v28, s[16:19], s82 offen offset:0 sc1
  buffer_load_dwordx4 v[84:87], v28, s[16:19], s82 offen offset:1024 sc1
  buffer_load_dwordx4 v[88:91], v28, s[16:19], s82 offen offset:2048 sc1
  buffer_load_dwordx4 v[92:95], v28, s[16:19], s82 offen offset:3072 sc1
  buffer_load_dwordx4 v[96:99], v28, s[16:19], s83 offen offset:0 sc1
  buffer_load_dwordx4 v[100:103], v28, s[16:19], s83 offen offset:1024 sc1
  buffer_load_dwordx4 v[104:107], v28, s[16:19], s83 offen offset:2048 sc1
  buffer_load_dwordx4 v[108:111], v28, s[16:19], s83 offen offset:3072 sc1
  buffer_load_dwordx4 v[112:115], v28, s[16:19], s84 offen offset:0 sc1
  buffer_load_dwordx4 v[116:119], v28, s[16:19], s84 offen offset:1024 sc1
  buffer_load_dwordx4 v[120:123], v28, s[16:19], s84 offen offset:2048 sc1
  buffer_load_dwordx4 v[124:127], v28, s[16:19], s84 offen offset:3072 sc1
  buffer_load_dwordx4 v[128:131], v28, s[16:19], s85 offen offset:0 sc1
  buffer_load_dwordx4 v[132:135], v28, s[16:19], s85 offen offset:1024 sc1
  buffer_load_dwordx4 v[136:139], v28, s[16:19], s85 offen offset:2048 sc1
  buffer_load_dwordx4 v[140:143], v28, s[16:19], s85 offen offset:3072 sc1
  s_waitcnt vmcnt(0)
  v_xor_b32 v1, s54, v80
  s_nop 1
  v_bitop3_b32 v1, v81, s55, v1 bitop3:0xbe
  s_nop 1
  v_bitop3_b32 v1, v82, s56, v1 bitop3:0xbe
  s_nop 1
  v_bitop3_b32 v1, v83, s57, v1 bitop3:0xbe
  s_nop 1
  v_bitop3_b32 v1, v84, s54, v1 bitop3:0xbe
  s_nop 1
  v_bitop3_b32 v1, v85, s55, v1 bitop3:0xbe
  s_nop 1
  v_bitop3_b32 v1, v86, s56, v1 bitop3:0xbe
  s_nop 1
  v_bitop3_b32 v1, v87, s57, v1 bitop3:0xbe
  s_nop 1
  v_bitop3_b32 v1, v88, s54, v1 bitop3:0xbe
  s_nop 1
  v_bitop3_b32 v1, v89, s55, v1 bitop3:0xbe
  s_nop 1
  v_bitop3_b32 v1, v90, s56, v1 bitop3:0xbe
  s_nop 1
  v_bitop3_b32 v1, v91, s57, v1 bitop3:0xbe
  s_nop 1
  v_bitop3_b32 v1, v92, s54, v1 bitop3:0xbe
  s_nop 1
  v_bitop3_b32 v1, v93, s55, v1 bitop3:0xbe
  s_nop 1
  v_bitop3_b32 v1, v94, s56, v1 bitop3:0xbe
  s_nop 1
  v_bitop3_b32 v1, v95, s57, v1 bitop3:0xbe
  s_nop 1
  v_bitop3_b32 v1, v96, s54, v1 bitop3:0xbe
  s_nop 1
  v_bitop3_b32 v1, v97, s55, v1 bitop3:0xbe
  s_nop 1
  v_bitop3_b32 v1, v98, s56, v1 bitop3:0xbe
  s_nop 1
  v_bitop3_b32 v1, v99, s57, v1 bitop3:0xbe
  s_nop 1
  v_bitop3_b32 v1, v100, s54, v1 bitop3:0xbe
  s_nop 1
  v_bitop3_b32 v1, v101, s55, v1 bitop3:0xbe
  s_nop 1
  v_bitop3_b32 v1, v102, s56, v1 bitop3:0xbe
  s_nop 1
  v_bitop3_b32 v1, v103, s57, v1 bitop3:0xbe
  s_nop 1
  v_bitop3_b32 v1, v104, s54, v1 bitop3:0xbe
  s_nop 1
  v_bitop3_b32 v1, v105, s55, v1 bitop3:0xbe
  s_nop 1
  v_bitop3_b32 v1, v106, s56, v1 bitop3:0xbe
  s_nop 1
  v_bitop3_b32 v1, v107, s57, v1 bitop3:0xbe
  s_nop 1
  v_bitop3_b32 v1, v108, s54, v1 bitop3:0xbe
  s_nop 1
  v_bitop3_b32 v1, v109, s55, v1 bitop3:0xbe
  s_nop 1
  v_bitop3_b32 v1, v110, s56, v1 bitop3:0xbe
  s_nop 1
  v_bitop3_b32 v1, v111, s57, v1 bitop3:0xbe
  s_nop 1
  v_bitop3_b32 v1, v112, s54, v1 bitop3:0xbe
  s_nop 1
  v_bitop3_b32 v1, v113, s55, v1 bitop3:0xbe
  s_nop 1
  v_bitop3_b32 v1, v114, s56, v1 bitop3:0xbe
  s_nop 1
  v_bitop3_b32 v1, v115, s57, v1 bitop3:0xbe
  s_nop 1
  v_bitop3_b32 v1, v116, s54, v1 bitop3:0xbe
  s_nop 1
  v_bitop3_b32 v1, v117, s55, v1 bitop3:0xbe
  s_nop 1
  v_bitop3_b32 v1, v118, s56, v1 bitop3:0xbe
  s_nop 1
  v_bitop3_b32 v1, v119, s57, v1 bitop3:0xbe
  s_nop 1
  v_bitop3_b32 v1, v120, s54, v1 bitop3:0xbe
  s_nop 1
  v_bitop3_b32 v1, v121, s55, v1 bitop3:0xbe
  s_nop 1
  v_bitop3_b32 v1, v122, s56, v1 bitop3:0xbe
  s_nop 1
  v_bitop3_b32 v1, v123, s57, v1 bitop3:0xbe
  s_nop 1
  v_bitop3_b32 v1, v124, s54, v1 bitop3:0xbe
  s_nop 1
  v_bitop3_b32 v1, v125, s55, v1 bitop3:0xbe
  s_nop 1
  v_bitop3_b32 v1, v126, s56, v1 bitop3:0xbe
  s_nop 1
  v_bitop3_b32 v1, v127, s57, v1 bitop3:0xbe
  s_nop 1
  v_bitop3_b32 v1, v128, s54, v1 bitop3:0xbe
  s_nop 1
  v_bitop3_b32 v1, v129, s55, v1 bitop3:0xbe
  s_nop 1
  v_bitop3_b32 v1, v130, s56, v1 bitop3:0xbe
  s_nop 1
  v_bitop3_b32 v1, v131, s57, v1 bitop3:0xbe
  s_nop 1
  v_bitop3_b32 v1, v132, s54, v1 bitop3:0xbe
  s_nop 1
  v_bitop3_b32 v1, v133, s55, v1 bitop3:0xbe
  s_nop 1
  v_bitop3_b32 v1, v134, s56, v1 bitop3:0xbe
  s_nop 1
  v_bitop3_b32 v1, v135, s57, v1 bitop3:0xbe
  s_nop 1
  v_bitop3_b32 v1, v136, s54, v1 bitop3:0xbe
  s_nop 1
  v_bitop3_b32 v1, v137, s55, v1 bitop3:0xbe
  s_nop 1
  v_bitop3_b32 v1, v138, s56, v1 bitop3:0xbe
  s_nop 1
  v_bitop3_b32 v1, v139, s57, v1 bitop3:0xbe
  s_nop 1
  v_bitop3_b32 v1, v140, s54, v1 bitop3:0xbe
  s_nop 1
  v_bitop3_b32 v1, v141, s55, v1 bitop3:0xbe
  s_nop 1
  v_bitop3_b32 v1, v142, s56, v1 bitop3:0xbe
  s_nop 1
  v_bitop3_b32 v1, v143, s57, v1 bitop3:0xbe
  s_nop 1
  v_and_b32 v80, 0xffffff00, v80
  s_nop 1
  v_and_b32 v81, 0xffffff00, v81
  s_nop 1
  v_and_b32 v82, 0xffffff00, v82
  s_nop 1
  v_and_b32 v83, 0xffffff00, v83
  s_nop 1
  v_and_b32 v84, 0xffffff00, v84
  s_nop 1
  v_and_b32 v85, 0xffffff00, v85
  s_nop 1
  v_and_b32 v86, 0xffffff00, v86
  s_nop 1
  v_and_b32 v87, 0xffffff00, v87
  s_nop 1
  v_and_b32 v88, 0xffffff00, v88
  s_nop 1
  v_and_b32 v89, 0xffffff00, v89
  s_nop 1
  v_and_b32 v90, 0xffffff00, v90
  s_nop 1
  v_and_b32 v91, 0xffffff00, v91
  s_nop 1
  v_and_b32 v92, 0xffffff00, v92
  s_nop 1
  v_and_b32 v93, 0xffffff00, v93
  s_nop 1
  v_and_b32 v94, 0xffffff00, v94
  s_nop 1
  v_and_b32 v95, 0xffffff00, v95
  s_nop 1
  v_and_b32 v96, 0xffffff00, v96
  s_nop 1
  v_and_b32 v97, 0xffffff00, v97
  s_nop 1
  v_and_b32 v98, 0xffffff00, v98
  s_nop 1
  v_and_b32 v99, 0xffffff00, v99
  s_nop 1
  v_and_b32 v100, 0xffffff00, v100
  s_nop 1
  v_and_b32 v101, 0xffffff00, v101
  s_nop 1
  v_and_b32 v102, 0xffffff00, v102
  s_nop 1
  v_and_b32 v103, 0xffffff00, v103
  s_nop 1
  v_and_b32 v104, 0xffffff00, v104
  s_nop 1
  v_and_b32 v105, 0xffffff00, v105
  s_nop 1
  v_and_b32 v106, 0xffffff00, v106
  s_nop 1
  v_and_b32 v107, 0xffffff00, v107
  s_nop 1
  v_and_b32 v108, 0xffffff00, v108
  s_nop 1
  v_and_b32 v109, 0xffffff00, v109
  s_nop 1
  v_and_b32 v110, 0xffffff00, v110
  s_nop 1
  v_and_b32 v111, 0xffffff00, v111
  s_nop 1
  v_and_b32 v112, 0xffffff00, v112
  s_nop 1
  v_and_b32 v113, 0xffffff00, v113
  s_nop 1
  v_and_b32 v114, 0xffffff00, v114
  s_nop 1
  v_and_b32 v115, 0xffffff00, v115
  s_nop 1
  v_and_b32 v116, 0xffffff00, v116
  s_nop 1
  v_and_b32 v117, 0xffffff00, v117
  s_nop 1
  v_and_b32 v118, 0xffffff00, v118
  s_nop 1
  v_and_b32 v119, 0xffffff00, v119
  s_nop 1
  v_and_b32 v120, 0xffffff00, v120
  s_nop 1
  v_and_b32 v121, 0xffffff00, v121
  s_nop 1
  v_and_b32 v122, 0xffffff00, v122
  s_nop 1
  v_and_b32 v123, 0xffffff00, v123
  s_nop 1
  v_and_b32 v124, 0xffffff00, v124
  s_nop 1
  v_and_b32 v125, 0xffffff00, v125
  s_nop 1
  v_and_b32 v126, 0xffffff00, v126
  s_nop 1
  v_and_b32 v127, 0xffffff00, v127
  s_nop 1
  v_and_b32 v128, 0xffffff00, v128
  s_nop 1
  v_and_b32 v129, 0xffffff00, v129
  s_nop 1
  v_and_b32 v130, 0xffffff00, v130
  s_nop 1
  v_and_b32 v131, 0xffffff00, v131
  s_nop 1
  v_and_b32 v132, 0xffffff00, v132
  s_nop 1
  v_and_b32 v133, 0xffffff00, v133
  s_nop 1
  v_and_b32 v134, 0xffffff00, v134
  s_nop 1
  v_and_b32 v135, 0xffffff00, v135
  s_nop 1
  v_and_b32 v136, 0xffffff00, v136
  s_nop 1
  v_and_b32 v137, 0xffffff00, v137
  s_nop 1
  v_and_b32 v138, 0xffffff00, v138
  s_nop 1
  v_and_b32 v139, 0xffffff00, v139
  s_nop 1
  v_and_b32 v140, 0xffffff00, v140
  s_nop 1
  v_and_b32 v141, 0xffffff00, v141
  s_nop 1
  v_and_b32 v142, 0xffffff00, v142
  s_nop 1
  v_and_b32 v143, 0xffffff00, v143
  s_nop 1
  v_and_b32 v1, 0xff, v1
  s_nop 1
  v_cmp_ne_u32 vcc, 0, v1
  s_nop 1
  s_cbranch_vccz Lslow_kvp_10_d
  s_add_u32 s68, s68, 1
  s_cmp_lt_u32 s68, 20000
  s_cbranch_scc1 Lslow_kvp_10_l
Lslow_kvp_10_d:
  s_nop 4
  s_branch Lback_kvp_10
Lslow_kvf_11:
  s_mov_b32 s68, 0
Lslow_kvf_11_l:
  s_nop 7
  s_nop 7
  s_mov_b32 s71, m0
  s_add_u32 m0, s59, 155648
  s_nop 0
  buffer_load_dwordx4 v28, s[16:19], s36 offen offset:0 sc1 lds
  buffer_load_dwordx4 v28, s[16:19], s36 offen offset:1024 sc1 lds
  s_mov_b32 m0, s71
  s_waitcnt vmcnt(0)
  ds_read_b32 v52, v46 offset:8
  ds_read_b32 v56, v46 offset:1032
  s_waitcnt lgkmcnt(0)
  s_waitcnt vmcnt(0)
  v_xor_b32 v52, s54, v52
  s_nop 1
  v_bitop3_b32 v52, v56, s54, v52 bitop3:0xbe
  s_nop 1
  v_cmp_ne_u32 vcc, 0, v52
  s_nop 1
  s_cbranch_vccz Lslow_kvf_11_d
  s_add_u32 s68, s68, 1
  s_cmp_lt_u32 s68, 20000
  s_cbranch_scc1 Lslow_kvf_11_l
Lslow_kvf_11_d:
  s_nop 4
  s_branch Lback_kvf_11
Lexit:
  s_endpgm
.section .rodata,"a"
.p2align 6
.amdhsa_kernel gated_mix__linear_kernel_hedgehog__mixer_gmlp__prompt_kernel
  .amdhsa_next_free_vgpr 512
  .amdhsa_next_free_sgpr 102
  .amdhsa_accum_offset 256
  .amdhsa_group_segment_fixed_size 0
  .amdhsa_kernarg_size 104
  .amdhsa_user_sgpr_count 2
  .amdhsa_user_sgpr_kernarg_segment_ptr 1
  .amdhsa_system_sgpr_workgroup_id_x 1
.end_amdhsa_kernel
```
